```python
import torch

def _softmax(x, axis=-1):
    return torch.softmax(x, dim=axis)

def _gelu(x):
    return torch.nn.functional.gelu(x, approximate='tanh')

def _silu(x):
    return torch.nn.functional.silu(x)

def _sigmoid(x):
    return torch.sigmoid(x)

def _layernorm(x, axis=-1, eps=1e-05):
    m = x.mean(dim=axis, keepdim=True)
    v = x.var(dim=axis, keepdim=True, unbiased=False)
    return (x - m) / torch.sqrt(v + eps)

def _scatter_add(tgt, idx, src, axis=0):
    return tgt.clone().index_add_(axis, idx, src)

def _segment_sum(src, seg, n):
    out = torch.zeros((n,) + src.shape[1:], dtype=src.dtype)
    return out.index_add_(0, seg, src)

def _pad(x, pw):
    flat = tuple((v for pair in reversed(pw) for v in pair))
    return torch.nn.functional.pad(x, flat)
kernel_name = 'adaLN_cond__sliding_block_cached__dense_activation_relu__prompt'

def setup_inputs():

    _w = lambda a: (lambda t: t.to(torch.bfloat16) if t.is_floating_point() else t)(torch.as_tensor(a))

    def _A_setup():
        B, Sq, D = (1, 2048, 1024)
        Hq, Hkv, Sk, Dh = (32, 4, 2048, 128)
        assert Hq % Hkv == 0, (Hq, Hkv)
        return {'x': _w((lambda *s: torch.randn(*s, dtype=torch.bfloat16) * 0.05)(B, Sq, D)), 'k_cache': _w((lambda *s: torch.randn(*s, dtype=torch.bfloat16) * 3.2)(B, Hkv, Sk, Dh)), 'v_cache': _w((lambda *s: torch.randn(*s, dtype=torch.bfloat16) * 0.4)(B, Hkv, Sk, Dh)), 'wq': _w((lambda *s: torch.randn(*s, dtype=torch.bfloat16) * 3.2)(D, Hq * Dh) * D ** (-0.5)), 'wo': _w((lambda *s: torch.randn(*s, dtype=torch.bfloat16) * 0.4)(Hq * Dh, D) * (Hq * Dh) ** (-0.5))}
    _A_in = _A_setup()

    def _B_setup():
        B, S, D, Dff = (1, 2048, 1024, 3584)
        return {'x': _w((lambda *s: torch.randn(*s, dtype=torch.bfloat16) * 0.05)(B, S, D)), 'w1': _w((lambda *s: torch.randn(*s, dtype=torch.bfloat16) * 0.05)(D, Dff)), 'w2': _w((lambda *s: torch.randn(*s, dtype=torch.bfloat16) * 0.05)(Dff, D))}
    _B_in = _B_setup()
    return {'A_x': _A_in['x'], 'A_k_cache': _A_in['k_cache'], 'A_v_cache': _A_in['v_cache'], 'A_wq': _A_in['wq'], 'A_wo': _A_in['wo'], 'B_x': _B_in['x'], 'B_w1': _B_in['w1'], 'B_w2': _B_in['w2'], 'c': _w((lambda *s: torch.randn(*s, dtype=torch.bfloat16) * 0.1)(1, 1024) * 8.0), 'w_mod': _w((lambda *s: torch.randn(*s, dtype=torch.bfloat16) * 0.1)(1024, 6 * 1024) * 1024 ** (-0.5) * 8.0)}

def reference(A_x, A_k_cache, A_v_cache, A_wq, A_wo, B_x, B_w1, B_w2, c, w_mod):

    def _A_ref(x, k_cache, v_cache, wq, wo):
        B, Sq, D = x.shape
        Hq, Dh = (32, 128)
        Hkv, Sk = (k_cache.shape[1], k_cache.shape[2])
        W = min(4096, max(256, Sk // 4))
        rep = Hq // Hkv
        q = (lambda x, *d: x.permute(*d))((x @ wq).reshape(B, Sq, Hq, Dh), 0, 2, 1, 3)
        k = (lambda x, n, axis: torch.repeat_interleave(x, n, dim=axis))(k_cache[:, :, Sk - W:, :], rep, axis=1)
        v = (lambda x, n, axis: torch.repeat_interleave(x, n, dim=axis))(v_cache[:, :, Sk - W:, :], rep, axis=1)
        scores = torch.einsum('bhqd,bhkd->bhqk', q, k) * Dh ** (-0.5)
        p = _softmax(scores, axis=-1)
        o = torch.einsum('bhqk,bhkd->bhqd', p, v)
        return (lambda x, *d: x.permute(*d))(o, 0, 2, 1, 3).reshape(B, Sq, Hq * Dh) @ wo

    def _B_ref(x, w1, w2):
        h = torch.einsum('bsd,df->bsf', x, w1)
        zero = torch.zeros_like(h)
        h = torch.maximum(h, zero)
        return torch.einsum('bsf,fd->bsd', h, w2)
    x = A_x
    mod = (_silu(c) @ w_mod).reshape(c.shape[0], 6, 1, -1)
    sa, ca, ga, sb, cb, gb = (mod[:, 0].clone(), mod[:, 1].clone(), mod[:, 2].clone(), mod[:, 3].clone(), mod[:, 4].clone(), mod[:, 5].clone())
    h = _layernorm(x, axis=-1) * (1 + ca) + sa
    x = x + ga * _A_ref(h, A_k_cache, A_v_cache, A_wq, A_wo)
    h = _layernorm(x, axis=-1) * (1 + cb) + sb
    x = x + gb * _B_ref(h, B_w1, B_w2)
    return x
```

```asm
; @launch kernel=prep_kernel grid=(448,1,1) block=(256,1,1) lds=12288
; @launch kernel=main_kernel grid=(256,1,1) block=(256,1,1) lds=147456
.amdgcn_target "amdgcn-amd-amdhsa--gfx950"
.text
.globl prep_kernel
.p2align 8
.type prep_kernel,@function
prep_kernel:
 s_cmp_ge_u32 s2, 448
 s_cbranch_scc1 prep_kernel_end
 s_load_dwordx2 s[4:5], s[0:1], 96
 s_load_dwordx2 s[6:7], s[0:1], 64
 s_load_dwordx2 s[36:37], s[0:1], 72
 s_load_dwordx2 s[38:39], s[0:1], 0
 s_load_dwordx2 s[40:41], s[0:1], 8
 s_load_dwordx2 s[42:43], s[0:1], 16
 v_and_b32 v1, 63, v0
 v_lshrrev_b32 v2, 6, v0
 s_nop 0
 v_readfirstlane_b32 s30, v2
 s_waitcnt lgkmcnt(0)
 s_mov_b32 s8, s4
 s_mov_b32 s9, s5
 s_mov_b32 s10, 0x5000000
 s_mov_b32 s11, 0x20000
 s_cmp_ge_u32 s2, 64
 s_cbranch_scc0 prep_kernel_kv
 s_sub_u32 s33, s2, 64
 s_mul_hi_u32 s32, s33, 0x5555556
 s_mul_i32 s31, s32, 48
 s_sub_u32 s31, s33, s31
 s_mov_b32 s12, s36
 s_mov_b32 s13, s37
 s_mov_b32 s14, 0xc00000
 s_mov_b32 s15, 0x20000
 s_mov_b32 s16, s6
 s_mov_b32 s17, s7
 s_mov_b32 s18, 0x800
 s_mov_b32 s19, 0x20000
 s_lshl_b32 s34, s32, 8
 v_and_b32 v10, 127, v0
 v_lshlrev_b32 v10, 1, v10
 buffer_load_ushort v12, v10, s[16:19], s34 offen
 s_mul_i32 s33, s32, 1572864
 s_lshl_b32 s35, s31, 8
 s_add_u32 s33, s33, s35
 v_and_b32 v3, 15, v0
 v_lshrrev_b32 v4, 4, v0
 s_mov_b32 s20, 12288
 v_mul_lo_u32 v5, v4, s20
 v_lshl_add_u32 v5, v3, 4, v5
 s_mov_b32 s21, s33
 buffer_load_dwordx4 v[64:67], v5, s[12:15], s21 offen nt
 s_add_u32 s21, s21, 196608
 buffer_load_dwordx4 v[68:71], v5, s[12:15], s21 offen nt
 s_add_u32 s21, s21, 196608
 buffer_load_dwordx4 v[72:75], v5, s[12:15], s21 offen nt
 s_add_u32 s21, s21, 196608
 buffer_load_dwordx4 v[76:79], v5, s[12:15], s21 offen nt
 s_add_u32 s21, s21, 196608
 buffer_load_dwordx4 v[80:83], v5, s[12:15], s21 offen nt
 s_add_u32 s21, s21, 196608
 buffer_load_dwordx4 v[84:87], v5, s[12:15], s21 offen nt
 s_add_u32 s21, s21, 196608
 buffer_load_dwordx4 v[88:91], v5, s[12:15], s21 offen nt
 s_add_u32 s21, s21, 196608
 buffer_load_dwordx4 v[92:95], v5, s[12:15], s21 offen nt
 s_waitcnt vmcnt(8)
 v_lshlrev_b32 v14, 16, v12
 v_mul_f32 v22, 0xbfb8aa3b, v14
 v_exp_f32 v22, v22
 s_nop 0
 v_add_f32 v22, 1.0, v22
 v_rcp_f32 v22, v22
 s_nop 0
 v_mul_f32 v14, v14, v22
 v_cvt_pk_bf16_f32 v14, v14, v14
 v_lshlrev_b32 v14, 16, v14
 v_lshlrev_b32 v10, 2, v0
 ds_write_b32 v10, v14
 s_waitcnt lgkmcnt(0)
 s_barrier
 v_lshlrev_b32 v6, 2, v4
 ds_read_b32 v32, v6 offset:0
 ds_read_b32 v33, v6 offset:64
 ds_read_b32 v34, v6 offset:128
 ds_read_b32 v35, v6 offset:192
 ds_read_b32 v36, v6 offset:256
 ds_read_b32 v37, v6 offset:320
 ds_read_b32 v38, v6 offset:384
 ds_read_b32 v39, v6 offset:448
 v_mov_b32 v128, 0
 v_mov_b32 v129, 0
 v_mov_b32 v130, 0
 v_mov_b32 v131, 0
 v_mov_b32 v132, 0
 v_mov_b32 v133, 0
 v_mov_b32 v134, 0
 v_mov_b32 v135, 0
 s_waitcnt lgkmcnt(0)
 s_waitcnt vmcnt(7)
 v_lshlrev_b32 v8, 16, v64
 v_and_b32 v9, 0xffff0000, v64
 v_fmac_f32 v128, v8, v32
 v_fmac_f32 v129, v9, v32
 v_lshlrev_b32 v8, 16, v65
 v_and_b32 v9, 0xffff0000, v65
 v_fmac_f32 v130, v8, v32
 v_fmac_f32 v131, v9, v32
 v_lshlrev_b32 v8, 16, v66
 v_and_b32 v9, 0xffff0000, v66
 v_fmac_f32 v132, v8, v32
 v_fmac_f32 v133, v9, v32
 v_lshlrev_b32 v8, 16, v67
 v_and_b32 v9, 0xffff0000, v67
 v_fmac_f32 v134, v8, v32
 v_fmac_f32 v135, v9, v32
 s_waitcnt vmcnt(6)
 v_lshlrev_b32 v8, 16, v68
 v_and_b32 v9, 0xffff0000, v68
 v_fmac_f32 v128, v8, v33
 v_fmac_f32 v129, v9, v33
 v_lshlrev_b32 v8, 16, v69
 v_and_b32 v9, 0xffff0000, v69
 v_fmac_f32 v130, v8, v33
 v_fmac_f32 v131, v9, v33
 v_lshlrev_b32 v8, 16, v70
 v_and_b32 v9, 0xffff0000, v70
 v_fmac_f32 v132, v8, v33
 v_fmac_f32 v133, v9, v33
 v_lshlrev_b32 v8, 16, v71
 v_and_b32 v9, 0xffff0000, v71
 v_fmac_f32 v134, v8, v33
 v_fmac_f32 v135, v9, v33
 s_waitcnt vmcnt(5)
 v_lshlrev_b32 v8, 16, v72
 v_and_b32 v9, 0xffff0000, v72
 v_fmac_f32 v128, v8, v34
 v_fmac_f32 v129, v9, v34
 v_lshlrev_b32 v8, 16, v73
 v_and_b32 v9, 0xffff0000, v73
 v_fmac_f32 v130, v8, v34
 v_fmac_f32 v131, v9, v34
 v_lshlrev_b32 v8, 16, v74
 v_and_b32 v9, 0xffff0000, v74
 v_fmac_f32 v132, v8, v34
 v_fmac_f32 v133, v9, v34
 v_lshlrev_b32 v8, 16, v75
 v_and_b32 v9, 0xffff0000, v75
 v_fmac_f32 v134, v8, v34
 v_fmac_f32 v135, v9, v34
 s_waitcnt vmcnt(4)
 v_lshlrev_b32 v8, 16, v76
 v_and_b32 v9, 0xffff0000, v76
 v_fmac_f32 v128, v8, v35
 v_fmac_f32 v129, v9, v35
 v_lshlrev_b32 v8, 16, v77
 v_and_b32 v9, 0xffff0000, v77
 v_fmac_f32 v130, v8, v35
 v_fmac_f32 v131, v9, v35
 v_lshlrev_b32 v8, 16, v78
 v_and_b32 v9, 0xffff0000, v78
 v_fmac_f32 v132, v8, v35
 v_fmac_f32 v133, v9, v35
 v_lshlrev_b32 v8, 16, v79
 v_and_b32 v9, 0xffff0000, v79
 v_fmac_f32 v134, v8, v35
 v_fmac_f32 v135, v9, v35
 s_waitcnt vmcnt(3)
 v_lshlrev_b32 v8, 16, v80
 v_and_b32 v9, 0xffff0000, v80
 v_fmac_f32 v128, v8, v36
 v_fmac_f32 v129, v9, v36
 v_lshlrev_b32 v8, 16, v81
 v_and_b32 v9, 0xffff0000, v81
 v_fmac_f32 v130, v8, v36
 v_fmac_f32 v131, v9, v36
 v_lshlrev_b32 v8, 16, v82
 v_and_b32 v9, 0xffff0000, v82
 v_fmac_f32 v132, v8, v36
 v_fmac_f32 v133, v9, v36
 v_lshlrev_b32 v8, 16, v83
 v_and_b32 v9, 0xffff0000, v83
 v_fmac_f32 v134, v8, v36
 v_fmac_f32 v135, v9, v36
 s_waitcnt vmcnt(2)
 v_lshlrev_b32 v8, 16, v84
 v_and_b32 v9, 0xffff0000, v84
 v_fmac_f32 v128, v8, v37
 v_fmac_f32 v129, v9, v37
 v_lshlrev_b32 v8, 16, v85
 v_and_b32 v9, 0xffff0000, v85
 v_fmac_f32 v130, v8, v37
 v_fmac_f32 v131, v9, v37
 v_lshlrev_b32 v8, 16, v86
 v_and_b32 v9, 0xffff0000, v86
 v_fmac_f32 v132, v8, v37
 v_fmac_f32 v133, v9, v37
 v_lshlrev_b32 v8, 16, v87
 v_and_b32 v9, 0xffff0000, v87
 v_fmac_f32 v134, v8, v37
 v_fmac_f32 v135, v9, v37
 s_waitcnt vmcnt(1)
 v_lshlrev_b32 v8, 16, v88
 v_and_b32 v9, 0xffff0000, v88
 v_fmac_f32 v128, v8, v38
 v_fmac_f32 v129, v9, v38
 v_lshlrev_b32 v8, 16, v89
 v_and_b32 v9, 0xffff0000, v89
 v_fmac_f32 v130, v8, v38
 v_fmac_f32 v131, v9, v38
 v_lshlrev_b32 v8, 16, v90
 v_and_b32 v9, 0xffff0000, v90
 v_fmac_f32 v132, v8, v38
 v_fmac_f32 v133, v9, v38
 v_lshlrev_b32 v8, 16, v91
 v_and_b32 v9, 0xffff0000, v91
 v_fmac_f32 v134, v8, v38
 v_fmac_f32 v135, v9, v38
 s_waitcnt vmcnt(0)
 v_lshlrev_b32 v8, 16, v92
 v_and_b32 v9, 0xffff0000, v92
 v_fmac_f32 v128, v8, v39
 v_fmac_f32 v129, v9, v39
 v_lshlrev_b32 v8, 16, v93
 v_and_b32 v9, 0xffff0000, v93
 v_fmac_f32 v130, v8, v39
 v_fmac_f32 v131, v9, v39
 v_lshlrev_b32 v8, 16, v94
 v_and_b32 v9, 0xffff0000, v94
 v_fmac_f32 v132, v8, v39
 v_fmac_f32 v133, v9, v39
 v_lshlrev_b32 v8, 16, v95
 v_and_b32 v9, 0xffff0000, v95
 v_fmac_f32 v134, v8, v39
 v_fmac_f32 v135, v9, v39
 v_mov_b32 v160, v128
 v_mov_b32 v161, v129
 v_mov_b32 v162, v130
 v_mov_b32 v163, v131
 v_mov_b32 v164, v132
 v_mov_b32 v165, v133
 v_mov_b32 v166, v134
 v_mov_b32 v167, v135
 v_permlane16_swap_b32 v128, v160
 v_permlane16_swap_b32 v129, v161
 v_permlane16_swap_b32 v130, v162
 v_permlane16_swap_b32 v131, v163
 v_permlane16_swap_b32 v132, v164
 v_permlane16_swap_b32 v133, v165
 v_permlane16_swap_b32 v134, v166
 v_permlane16_swap_b32 v135, v167
 v_add_f32 v128, v128, v160
 v_add_f32 v129, v129, v161
 v_add_f32 v130, v130, v162
 v_add_f32 v131, v131, v163
 v_add_f32 v132, v132, v164
 v_add_f32 v133, v133, v165
 v_add_f32 v134, v134, v166
 v_add_f32 v135, v135, v167
 v_mov_b32 v160, v128
 v_mov_b32 v161, v129
 v_mov_b32 v162, v130
 v_mov_b32 v163, v131
 v_mov_b32 v164, v132
 v_mov_b32 v165, v133
 v_mov_b32 v166, v134
 v_mov_b32 v167, v135
 v_permlane32_swap_b32 v128, v160
 v_permlane32_swap_b32 v129, v161
 v_permlane32_swap_b32 v130, v162
 v_permlane32_swap_b32 v131, v163
 v_permlane32_swap_b32 v132, v164
 v_permlane32_swap_b32 v133, v165
 v_permlane32_swap_b32 v134, v166
 v_permlane32_swap_b32 v135, v167
 v_add_f32 v128, v128, v160
 v_add_f32 v129, v129, v161
 v_add_f32 v130, v130, v162
 v_add_f32 v131, v131, v163
 v_add_f32 v132, v132, v164
 v_add_f32 v133, v133, v165
 v_add_f32 v134, v134, v166
 v_add_f32 v135, v135, v167
 v_lshlrev_b32 v7, 5, v3
 s_lshl_b32 s20, s30, 9
 v_add_u32 v7, s20, v7
 v_cmp_gt_u32 vcc, 16, v1
 s_and_saveexec_b64 s[22:23], vcc
 ds_write_b128 v7, v[128:131] offset:4096
 ds_write_b128 v7, v[132:135] offset:4112
 s_mov_b64 exec, s[22:23]
 s_waitcnt lgkmcnt(0)
 s_barrier
 v_and_b32 v7, 127, v0
 v_lshlrev_b32 v7, 2, v7
 v_lshrrev_b32 v8, 7, v0
 v_lshl_add_u32 v7, v8, 11, v7
 ds_read_b32 v10, v7 offset:4096
 ds_read_b32 v11, v7 offset:4608
 ds_read_b32 v12, v7 offset:5120
 ds_read_b32 v13, v7 offset:5632
 s_waitcnt lgkmcnt(0)
 v_add_f32 v10, v10, v11
 v_add_f32 v12, v12, v13
 v_add_f32 v20, v10, v12
 s_mul_i32 s33, s32, 24576
 s_lshl_b32 s35, s31, 9
 s_add_u32 s33, s33, s35
 s_add_u32 s33, s33, 51707904
 v_lshlrev_b32 v7, 2, v0
 v_cmp_gt_u32 vcc, 128, v0
 s_and_saveexec_b64 s[22:23], vcc
 s_cbranch_execz prep_kernel_a_skip
 buffer_store_dword v20, v7, s[8:11], s33 offen
prep_kernel_a_skip:
 s_mov_b64 exec, s[22:23]
 s_branch prep_kernel_fin
prep_kernel_kv:
 v_lshlrev_b32 v51, 7, v0
 v_mov_b32 v52, 0
 s_mul_i32 s63, s2, 4352
 s_add_u32 s63, s63, 52428800
 v_cmp_gt_u32 vcc, 34, v0
 s_and_saveexec_b64 s[22:23], vcc
 s_cbranch_execz prep_kernel_z
 buffer_store_dword v52, v51, s[8:11], s63 offen
prep_kernel_z:
 s_mov_b64 exec, s[22:23]
 s_mov_b32 s12, s40
 s_mov_b32 s13, s41
 s_mov_b32 s14, 0x200000
 s_mov_b32 s15, 0x20000
 s_mov_b32 s16, s42
 s_mov_b32 s17, s43
 s_mov_b32 s18, 0x200000
 s_mov_b32 s19, 0x20000
 s_sub_u32 s31, s2, 0
 s_lshr_b32 s32, s31, 4
 s_and_b32 s33, s31, 15
 s_lshl_b32 s34, s32, 19
 s_lshl_b32 s35, s33, 13
 s_add_u32 s34, s34, s35
 s_add_u32 s34, s34, 393216
 s_lshl_b32 s35, s31, 14
 s_add_u32 s35, s35, 50331648
 v_and_b32 v3, 15, v1
 v_lshrrev_b32 v4, 4, v1
 v_lshlrev_b32 v5, 8, v3
 v_lshl_add_u32 v5, v4, 3, v5
 s_lshl_b32 s20, s30, 6
 v_add_u32 v5, s20, v5
 s_add_u32 s21, s34, 0
 buffer_load_dwordx2 v[12:13], v5, s[12:15], s21 offen nt
 buffer_load_dwordx2 v[14:15], v5, s[12:15], s21 offen offset:32 nt
 s_add_u32 s21, s34, 4096
 buffer_load_dwordx2 v[16:17], v5, s[12:15], s21 offen nt
 buffer_load_dwordx2 v[18:19], v5, s[12:15], s21 offen offset:32 nt
 v_lshlrev_b32 v6, 10, v4
 v_lshl_add_u32 v6, v3, 1, v6
 s_lshl_b32 s20, s30, 5
 v_add_u32 v6, s20, v6
 s_add_u32 s21, s34, 0
 buffer_load_ushort v32, v6, s[16:19], s21 offen nt
 s_add_u32 s21, s34, 256
 buffer_load_ushort v33, v6, s[16:19], s21 offen nt
 s_add_u32 s21, s34, 512
 buffer_load_ushort v34, v6, s[16:19], s21 offen nt
 s_add_u32 s21, s34, 768
 buffer_load_ushort v35, v6, s[16:19], s21 offen nt
 s_add_u32 s21, s34, 4096
 buffer_load_ushort v36, v6, s[16:19], s21 offen nt
 s_add_u32 s21, s34, 4352
 buffer_load_ushort v37, v6, s[16:19], s21 offen nt
 s_add_u32 s21, s34, 4608
 buffer_load_ushort v38, v6, s[16:19], s21 offen nt
 s_add_u32 s21, s34, 4864
 buffer_load_ushort v39, v6, s[16:19], s21 offen nt
 s_add_u32 s21, s34, 128
 buffer_load_ushort v40, v6, s[16:19], s21 offen nt
 s_add_u32 s21, s34, 384
 buffer_load_ushort v41, v6, s[16:19], s21 offen nt
 s_add_u32 s21, s34, 640
 buffer_load_ushort v42, v6, s[16:19], s21 offen nt
 s_add_u32 s21, s34, 896
 buffer_load_ushort v43, v6, s[16:19], s21 offen nt
 s_add_u32 s21, s34, 4224
 buffer_load_ushort v44, v6, s[16:19], s21 offen nt
 s_add_u32 s21, s34, 4480
 buffer_load_ushort v45, v6, s[16:19], s21 offen nt
 s_add_u32 s21, s34, 4736
 buffer_load_ushort v46, v6, s[16:19], s21 offen nt
 s_add_u32 s21, s34, 4992
 buffer_load_ushort v47, v6, s[16:19], s21 offen nt
 s_waitcnt vmcnt(0)
 v_lshl_or_b32 v24, v33, 16, v32
 v_lshl_or_b32 v25, v35, 16, v34
 v_lshl_or_b32 v26, v37, 16, v36
 v_lshl_or_b32 v27, v39, 16, v38
 v_lshl_or_b32 v28, v41, 16, v40
 v_lshl_or_b32 v29, v43, 16, v42
 v_lshl_or_b32 v30, v45, 16, v44
 v_lshl_or_b32 v31, v47, 16, v46
 v_lshlrev_b32 v7, 4, v1
 s_lshl_b32 s20, s30, 10
 s_add_u32 s20, s20, 0
 s_add_u32 s20, s20, s35
 buffer_store_dwordx4 v[12:15], v7, s[8:11], s20 offen
 s_add_u32 s20, s20, 8192
 buffer_store_dwordx4 v[24:27], v7, s[8:11], s20 offen
 s_lshl_b32 s20, s30, 10
 s_add_u32 s20, s20, 4096
 s_add_u32 s20, s20, s35
 buffer_store_dwordx4 v[16:19], v7, s[8:11], s20 offen
 s_add_u32 s20, s20, 8192
 buffer_store_dwordx4 v[28:31], v7, s[8:11], s20 offen
prep_kernel_fin:
prep_kernel_end:
 s_endpgm
.globl main_kernel
.p2align 8
.type main_kernel,@function
main_kernel:
 s_cmp_ge_u32 s2, 256
 s_cbranch_scc1 main_kernel_end
 s_load_dwordx2 s[4:5], s[0:1], 96
 s_load_dwordx2 s[36:37], s[0:1], 24
 v_and_b32 v1, 63, v0
 v_lshrrev_b32 v2, 6, v0
 s_nop 0
 v_readfirstlane_b32 s30, v2
 s_and_b32 s31, s2, 1
 s_lshl_b32 s31, s31, 2
 s_bfe_u32 s33, s2, 0x20003
 s_add_u32 s100, s31, s33
 s_bfe_u32 s34, s2, 0x20001
 s_lshl_b32 s32, s34, 3
 s_lshr_b32 s33, s2, 5
 s_add_u32 s101, s32, s33
 s_lshl_b32 s81, s100, 5
 s_add_u32 s81, s81, s101
 s_waitcnt lgkmcnt(0)
 s_mov_b32 s8, s4
 s_mov_b32 s9, s5
 s_mov_b32 s10, 0x5000000
 s_mov_b32 s11, 0x20000
 s_mov_b32 s12, s36
 s_mov_b32 s13, s37
 s_mov_b32 s14, 0x800000
 s_mov_b32 s15, 0x20000
 s_load_dwordx2 s[38:39], s[0:1], 0
 v_and_b32 v20, 7, v0
 v_bfe_u32 v21, v0, 3, 2
 v_lshrrev_b32 v22, 5, v0
 v_lshlrev_b32 v23, 6, v22
 v_lshl_add_u32 v23, v21, 3, v23
 v_lshlrev_b32 v26, 11, v20
 v_add_u32 v24, v26, v23
 s_lshl_b32 s20, s81, 14
 s_waitcnt lgkmcnt(0)
 s_mov_b32 s16, s38
 s_mov_b32 s17, s39
 s_mov_b32 s18, 0x400000
 s_mov_b32 s19, 0x20000
 buffer_load_ushort v27, v26, s[16:19], s20 offen
 buffer_load_dwordx2 v[144:145], v24, s[16:19], s20 offen offset:0
 buffer_load_dwordx2 v[146:147], v24, s[16:19], s20 offen offset:32
 buffer_load_dwordx2 v[148:149], v24, s[16:19], s20 offen offset:512
 buffer_load_dwordx2 v[150:151], v24, s[16:19], s20 offen offset:544
 buffer_load_dwordx2 v[152:153], v24, s[16:19], s20 offen offset:1024
 buffer_load_dwordx2 v[154:155], v24, s[16:19], s20 offen offset:1056
 buffer_load_dwordx2 v[156:157], v24, s[16:19], s20 offen offset:1536
 buffer_load_dwordx2 v[158:159], v24, s[16:19], s20 offen offset:1568
 v_lshlrev_b32 v37, 5, v0
 s_mov_b32 s21, 51707904
 buffer_load_dwordx4 v[64:67], v37, s[8:11], s21 offen
 buffer_load_dwordx4 v[68:71], v37, s[8:11], s21 offen offset:16
 s_add_u32 s21, s21, 24576
 buffer_load_dwordx4 v[72:75], v37, s[8:11], s21 offen
 buffer_load_dwordx4 v[76:79], v37, s[8:11], s21 offen offset:16
 s_add_u32 s21, s21, 24576
 buffer_load_dwordx4 v[80:83], v37, s[8:11], s21 offen
 buffer_load_dwordx4 v[84:87], v37, s[8:11], s21 offen offset:16
 s_add_u32 s21, s21, 24576
 buffer_load_dwordx4 v[88:91], v37, s[8:11], s21 offen
 buffer_load_dwordx4 v[92:95], v37, s[8:11], s21 offen offset:16
 s_add_u32 s21, s21, 24576
 buffer_load_dwordx4 v[96:99], v37, s[8:11], s21 offen
 buffer_load_dwordx4 v[100:103], v37, s[8:11], s21 offen offset:16
 s_add_u32 s21, s21, 24576
 buffer_load_dwordx4 v[104:107], v37, s[8:11], s21 offen
 buffer_load_dwordx4 v[108:111], v37, s[8:11], s21 offen offset:16
 s_add_u32 s21, s21, 24576
 buffer_load_dwordx4 v[112:115], v37, s[8:11], s21 offen
 buffer_load_dwordx4 v[116:119], v37, s[8:11], s21 offen offset:16
 s_add_u32 s21, s21, 24576
 buffer_load_dwordx4 v[120:123], v37, s[8:11], s21 offen
 buffer_load_dwordx4 v[124:127], v37, s[8:11], s21 offen offset:16
 s_lshl_b32 s33, s101, 8
 v_lshrrev_b32 v40, 4, v1
 v_and_b32 v41, 15, v1
 v_and_b32 v42, 3, v40
 v_lshlrev_b32 v42, 1, v42
 v_xor_b32 v41, v41, v42
 s_mul_i32 s29, s30, 16
 v_add_u32 v40, s29, v40
 s_mov_b32 s29, 8192
 v_mul_lo_u32 v40, v40, s29
 v_add_u32 v40, s33, v40
 v_lshl_add_u32 v2, v41, 4, v40
 v_xor_b32 v41, 8, v41
 v_lshl_add_u32 v3, v41, 4, v40
 s_mul_i32 s27, s30, 4096
 v_lshrrev_b32 v41, 2, v1
 v_mul_u32_u24 v40, 256, v41
 v_and_b32 v42, 3, v1
 v_lshl_add_u32 v40, v42, 3, v40
 v_and_b32 v41, 7, v41
 v_xor_b32 v42, 0, v41
 v_lshlrev_b32 v42, 5, v42
 v_add_u32 v4, v40, v42
 v_xor_b32 v42, 1, v41
 v_lshlrev_b32 v42, 5, v42
 v_add_u32 v5, v40, v42
 v_xor_b32 v42, 2, v41
 v_lshlrev_b32 v42, 5, v42
 v_add_u32 v6, v40, v42
 v_xor_b32 v42, 3, v41
 v_lshlrev_b32 v42, 5, v42
 v_add_u32 v7, v40, v42
 v_xor_b32 v42, 4, v41
 v_lshlrev_b32 v42, 5, v42
 v_add_u32 v8, v40, v42
 v_xor_b32 v42, 5, v41
 v_lshlrev_b32 v42, 5, v42
 v_add_u32 v9, v40, v42
 v_xor_b32 v42, 6, v41
 v_lshlrev_b32 v42, 5, v42
 v_add_u32 v10, v40, v42
 v_xor_b32 v42, 7, v41
 v_lshlrev_b32 v42, 5, v42
 v_add_u32 v11, v40, v42
 s_mov_b32 s20, 0
 s_add_u32 m0, s27, 0
 s_nop 0
 buffer_load_dwordx4 v2, s[12:15], s20 offen lds
 s_add_u32 s29, s20, 31744
 buffer_load_dwordx4 v3, s[12:15], s29 offen offset:1024 lds
 s_add_u32 s29, s20, 63488
 buffer_load_dwordx4 v2, s[12:15], s29 offen offset:2048 lds
 s_add_u32 s29, s20, 95232
 buffer_load_dwordx4 v3, s[12:15], s29 offen offset:3072 lds
 s_add_u32 s20, s20, 524288
 s_add_u32 m0, s27, 16384
 s_nop 0
 buffer_load_dwordx4 v2, s[12:15], s20 offen lds
 s_add_u32 s29, s20, 31744
 buffer_load_dwordx4 v3, s[12:15], s29 offen offset:1024 lds
 s_add_u32 s29, s20, 63488
 buffer_load_dwordx4 v2, s[12:15], s29 offen offset:2048 lds
 s_add_u32 s29, s20, 95232
 buffer_load_dwordx4 v3, s[12:15], s29 offen offset:3072 lds
 s_add_u32 s20, s20, 524288
 s_add_u32 m0, s27, 32768
 s_nop 0
 buffer_load_dwordx4 v2, s[12:15], s20 offen lds
 s_add_u32 s29, s20, 31744
 buffer_load_dwordx4 v3, s[12:15], s29 offen offset:1024 lds
 s_add_u32 s29, s20, 63488
 buffer_load_dwordx4 v2, s[12:15], s29 offen offset:2048 lds
 s_add_u32 s29, s20, 95232
 buffer_load_dwordx4 v3, s[12:15], s29 offen offset:3072 lds
 s_add_u32 s20, s20, 524288
 s_add_u32 m0, s27, 49152
 s_nop 0
 buffer_load_dwordx4 v2, s[12:15], s20 offen lds
 s_add_u32 s29, s20, 31744
 buffer_load_dwordx4 v3, s[12:15], s29 offen offset:1024 lds
 s_lshr_b32 s22, s81, 1
 s_lshl_b32 s22, s22, 15
 s_and_b32 s23, s81, 1
 s_lshl_b32 s23, s23, 7
 s_add_u32 s22, s22, s23
 v_lshlrev_b32 v25, 10, v22
 v_lshl_add_u32 v25, v21, 8, v25
 v_lshl_add_u32 v25, v20, 4, v25
 s_mov_b32 s24, 0x3e0293ee
 s_waitcnt vmcnt(30)
 v_lshlrev_b32 v26, 16, v27
 v_mov_b32 v27, v26
 v_lshlrev_b32 v160, 16, v144
 v_and_b32 v161, 0xffff0000, v144
 v_lshlrev_b32 v162, 16, v145
 v_and_b32 v163, 0xffff0000, v145
 v_lshlrev_b32 v164, 16, v146
 v_and_b32 v165, 0xffff0000, v146
 v_lshlrev_b32 v166, 16, v147
 v_and_b32 v167, 0xffff0000, v147
 v_lshlrev_b32 v168, 16, v148
 v_and_b32 v169, 0xffff0000, v148
 v_lshlrev_b32 v170, 16, v149
 v_and_b32 v171, 0xffff0000, v149
 v_lshlrev_b32 v172, 16, v150
 v_and_b32 v173, 0xffff0000, v150
 v_lshlrev_b32 v174, 16, v151
 v_and_b32 v175, 0xffff0000, v151
 v_lshlrev_b32 v176, 16, v152
 v_and_b32 v177, 0xffff0000, v152
 v_lshlrev_b32 v178, 16, v153
 v_and_b32 v179, 0xffff0000, v153
 v_lshlrev_b32 v180, 16, v154
 v_and_b32 v181, 0xffff0000, v154
 v_lshlrev_b32 v182, 16, v155
 v_and_b32 v183, 0xffff0000, v155
 v_lshlrev_b32 v184, 16, v156
 v_and_b32 v185, 0xffff0000, v156
 v_lshlrev_b32 v186, 16, v157
 v_and_b32 v187, 0xffff0000, v157
 v_lshlrev_b32 v188, 16, v158
 v_and_b32 v189, 0xffff0000, v158
 v_lshlrev_b32 v190, 16, v159
 v_and_b32 v191, 0xffff0000, v159
 v_pk_add_f32 v[160:161], v[160:161], v[26:27] neg_lo:[0,1] neg_hi:[0,1]
 v_pk_add_f32 v[162:163], v[162:163], v[26:27] neg_lo:[0,1] neg_hi:[0,1]
 v_pk_add_f32 v[164:165], v[164:165], v[26:27] neg_lo:[0,1] neg_hi:[0,1]
 v_pk_add_f32 v[166:167], v[166:167], v[26:27] neg_lo:[0,1] neg_hi:[0,1]
 v_pk_add_f32 v[168:169], v[168:169], v[26:27] neg_lo:[0,1] neg_hi:[0,1]
 v_pk_add_f32 v[170:171], v[170:171], v[26:27] neg_lo:[0,1] neg_hi:[0,1]
 v_pk_add_f32 v[172:173], v[172:173], v[26:27] neg_lo:[0,1] neg_hi:[0,1]
 v_pk_add_f32 v[174:175], v[174:175], v[26:27] neg_lo:[0,1] neg_hi:[0,1]
 v_pk_add_f32 v[176:177], v[176:177], v[26:27] neg_lo:[0,1] neg_hi:[0,1]
 v_pk_add_f32 v[178:179], v[178:179], v[26:27] neg_lo:[0,1] neg_hi:[0,1]
 v_pk_add_f32 v[180:181], v[180:181], v[26:27] neg_lo:[0,1] neg_hi:[0,1]
 v_pk_add_f32 v[182:183], v[182:183], v[26:27] neg_lo:[0,1] neg_hi:[0,1]
 v_pk_add_f32 v[184:185], v[184:185], v[26:27] neg_lo:[0,1] neg_hi:[0,1]
 v_pk_add_f32 v[186:187], v[186:187], v[26:27] neg_lo:[0,1] neg_hi:[0,1]
 v_pk_add_f32 v[188:189], v[188:189], v[26:27] neg_lo:[0,1] neg_hi:[0,1]
 v_pk_add_f32 v[190:191], v[190:191], v[26:27] neg_lo:[0,1] neg_hi:[0,1]
 v_pk_add_f32 v[28:29], v[160:161], v[162:163]
 v_pk_mul_f32 v[30:31], v[160:161], v[160:161]
 v_pk_fma_f32 v[30:31], v[162:163], v[162:163], v[30:31]
 v_pk_add_f32 v[28:29], v[28:29], v[164:165]
 v_pk_fma_f32 v[30:31], v[164:165], v[164:165], v[30:31]
 v_pk_add_f32 v[28:29], v[28:29], v[166:167]
 v_pk_fma_f32 v[30:31], v[166:167], v[166:167], v[30:31]
 v_pk_add_f32 v[28:29], v[28:29], v[168:169]
 v_pk_fma_f32 v[30:31], v[168:169], v[168:169], v[30:31]
 v_pk_add_f32 v[28:29], v[28:29], v[170:171]
 v_pk_fma_f32 v[30:31], v[170:171], v[170:171], v[30:31]
 v_pk_add_f32 v[28:29], v[28:29], v[172:173]
 v_pk_fma_f32 v[30:31], v[172:173], v[172:173], v[30:31]
 v_pk_add_f32 v[28:29], v[28:29], v[174:175]
 v_pk_fma_f32 v[30:31], v[174:175], v[174:175], v[30:31]
 v_pk_add_f32 v[28:29], v[28:29], v[176:177]
 v_pk_fma_f32 v[30:31], v[176:177], v[176:177], v[30:31]
 v_pk_add_f32 v[28:29], v[28:29], v[178:179]
 v_pk_fma_f32 v[30:31], v[178:179], v[178:179], v[30:31]
 v_pk_add_f32 v[28:29], v[28:29], v[180:181]
 v_pk_fma_f32 v[30:31], v[180:181], v[180:181], v[30:31]
 v_pk_add_f32 v[28:29], v[28:29], v[182:183]
 v_pk_fma_f32 v[30:31], v[182:183], v[182:183], v[30:31]
 v_pk_add_f32 v[28:29], v[28:29], v[184:185]
 v_pk_fma_f32 v[30:31], v[184:185], v[184:185], v[30:31]
 v_pk_add_f32 v[28:29], v[28:29], v[186:187]
 v_pk_fma_f32 v[30:31], v[186:187], v[186:187], v[30:31]
 v_pk_add_f32 v[28:29], v[28:29], v[188:189]
 v_pk_fma_f32 v[30:31], v[188:189], v[188:189], v[30:31]
 v_pk_add_f32 v[28:29], v[28:29], v[190:191]
 v_pk_fma_f32 v[30:31], v[190:191], v[190:191], v[30:31]
 v_add_f32 v28, v28, v29
 v_add_f32 v29, v30, v31
 s_nop 0
 v_add_f32_dpp v28, v28, v28 row_ror:8 row_mask:0xf bank_mask:0xf
 v_add_f32_dpp v29, v29, v29 row_ror:8 row_mask:0xf bank_mask:0xf
 v_mov_b32 v30, v28
 v_mov_b32 v31, v29
 s_nop 0
 v_permlane16_swap_b32 v28, v30
 v_permlane16_swap_b32 v29, v31
 v_add_f32 v28, v28, v30
 v_add_f32 v29, v29, v31
 v_mov_b32 v30, v28
 v_mov_b32 v31, v29
 s_nop 0
 v_permlane32_swap_b32 v28, v30
 v_permlane32_swap_b32 v29, v31
 v_add_f32 v28, v28, v30
 v_add_f32 v29, v29, v31
 v_lshlrev_b32 v32, 3, v20
 v_add_u32 v32, 131072, v32
 s_lshl_b32 s25, s30, 6
 v_add_u32 v33, s25, v32
 v_cmp_gt_u32 vcc, 8, v1
 s_and_saveexec_b64 s[60:61], vcc
 ds_write_b64 v33, v[28:29]
 s_mov_b64 exec, s[60:61]
 s_waitcnt vmcnt(14)
 v_pk_add_f32 v[64:65], v[64:65], v[72:73]
 v_pk_add_f32 v[66:67], v[66:67], v[74:75]
 v_pk_add_f32 v[68:69], v[68:69], v[76:77]
 v_pk_add_f32 v[70:71], v[70:71], v[78:79]
 v_pk_add_f32 v[80:81], v[80:81], v[88:89]
 v_pk_add_f32 v[82:83], v[82:83], v[90:91]
 v_pk_add_f32 v[84:85], v[84:85], v[92:93]
 v_pk_add_f32 v[86:87], v[86:87], v[94:95]
 v_pk_add_f32 v[96:97], v[96:97], v[104:105]
 v_pk_add_f32 v[98:99], v[98:99], v[106:107]
 v_pk_add_f32 v[100:101], v[100:101], v[108:109]
 v_pk_add_f32 v[102:103], v[102:103], v[110:111]
 v_pk_add_f32 v[112:113], v[112:113], v[120:121]
 v_pk_add_f32 v[114:115], v[114:115], v[122:123]
 v_pk_add_f32 v[116:117], v[116:117], v[124:125]
 v_pk_add_f32 v[118:119], v[118:119], v[126:127]
 v_pk_add_f32 v[64:65], v[64:65], v[80:81]
 v_pk_add_f32 v[66:67], v[66:67], v[82:83]
 v_pk_add_f32 v[68:69], v[68:69], v[84:85]
 v_pk_add_f32 v[70:71], v[70:71], v[86:87]
 v_pk_add_f32 v[96:97], v[96:97], v[112:113]
 v_pk_add_f32 v[98:99], v[98:99], v[114:115]
 v_pk_add_f32 v[100:101], v[100:101], v[116:117]
 v_pk_add_f32 v[102:103], v[102:103], v[118:119]
 v_pk_add_f32 v[64:65], v[64:65], v[96:97]
 v_pk_add_f32 v[66:67], v[66:67], v[98:99]
 v_pk_add_f32 v[68:69], v[68:69], v[100:101]
 v_pk_add_f32 v[70:71], v[70:71], v[102:103]
 v_cvt_pk_bf16_f32 v72, v64, v65
 v_cvt_pk_bf16_f32 v73, v66, v67
 v_cvt_pk_bf16_f32 v74, v68, v69
 v_cvt_pk_bf16_f32 v75, v70, v71
 v_lshlrev_b32 v64, 16, v72
 v_and_b32 v65, 0xffff0000, v72
 v_lshlrev_b32 v66, 16, v73
 v_and_b32 v67, 0xffff0000, v73
 v_lshlrev_b32 v68, 16, v74
 v_and_b32 v69, 0xffff0000, v74
 v_lshlrev_b32 v70, 16, v75
 v_and_b32 v71, 0xffff0000, v75
 s_cmp_lt_u32 s30, 2
 s_cbranch_scc1 main_kernel_nop1
 v_add_f32 v64, 1.0, v64
 v_add_f32 v65, 1.0, v65
 v_add_f32 v66, 1.0, v66
 v_add_f32 v67, 1.0, v67
 v_add_f32 v68, 1.0, v68
 v_add_f32 v69, 1.0, v69
 v_add_f32 v70, 1.0, v70
 v_add_f32 v71, 1.0, v71
 v_cvt_pk_bf16_f32 v72, v64, v65
 v_cvt_pk_bf16_f32 v73, v66, v67
 v_cvt_pk_bf16_f32 v74, v68, v69
 v_cvt_pk_bf16_f32 v75, v70, v71
 v_lshlrev_b32 v64, 16, v72
 v_and_b32 v65, 0xffff0000, v72
 v_lshlrev_b32 v66, 16, v73
 v_and_b32 v67, 0xffff0000, v73
 v_lshlrev_b32 v68, 16, v74
 v_and_b32 v69, 0xffff0000, v74
 v_lshlrev_b32 v70, 16, v75
 v_and_b32 v71, 0xffff0000, v75
main_kernel_nop1:
 v_mul_f32 v64, s24, v64
 v_mul_f32 v65, s24, v65
 v_mul_f32 v66, s24, v66
 v_mul_f32 v67, s24, v67
 v_mul_f32 v68, s24, v68
 v_mul_f32 v69, s24, v69
 v_mul_f32 v70, s24, v70
 v_mul_f32 v71, s24, v71
 v_add_u32 v37, 131072, v37
 ds_write_b128 v37, v[64:67] offset:1024
 ds_write_b128 v37, v[68:71] offset:1040
 s_waitcnt lgkmcnt(0)
 s_barrier
 ds_read_b64 v[40:41], v32 offset:0
 ds_read_b64 v[42:43], v32 offset:64
 ds_read_b64 v[44:45], v32 offset:128
 ds_read_b64 v[46:47], v32 offset:192
 v_lshlrev_b32 v34, 1, v23
 v_add_u32 v34, 131072, v34
 ds_read_b128 v[64:67], v34 offset:1024
 ds_read_b128 v[96:99], v34 offset:5120
 ds_read_b128 v[68:71], v34 offset:1088
 ds_read_b128 v[100:103], v34 offset:5184
 ds_read_b128 v[72:75], v34 offset:2048
 ds_read_b128 v[104:107], v34 offset:6144
 ds_read_b128 v[76:79], v34 offset:2112
 ds_read_b128 v[108:111], v34 offset:6208
 ds_read_b128 v[80:83], v34 offset:3072
 ds_read_b128 v[112:115], v34 offset:7168
 ds_read_b128 v[84:87], v34 offset:3136
 ds_read_b128 v[116:119], v34 offset:7232
 ds_read_b128 v[88:91], v34 offset:4096
 ds_read_b128 v[120:123], v34 offset:8192
 ds_read_b128 v[92:95], v34 offset:4160
 ds_read_b128 v[124:127], v34 offset:8256
 s_waitcnt lgkmcnt(0)
 v_pk_add_f32 v[40:41], v[40:41], v[42:43]
 v_pk_add_f32 v[44:45], v[44:45], v[46:47]
 v_pk_add_f32 v[40:41], v[40:41], v[44:45]
 v_mul_f32 v40, 0x3a800000, v40
 v_mul_f32 v41, 0x3a800000, v41
 v_fma_f32 v41, -v40, v40, v41
 v_max_f32 v41, 0, v41
 v_add_f32 v41, 0x3727c5ac, v41
 v_rsq_f32 v42, v41
 s_nop 0
 v_mul_f32 v44, v40, v42
 v_sub_f32 v44, 0, v44
 v_mov_b32 v45, v44
 v_mov_b32 v43, v42
 v_pk_fma_f32 v[160:161], v[160:161], v[42:43], v[44:45]
 v_pk_fma_f32 v[162:163], v[162:163], v[42:43], v[44:45]
 v_pk_fma_f32 v[164:165], v[164:165], v[42:43], v[44:45]
 v_pk_fma_f32 v[166:167], v[166:167], v[42:43], v[44:45]
 v_pk_fma_f32 v[168:169], v[168:169], v[42:43], v[44:45]
 v_pk_fma_f32 v[170:171], v[170:171], v[42:43], v[44:45]
 v_pk_fma_f32 v[172:173], v[172:173], v[42:43], v[44:45]
 v_pk_fma_f32 v[174:175], v[174:175], v[42:43], v[44:45]
 v_pk_fma_f32 v[176:177], v[176:177], v[42:43], v[44:45]
 v_pk_fma_f32 v[178:179], v[178:179], v[42:43], v[44:45]
 v_pk_fma_f32 v[180:181], v[180:181], v[42:43], v[44:45]
 v_pk_fma_f32 v[182:183], v[182:183], v[42:43], v[44:45]
 v_pk_fma_f32 v[184:185], v[184:185], v[42:43], v[44:45]
 v_pk_fma_f32 v[186:187], v[186:187], v[42:43], v[44:45]
 v_pk_fma_f32 v[188:189], v[188:189], v[42:43], v[44:45]
 v_pk_fma_f32 v[190:191], v[190:191], v[42:43], v[44:45]
 v_pk_fma_f32 v[160:161], v[160:161], v[96:97], v[64:65]
 v_pk_fma_f32 v[162:163], v[162:163], v[98:99], v[66:67]
 v_pk_fma_f32 v[164:165], v[164:165], v[100:101], v[68:69]
 v_pk_fma_f32 v[166:167], v[166:167], v[102:103], v[70:71]
 v_pk_fma_f32 v[168:169], v[168:169], v[104:105], v[72:73]
 v_pk_fma_f32 v[170:171], v[170:171], v[106:107], v[74:75]
 v_pk_fma_f32 v[172:173], v[172:173], v[108:109], v[76:77]
 v_pk_fma_f32 v[174:175], v[174:175], v[110:111], v[78:79]
 v_pk_fma_f32 v[176:177], v[176:177], v[112:113], v[80:81]
 v_pk_fma_f32 v[178:179], v[178:179], v[114:115], v[82:83]
 v_pk_fma_f32 v[180:181], v[180:181], v[116:117], v[84:85]
 v_pk_fma_f32 v[182:183], v[182:183], v[118:119], v[86:87]
 v_pk_fma_f32 v[184:185], v[184:185], v[120:121], v[88:89]
 v_pk_fma_f32 v[186:187], v[186:187], v[122:123], v[90:91]
 v_pk_fma_f32 v[188:189], v[188:189], v[124:125], v[92:93]
 v_pk_fma_f32 v[190:191], v[190:191], v[126:127], v[94:95]
 v_cvt_pk_bf16_f32 v144, v160, v161
 v_cvt_pk_bf16_f32 v145, v162, v163
 v_cvt_pk_bf16_f32 v146, v164, v165
 v_cvt_pk_bf16_f32 v147, v166, v167
 v_cvt_pk_bf16_f32 v148, v168, v169
 v_cvt_pk_bf16_f32 v149, v170, v171
 v_cvt_pk_bf16_f32 v150, v172, v173
 v_cvt_pk_bf16_f32 v151, v174, v175
 v_cvt_pk_bf16_f32 v152, v176, v177
 v_cvt_pk_bf16_f32 v153, v178, v179
 v_cvt_pk_bf16_f32 v154, v180, v181
 v_cvt_pk_bf16_f32 v155, v182, v183
 v_cvt_pk_bf16_f32 v156, v184, v185
 v_cvt_pk_bf16_f32 v157, v186, v187
 v_cvt_pk_bf16_f32 v158, v188, v189
 v_cvt_pk_bf16_f32 v159, v190, v191
 s_add_u32 s23, s22, 0
 buffer_store_dwordx4 v[144:147], v25, s[8:11], s23 offen sc1
 s_add_u32 s23, s23, 8192
 buffer_store_dwordx4 v[148:151], v25, s[8:11], s23 offen sc1
 s_add_u32 s23, s23, 8192
 buffer_store_dwordx4 v[152:155], v25, s[8:11], s23 offen sc1
 s_add_u32 s23, s23, 8192
 buffer_store_dwordx4 v[156:159], v25, s[8:11], s23 offen sc1
 s_waitcnt vmcnt(0)
 s_barrier
 s_cmp_eq_u32 s30, 0
 s_cbranch_scc0 w0_1
 s_lshl_b32 s78, s100, 7
 s_add_u32 s78, s78, 52690944
 v_mov_b32 v30, 1
 v_mov_b32 v31, 0
 s_mov_b64 exec, 1
 buffer_atomic_add v30, v31, s[8:11], s78 offen sc1
 s_mov_b64 exec, -1
w0_1:
 s_lshl_b32 s35, s100, 4
 s_lshl_b32 s38, s30, 2
 s_add_u32 s35, s35, s38
 v_lshlrev_b32 v40, 4, v1
 s_mul_i32 s29, s35, 32768
 v_add_u32 v12, s29, v40
 s_add_u32 s29, s29, 32768
 v_add_u32 v13, s29, v40
 s_add_u32 s29, s29, 32768
 v_add_u32 v14, s29, v40
 s_add_u32 s29, s29, 32768
 v_add_u32 v15, s29, v40
 v_lshlrev_b32 v16, 4, v1
 s_lshr_b32 s34, s101, 3
 s_lshl_b32 s50, s34, 18
 s_add_u32 s50, s50, 50331648
 s_lshl_b32 s54, s30, 11
 s_add_u32 s50, s50, s54
 s_add_u32 s58, s54, 65536
 s_add_u32 s59, s54, 98304
 v_mov_b32 v128, 0
 v_mov_b32 v129, 0
 v_mov_b32 v130, 0
 v_mov_b32 v131, 0
 v_mov_b32 v132, 0
 v_mov_b32 v133, 0
 v_mov_b32 v134, 0
 v_mov_b32 v135, 0
 v_mov_b32 v136, 0
 v_mov_b32 v137, 0
 v_mov_b32 v138, 0
 v_mov_b32 v139, 0
 v_mov_b32 v140, 0
 v_mov_b32 v141, 0
 v_mov_b32 v142, 0
 v_mov_b32 v143, 0
 v_mov_b32 v144, 0
 v_mov_b32 v145, 0
 v_mov_b32 v146, 0
 v_mov_b32 v147, 0
 v_mov_b32 v148, 0
 v_mov_b32 v149, 0
 v_mov_b32 v150, 0
 v_mov_b32 v151, 0
 v_mov_b32 v152, 0
 v_mov_b32 v153, 0
 v_mov_b32 v154, 0
 v_mov_b32 v155, 0
 v_mov_b32 v156, 0
 v_mov_b32 v157, 0
 v_mov_b32 v158, 0
 v_mov_b32 v159, 0
 v_mov_b32 v160, 0
 v_mov_b32 v161, 0
 v_mov_b32 v162, 0
 v_mov_b32 v163, 0
 v_mov_b32 v164, 0
 v_mov_b32 v165, 0
 v_mov_b32 v166, 0
 v_mov_b32 v167, 0
 v_mov_b32 v168, 0
 v_mov_b32 v169, 0
 v_mov_b32 v170, 0
 v_mov_b32 v171, 0
 v_mov_b32 v172, 0
 v_mov_b32 v173, 0
 v_mov_b32 v174, 0
 v_mov_b32 v175, 0
 v_mov_b32 v176, 0
 v_mov_b32 v177, 0
 v_mov_b32 v178, 0
 v_mov_b32 v179, 0
 v_mov_b32 v180, 0
 v_mov_b32 v181, 0
 v_mov_b32 v182, 0
 v_mov_b32 v183, 0
 v_mov_b32 v184, 0
 v_mov_b32 v185, 0
 v_mov_b32 v186, 0
 v_mov_b32 v187, 0
 v_mov_b32 v188, 0
 v_mov_b32 v189, 0
 v_mov_b32 v190, 0
 v_mov_b32 v191, 0
 v_mov_b32 v192, 0
 v_mov_b32 v193, 0
 v_mov_b32 v194, 0
 v_mov_b32 v195, 0
 v_mov_b32 v196, 0
 v_mov_b32 v197, 0
 v_mov_b32 v198, 0
 v_mov_b32 v199, 0
 v_mov_b32 v200, 0
 v_mov_b32 v201, 0
 v_mov_b32 v202, 0
 v_mov_b32 v203, 0
 v_mov_b32 v204, 0
 v_mov_b32 v205, 0
 v_mov_b32 v206, 0
 v_mov_b32 v207, 0
 v_mov_b32 v208, 0
 v_mov_b32 v209, 0
 v_mov_b32 v210, 0
 v_mov_b32 v211, 0
 v_mov_b32 v212, 0
 v_mov_b32 v213, 0
 v_mov_b32 v214, 0
 v_mov_b32 v215, 0
 v_mov_b32 v216, 0
 v_mov_b32 v217, 0
 v_mov_b32 v218, 0
 v_mov_b32 v219, 0
 v_mov_b32 v220, 0
 v_mov_b32 v221, 0
 v_mov_b32 v222, 0
 v_mov_b32 v223, 0
 v_mov_b32 v224, 0
 v_mov_b32 v225, 0
 v_mov_b32 v226, 0
 v_mov_b32 v227, 0
 v_mov_b32 v228, 0
 v_mov_b32 v229, 0
 v_mov_b32 v230, 0
 v_mov_b32 v231, 0
 v_mov_b32 v232, 0
 v_mov_b32 v233, 0
 v_mov_b32 v234, 0
 v_mov_b32 v235, 0
 v_mov_b32 v236, 0
 v_mov_b32 v237, 0
 v_mov_b32 v238, 0
 v_mov_b32 v239, 0
 v_mov_b32 v240, 0
 v_mov_b32 v241, 0
 v_mov_b32 v242, 0
 v_mov_b32 v243, 0
 v_mov_b32 v244, 0
 v_mov_b32 v245, 0
 v_mov_b32 v246, 0
 v_mov_b32 v247, 0
 v_mov_b32 v248, 0
 v_mov_b32 v249, 0
 v_mov_b32 v250, 0
 v_mov_b32 v251, 0
 v_mov_b32 v252, 0
 v_mov_b32 v253, 0
 v_mov_b32 v254, 0
 v_mov_b32 v255, 0
 s_load_dwordx2 s[62:63], s[0:1], 32
 s_load_dwordx2 s[64:65], s[0:1], 56
 s_load_dwordx2 s[66:67], s[0:1], 48
 v_accvgpr_write_b32 a128, 0
 v_accvgpr_write_b32 a129, 0
 v_accvgpr_write_b32 a130, 0
 v_accvgpr_write_b32 a131, 0
 v_accvgpr_write_b32 a132, 0
 v_accvgpr_write_b32 a133, 0
 v_accvgpr_write_b32 a134, 0
 v_accvgpr_write_b32 a135, 0
 v_accvgpr_write_b32 a136, 0
 v_accvgpr_write_b32 a137, 0
 v_accvgpr_write_b32 a138, 0
 v_accvgpr_write_b32 a139, 0
 v_accvgpr_write_b32 a140, 0
 v_accvgpr_write_b32 a141, 0
 v_accvgpr_write_b32 a142, 0
 v_accvgpr_write_b32 a143, 0
 v_accvgpr_write_b32 a144, 0
 v_accvgpr_write_b32 a145, 0
 v_accvgpr_write_b32 a146, 0
 v_accvgpr_write_b32 a147, 0
 v_accvgpr_write_b32 a148, 0
 v_accvgpr_write_b32 a149, 0
 v_accvgpr_write_b32 a150, 0
 v_accvgpr_write_b32 a151, 0
 v_accvgpr_write_b32 a152, 0
 v_accvgpr_write_b32 a153, 0
 v_accvgpr_write_b32 a154, 0
 v_accvgpr_write_b32 a155, 0
 v_accvgpr_write_b32 a156, 0
 v_accvgpr_write_b32 a157, 0
 v_accvgpr_write_b32 a158, 0
 v_accvgpr_write_b32 a159, 0
 v_accvgpr_write_b32 a160, 0
 v_accvgpr_write_b32 a161, 0
 v_accvgpr_write_b32 a162, 0
 v_accvgpr_write_b32 a163, 0
 v_accvgpr_write_b32 a164, 0
 v_accvgpr_write_b32 a165, 0
 v_accvgpr_write_b32 a166, 0
 v_accvgpr_write_b32 a167, 0
 v_accvgpr_write_b32 a168, 0
 v_accvgpr_write_b32 a169, 0
 v_accvgpr_write_b32 a170, 0
 v_accvgpr_write_b32 a171, 0
 v_accvgpr_write_b32 a172, 0
 v_accvgpr_write_b32 a173, 0
 v_accvgpr_write_b32 a174, 0
 v_accvgpr_write_b32 a175, 0
 v_accvgpr_write_b32 a176, 0
 v_accvgpr_write_b32 a177, 0
 v_accvgpr_write_b32 a178, 0
 v_accvgpr_write_b32 a179, 0
 v_accvgpr_write_b32 a180, 0
 v_accvgpr_write_b32 a181, 0
 v_accvgpr_write_b32 a182, 0
 v_accvgpr_write_b32 a183, 0
 v_accvgpr_write_b32 a184, 0
 v_accvgpr_write_b32 a185, 0
 v_accvgpr_write_b32 a186, 0
 v_accvgpr_write_b32 a187, 0
 v_accvgpr_write_b32 a188, 0
 v_accvgpr_write_b32 a189, 0
 v_accvgpr_write_b32 a190, 0
 v_accvgpr_write_b32 a191, 0
 v_accvgpr_write_b32 a192, 0
 v_accvgpr_write_b32 a193, 0
 v_accvgpr_write_b32 a194, 0
 v_accvgpr_write_b32 a195, 0
 v_accvgpr_write_b32 a196, 0
 v_accvgpr_write_b32 a197, 0
 v_accvgpr_write_b32 a198, 0
 v_accvgpr_write_b32 a199, 0
 v_accvgpr_write_b32 a200, 0
 v_accvgpr_write_b32 a201, 0
 v_accvgpr_write_b32 a202, 0
 v_accvgpr_write_b32 a203, 0
 v_accvgpr_write_b32 a204, 0
 v_accvgpr_write_b32 a205, 0
 v_accvgpr_write_b32 a206, 0
 v_accvgpr_write_b32 a207, 0
 v_accvgpr_write_b32 a208, 0
 v_accvgpr_write_b32 a209, 0
 v_accvgpr_write_b32 a210, 0
 v_accvgpr_write_b32 a211, 0
 v_accvgpr_write_b32 a212, 0
 v_accvgpr_write_b32 a213, 0
 v_accvgpr_write_b32 a214, 0
 v_accvgpr_write_b32 a215, 0
 v_accvgpr_write_b32 a216, 0
 v_accvgpr_write_b32 a217, 0
 v_accvgpr_write_b32 a218, 0
 v_accvgpr_write_b32 a219, 0
 v_accvgpr_write_b32 a220, 0
 v_accvgpr_write_b32 a221, 0
 v_accvgpr_write_b32 a222, 0
 v_accvgpr_write_b32 a223, 0
 v_accvgpr_write_b32 a224, 0
 v_accvgpr_write_b32 a225, 0
 v_accvgpr_write_b32 a226, 0
 v_accvgpr_write_b32 a227, 0
 v_accvgpr_write_b32 a228, 0
 v_accvgpr_write_b32 a229, 0
 v_accvgpr_write_b32 a230, 0
 v_accvgpr_write_b32 a231, 0
 v_accvgpr_write_b32 a232, 0
 v_accvgpr_write_b32 a233, 0
 v_accvgpr_write_b32 a234, 0
 v_accvgpr_write_b32 a235, 0
 v_accvgpr_write_b32 a236, 0
 v_accvgpr_write_b32 a237, 0
 v_accvgpr_write_b32 a238, 0
 v_accvgpr_write_b32 a239, 0
 v_accvgpr_write_b32 a240, 0
 v_accvgpr_write_b32 a241, 0
 v_accvgpr_write_b32 a242, 0
 v_accvgpr_write_b32 a243, 0
 v_accvgpr_write_b32 a244, 0
 v_accvgpr_write_b32 a245, 0
 v_accvgpr_write_b32 a246, 0
 v_accvgpr_write_b32 a247, 0
 v_accvgpr_write_b32 a248, 0
 v_accvgpr_write_b32 a249, 0
 v_accvgpr_write_b32 a250, 0
 v_accvgpr_write_b32 a251, 0
 v_accvgpr_write_b32 a252, 0
 v_accvgpr_write_b32 a253, 0
 v_accvgpr_write_b32 a254, 0
 v_accvgpr_write_b32 a255, 0
 v_mov_b32 v20, 0
 v_mov_b32 v21, 0
 v_mov_b32 v22, 0
 v_mov_b32 v23, 0
 s_waitcnt lgkmcnt(0)
 v_and_b32 v40, 3, v1
 s_lshl_b32 s72, s30, 2
 v_add_u32 v40, s72, v40
 v_mov_b32 v51, 0
 s_mov_b64 exec, 0xf00f
 s_lshl_b32 s73, s2, 15
 v_lshl_add_u32 v41, v40, 7, s73
 v_mov_b32 v49, s63
 v_add_co_u32 v48, vcc, s62, v41
 s_nop 1
 v_addc_co_u32 v49, vcc, 0, v49, vcc
 v_mov_b32 v50, 2048
 s_mov_b64 exec, 0xf0
 s_mul_i32 s73, s2, 28672
 v_mul_u32_u24 v41, 112, v40
 v_add_u32 v41, s73, v41
 v_mov_b32 v49, s65
 v_add_co_u32 v48, vcc, s64, v41
 s_nop 1
 v_addc_co_u32 v49, vcc, 0, v49, vcc
 v_mov_b32 v50, 1792
 s_mov_b64 exec, 0xf00
 v_mul_u32_u24 v41, 112, v40
 v_add_u32 v41, s73, v41
 v_mov_b32 v49, s67
 v_add_co_u32 v48, vcc, s66, v41
 s_nop 1
 v_addc_co_u32 v49, vcc, 0, v49, vcc
 v_mov_b32 v50, 1792
 s_mov_b64 exec, -1
 v_add_u32 v19, 65536, v16
 v_mov_b32 v17, v19
 v_mov_b32 v24, 0
 v_mov_b32 v25, 0
 v_mov_b32 v26, 0
 v_mov_b32 v27, 0
 v_mov_b32 v28, 0
 v_mov_b32 v29, 0
 v_mov_b32 v30, 0
 v_mov_b32 v31, 0
 v_mov_b32 v32, 0
 v_mov_b32 v33, 0
 v_mov_b32 v34, 0
 v_mov_b32 v35, 0
 v_mov_b32 v36, 0
 v_mov_b32 v37, 0
 v_mov_b32 v38, 0
 v_mov_b32 v39, 0
 s_mov_b32 s51, -1
 s_mov_b32 s55, 24576
 s_mov_b32 s49, 8192
 s_add_u32 s56, s50, 32768
 s_add_u32 s57, s50, 8192
 s_cmp_eq_u32 s30, 0
 s_cbranch_scc0 w0_2
 s_lshl_b32 s78, s100, 7
 s_add_u32 s78, s78, 52690944
 v_mov_b32 v31, 0
 s_mov_b64 exec, 1
 s_mov_b32 s76, 0
pl_3:
 buffer_load_dword v30, v31, s[8:11], s78 offen sc1
 s_waitcnt vmcnt(0)
 v_readfirstlane_b32 s77, v30
 s_add_u32 s76, s76, 1
 s_cmp_ge_u32 s77, 32
 s_cbranch_scc1 pd_4
 s_cmp_lt_u32 s76, 0x40000
 s_cbranch_scc1 pl_3
pd_4:
 s_mov_b64 exec, -1
w0_2:
 s_barrier
 s_mov_b32 s26, 0x0
 buffer_load_dwordx4 a[0:3], v12, s[8:11], s26 offen sc1
 buffer_load_dwordx4 a[4:7], v13, s[8:11], s26 offen sc1
 buffer_load_dwordx4 a[8:11], v14, s[8:11], s26 offen sc1
 buffer_load_dwordx4 a[12:15], v15, s[8:11], s26 offen sc1
 buffer_load_dwordx4 a[16:19], v12, s[8:11], s26 offen offset:1024 sc1
 buffer_load_dwordx4 a[20:23], v13, s[8:11], s26 offen offset:1024 sc1
 buffer_load_dwordx4 a[24:27], v14, s[8:11], s26 offen offset:1024 sc1
 buffer_load_dwordx4 a[28:31], v15, s[8:11], s26 offen offset:1024 sc1
 buffer_load_dwordx4 a[32:35], v12, s[8:11], s26 offen offset:2048 sc1
 buffer_load_dwordx4 a[36:39], v13, s[8:11], s26 offen offset:2048 sc1
 buffer_load_dwordx4 a[40:43], v14, s[8:11], s26 offen offset:2048 sc1
 buffer_load_dwordx4 a[44:47], v15, s[8:11], s26 offen offset:2048 sc1
 s_add_u32 s52, s50, 0
 s_add_u32 m0, s58, 0
 s_nop 0
 buffer_load_dwordx4 v16, s[8:11], s52 offen lds
 buffer_load_dwordx4 v16, s[8:11], s52 offen offset:1024 lds
 s_add_u32 s52, s50, 16384
 s_add_u32 m0, s58, 8192
 s_nop 0
 buffer_load_dwordx4 v16, s[8:11], s52 offen lds
 buffer_load_dwordx4 v16, s[8:11], s52 offen offset:1024 lds
 s_add_u32 s52, s50, 8192
 s_add_u32 m0, s59, 0
 s_nop 0
 buffer_load_dwordx4 v16, s[8:11], s52 offen lds
 buffer_load_dwordx4 v16, s[8:11], s52 offen offset:1024 lds
 s_add_u32 s52, s50, 32768
 s_add_u32 m0, s58, 16384
 s_nop 0
 buffer_load_dwordx4 v16, s[8:11], s52 offen lds
 buffer_load_dwordx4 v16, s[8:11], s52 offen offset:1024 lds
 s_add_u32 m0, s27, 49152
 s_mov_b32 s28, 0
 s_waitcnt vmcnt(20)
 s_barrier
 ds_read_b64_tr_b16 a[64:65], v4 offset:0
 ds_read_b64_tr_b16 a[66:67], v4 offset:4096
 ds_read_b64_tr_b16 a[68:69], v5 offset:0
 ds_read_b64_tr_b16 a[70:71], v5 offset:4096
 ds_read_b64_tr_b16 a[72:73], v6 offset:0
 ds_read_b64_tr_b16 a[74:75], v6 offset:4096
 ds_read_b64_tr_b16 a[76:77], v7 offset:0
 ds_read_b64_tr_b16 a[78:79], v7 offset:4096
 ds_read_b64_tr_b16 a[80:81], v8 offset:0
 ds_read_b64_tr_b16 a[82:83], v8 offset:4096
 ds_read_b64_tr_b16 a[84:85], v9 offset:0
 ds_read_b64_tr_b16 a[86:87], v9 offset:4096
 ds_read_b64_tr_b16 a[88:89], v10 offset:0
 ds_read_b64_tr_b16 a[90:91], v10 offset:4096
 ds_read_b64_tr_b16 a[92:93], v11 offset:0
 ds_read_b64_tr_b16 a[94:95], v11 offset:4096
qp_loop:
 s_waitcnt vmcnt(14) lgkmcnt(0)
 v_mfma_f32_16x16x32_bf16 v[128:131], a[64:67], a[0:3], v[128:131]
 ds_read_b64_tr_b16 a[96:97], v4 offset:8192
 ds_read_b64_tr_b16 a[98:99], v4 offset:12288
 v_mfma_f32_16x16x32_bf16 v[132:135], a[64:67], a[4:7], v[132:135]
 buffer_load_dwordx4 a[48:51], v12, s[8:11], s26 offen offset:3072 sc1
 v_mfma_f32_16x16x32_bf16 v[136:139], a[64:67], a[8:11], v[136:139]
 v_mfma_f32_16x16x32_bf16 v[140:143], a[64:67], a[12:15], v[140:143]
 v_mfma_f32_16x16x32_bf16 v[156:159], a[68:71], a[12:15], v[156:159]
 ds_read_b64_tr_b16 a[100:101], v5 offset:8192
 ds_read_b64_tr_b16 a[102:103], v5 offset:12288
 v_mfma_f32_16x16x32_bf16 v[152:155], a[68:71], a[8:11], v[152:155]
 buffer_load_dwordx4 a[52:55], v13, s[8:11], s26 offen offset:3072 sc1
 v_mfma_f32_16x16x32_bf16 v[148:151], a[68:71], a[4:7], v[148:151]
 v_mfma_f32_16x16x32_bf16 v[144:147], a[68:71], a[0:3], v[144:147]
 v_mfma_f32_16x16x32_bf16 v[160:163], a[72:75], a[0:3], v[160:163]
 ds_read_b64_tr_b16 a[104:105], v6 offset:8192
 ds_read_b64_tr_b16 a[106:107], v6 offset:12288
 v_mfma_f32_16x16x32_bf16 v[164:167], a[72:75], a[4:7], v[164:167]
 v_mfma_f32_16x16x32_bf16 v[168:171], a[72:75], a[8:11], v[168:171]
 v_mfma_f32_16x16x32_bf16 v[172:175], a[72:75], a[12:15], v[172:175]
 buffer_load_dwordx4 a[56:59], v14, s[8:11], s26 offen offset:3072 sc1
 v_mfma_f32_16x16x32_bf16 v[188:191], a[76:79], a[12:15], v[188:191]
 ds_read_b64_tr_b16 a[108:109], v7 offset:8192
 ds_read_b64_tr_b16 a[110:111], v7 offset:12288
 v_mfma_f32_16x16x32_bf16 v[184:187], a[76:79], a[8:11], v[184:187]
 v_mfma_f32_16x16x32_bf16 v[180:183], a[76:79], a[4:7], v[180:183]
 v_mfma_f32_16x16x32_bf16 v[176:179], a[76:79], a[0:3], v[176:179]
 v_mfma_f32_16x16x32_bf16 v[192:195], a[80:83], a[0:3], v[192:195]
 ds_read_b64_tr_b16 a[112:113], v8 offset:8192
 ds_read_b64_tr_b16 a[114:115], v8 offset:12288
 v_mfma_f32_16x16x32_bf16 v[196:199], a[80:83], a[4:7], v[196:199]
 buffer_load_dwordx4 a[60:63], v15, s[8:11], s26 offen offset:3072 sc1
 s_add_u32 s26, s26, 4096
 v_mfma_f32_16x16x32_bf16 v[200:203], a[80:83], a[8:11], v[200:203]
 v_mfma_f32_16x16x32_bf16 v[204:207], a[80:83], a[12:15], v[204:207]
 v_mfma_f32_16x16x32_bf16 v[220:223], a[84:87], a[12:15], v[220:223]
 ds_read_b64_tr_b16 a[116:117], v9 offset:8192
 ds_read_b64_tr_b16 a[118:119], v9 offset:12288
 v_mfma_f32_16x16x32_bf16 v[216:219], a[84:87], a[8:11], v[216:219]
 s_add_u32 s29, s20, 63488
 buffer_load_dwordx4 v2, s[12:15], s29 offen offset:2048 lds
 v_mfma_f32_16x16x32_bf16 v[212:215], a[84:87], a[4:7], v[212:215]
 v_mfma_f32_16x16x32_bf16 v[208:211], a[84:87], a[0:3], v[208:211]
 v_mfma_f32_16x16x32_bf16 v[224:227], a[88:91], a[0:3], v[224:227]
 ds_read_b64_tr_b16 a[120:121], v10 offset:8192
 ds_read_b64_tr_b16 a[122:123], v10 offset:12288
 v_mfma_f32_16x16x32_bf16 v[228:231], a[88:91], a[4:7], v[228:231]
 v_mfma_f32_16x16x32_bf16 v[232:235], a[88:91], a[8:11], v[232:235]
 v_mfma_f32_16x16x32_bf16 v[236:239], a[88:91], a[12:15], v[236:239]
 s_add_u32 s29, s20, 95232
 buffer_load_dwordx4 v3, s[12:15], s29 offen offset:3072 lds
 s_add_u32 s20, s20, 524288
 v_mfma_f32_16x16x32_bf16 v[252:255], a[92:95], a[12:15], v[252:255]
 ds_read_b64_tr_b16 a[124:125], v11 offset:8192
 ds_read_b64_tr_b16 a[126:127], v11 offset:12288
 v_mfma_f32_16x16x32_bf16 v[248:251], a[92:95], a[8:11], v[248:251]
 v_mfma_f32_16x16x32_bf16 v[244:247], a[92:95], a[4:7], v[244:247]
 v_mfma_f32_16x16x32_bf16 v[240:243], a[92:95], a[0:3], v[240:243]
 s_waitcnt vmcnt(14) lgkmcnt(0)
 s_barrier
 v_mfma_f32_16x16x32_bf16 v[128:131], a[96:99], a[16:19], v[128:131]
 ds_read_b64_tr_b16 a[64:65], v4 offset:16384
 ds_read_b64_tr_b16 a[66:67], v4 offset:20480
 v_mfma_f32_16x16x32_bf16 v[132:135], a[96:99], a[20:23], v[132:135]
 buffer_load_dwordx4 a[0:3], v12, s[8:11], s26 offen sc1
 v_mfma_f32_16x16x32_bf16 v[136:139], a[96:99], a[24:27], v[136:139]
 v_mfma_f32_16x16x32_bf16 v[140:143], a[96:99], a[28:31], v[140:143]
 v_mfma_f32_16x16x32_bf16 v[156:159], a[100:103], a[28:31], v[156:159]
 ds_read_b64_tr_b16 a[68:69], v5 offset:16384
 ds_read_b64_tr_b16 a[70:71], v5 offset:20480
 v_mfma_f32_16x16x32_bf16 v[152:155], a[100:103], a[24:27], v[152:155]
 buffer_load_dwordx4 a[4:7], v13, s[8:11], s26 offen sc1
 v_mfma_f32_16x16x32_bf16 v[148:151], a[100:103], a[20:23], v[148:151]
 v_mfma_f32_16x16x32_bf16 v[144:147], a[100:103], a[16:19], v[144:147]
 v_mfma_f32_16x16x32_bf16 v[160:163], a[104:107], a[16:19], v[160:163]
 ds_read_b64_tr_b16 a[72:73], v6 offset:16384
 ds_read_b64_tr_b16 a[74:75], v6 offset:20480
 v_mfma_f32_16x16x32_bf16 v[164:167], a[104:107], a[20:23], v[164:167]
 v_mfma_f32_16x16x32_bf16 v[168:171], a[104:107], a[24:27], v[168:171]
 v_mfma_f32_16x16x32_bf16 v[172:175], a[104:107], a[28:31], v[172:175]
 buffer_load_dwordx4 a[8:11], v14, s[8:11], s26 offen sc1
 v_mfma_f32_16x16x32_bf16 v[188:191], a[108:111], a[28:31], v[188:191]
 ds_read_b64_tr_b16 a[76:77], v7 offset:16384
 ds_read_b64_tr_b16 a[78:79], v7 offset:20480
 v_mfma_f32_16x16x32_bf16 v[184:187], a[108:111], a[24:27], v[184:187]
 v_mfma_f32_16x16x32_bf16 v[180:183], a[108:111], a[20:23], v[180:183]
 v_mfma_f32_16x16x32_bf16 v[176:179], a[108:111], a[16:19], v[176:179]
 v_mfma_f32_16x16x32_bf16 v[192:195], a[112:115], a[16:19], v[192:195]
 ds_read_b64_tr_b16 a[80:81], v8 offset:16384
 ds_read_b64_tr_b16 a[82:83], v8 offset:20480
 v_mfma_f32_16x16x32_bf16 v[196:199], a[112:115], a[20:23], v[196:199]
 buffer_load_dwordx4 a[12:15], v15, s[8:11], s26 offen sc1
 v_mfma_f32_16x16x32_bf16 v[200:203], a[112:115], a[24:27], v[200:203]
 v_mfma_f32_16x16x32_bf16 v[204:207], a[112:115], a[28:31], v[204:207]
 v_mfma_f32_16x16x32_bf16 v[220:223], a[116:119], a[28:31], v[220:223]
 ds_read_b64_tr_b16 a[84:85], v9 offset:16384
 ds_read_b64_tr_b16 a[86:87], v9 offset:20480
 v_mfma_f32_16x16x32_bf16 v[216:219], a[116:119], a[24:27], v[216:219]
 s_add_u32 m0, s27, 0
 s_nop 0
 buffer_load_dwordx4 v2, s[12:15], s20 offen lds
 v_mfma_f32_16x16x32_bf16 v[212:215], a[116:119], a[20:23], v[212:215]
 v_mfma_f32_16x16x32_bf16 v[208:211], a[116:119], a[16:19], v[208:211]
 v_mfma_f32_16x16x32_bf16 v[224:227], a[120:123], a[16:19], v[224:227]
 ds_read_b64_tr_b16 a[88:89], v10 offset:16384
 ds_read_b64_tr_b16 a[90:91], v10 offset:20480
 v_mfma_f32_16x16x32_bf16 v[228:231], a[120:123], a[20:23], v[228:231]
 v_mfma_f32_16x16x32_bf16 v[232:235], a[120:123], a[24:27], v[232:235]
 v_mfma_f32_16x16x32_bf16 v[236:239], a[120:123], a[28:31], v[236:239]
 s_add_u32 s29, s20, 31744
 buffer_load_dwordx4 v3, s[12:15], s29 offen offset:1024 lds
 v_mfma_f32_16x16x32_bf16 v[252:255], a[124:127], a[28:31], v[252:255]
 ds_read_b64_tr_b16 a[92:93], v11 offset:16384
 ds_read_b64_tr_b16 a[94:95], v11 offset:20480
 v_mfma_f32_16x16x32_bf16 v[248:251], a[124:127], a[24:27], v[248:251]
 v_mfma_f32_16x16x32_bf16 v[244:247], a[124:127], a[20:23], v[244:247]
 v_mfma_f32_16x16x32_bf16 v[240:243], a[124:127], a[16:19], v[240:243]
 s_waitcnt vmcnt(14) lgkmcnt(0)
 v_mfma_f32_16x16x32_bf16 v[128:131], a[64:67], a[32:35], v[128:131]
 ds_read_b64_tr_b16 a[96:97], v4 offset:24576
 ds_read_b64_tr_b16 a[98:99], v4 offset:28672
 v_mfma_f32_16x16x32_bf16 v[132:135], a[64:67], a[36:39], v[132:135]
 buffer_load_dwordx4 a[16:19], v12, s[8:11], s26 offen offset:1024 sc1
 v_mfma_f32_16x16x32_bf16 v[136:139], a[64:67], a[40:43], v[136:139]
 v_mfma_f32_16x16x32_bf16 v[140:143], a[64:67], a[44:47], v[140:143]
 v_mfma_f32_16x16x32_bf16 v[156:159], a[68:71], a[44:47], v[156:159]
 ds_read_b64_tr_b16 a[100:101], v5 offset:24576
 ds_read_b64_tr_b16 a[102:103], v5 offset:28672
 v_mfma_f32_16x16x32_bf16 v[152:155], a[68:71], a[40:43], v[152:155]
 buffer_load_dwordx4 a[20:23], v13, s[8:11], s26 offen offset:1024 sc1
 v_mfma_f32_16x16x32_bf16 v[148:151], a[68:71], a[36:39], v[148:151]
 v_mfma_f32_16x16x32_bf16 v[144:147], a[68:71], a[32:35], v[144:147]
 v_mfma_f32_16x16x32_bf16 v[160:163], a[72:75], a[32:35], v[160:163]
 ds_read_b64_tr_b16 a[104:105], v6 offset:24576
 ds_read_b64_tr_b16 a[106:107], v6 offset:28672
 v_mfma_f32_16x16x32_bf16 v[164:167], a[72:75], a[36:39], v[164:167]
 v_mfma_f32_16x16x32_bf16 v[168:171], a[72:75], a[40:43], v[168:171]
 v_mfma_f32_16x16x32_bf16 v[172:175], a[72:75], a[44:47], v[172:175]
 buffer_load_dwordx4 a[24:27], v14, s[8:11], s26 offen offset:1024 sc1
 v_mfma_f32_16x16x32_bf16 v[188:191], a[76:79], a[44:47], v[188:191]
 ds_read_b64_tr_b16 a[108:109], v7 offset:24576
 ds_read_b64_tr_b16 a[110:111], v7 offset:28672
 v_mfma_f32_16x16x32_bf16 v[184:187], a[76:79], a[40:43], v[184:187]
 v_mfma_f32_16x16x32_bf16 v[180:183], a[76:79], a[36:39], v[180:183]
 v_mfma_f32_16x16x32_bf16 v[176:179], a[76:79], a[32:35], v[176:179]
 v_mfma_f32_16x16x32_bf16 v[192:195], a[80:83], a[32:35], v[192:195]
 ds_read_b64_tr_b16 a[112:113], v8 offset:24576
 ds_read_b64_tr_b16 a[114:115], v8 offset:28672
 v_mfma_f32_16x16x32_bf16 v[196:199], a[80:83], a[36:39], v[196:199]
 buffer_load_dwordx4 a[28:31], v15, s[8:11], s26 offen offset:1024 sc1
 v_mfma_f32_16x16x32_bf16 v[200:203], a[80:83], a[40:43], v[200:203]
 v_mfma_f32_16x16x32_bf16 v[204:207], a[80:83], a[44:47], v[204:207]
 v_mfma_f32_16x16x32_bf16 v[220:223], a[84:87], a[44:47], v[220:223]
 ds_read_b64_tr_b16 a[116:117], v9 offset:24576
 ds_read_b64_tr_b16 a[118:119], v9 offset:28672
 v_mfma_f32_16x16x32_bf16 v[216:219], a[84:87], a[40:43], v[216:219]
 s_add_u32 s29, s20, 63488
 buffer_load_dwordx4 v2, s[12:15], s29 offen offset:2048 lds
 v_mfma_f32_16x16x32_bf16 v[212:215], a[84:87], a[36:39], v[212:215]
 v_mfma_f32_16x16x32_bf16 v[208:211], a[84:87], a[32:35], v[208:211]
 v_mfma_f32_16x16x32_bf16 v[224:227], a[88:91], a[32:35], v[224:227]
 ds_read_b64_tr_b16 a[120:121], v10 offset:24576
 ds_read_b64_tr_b16 a[122:123], v10 offset:28672
 v_mfma_f32_16x16x32_bf16 v[228:231], a[88:91], a[36:39], v[228:231]
 v_mfma_f32_16x16x32_bf16 v[232:235], a[88:91], a[40:43], v[232:235]
 v_mfma_f32_16x16x32_bf16 v[236:239], a[88:91], a[44:47], v[236:239]
 s_add_u32 s29, s20, 95232
 buffer_load_dwordx4 v3, s[12:15], s29 offen offset:3072 lds
 s_add_u32 s20, s20, 524288
 v_mfma_f32_16x16x32_bf16 v[252:255], a[92:95], a[44:47], v[252:255]
 ds_read_b64_tr_b16 a[124:125], v11 offset:24576
 ds_read_b64_tr_b16 a[126:127], v11 offset:28672
 v_mfma_f32_16x16x32_bf16 v[248:251], a[92:95], a[40:43], v[248:251]
 v_mfma_f32_16x16x32_bf16 v[244:247], a[92:95], a[36:39], v[244:247]
 v_mfma_f32_16x16x32_bf16 v[240:243], a[92:95], a[32:35], v[240:243]
 s_waitcnt vmcnt(14) lgkmcnt(0)
 s_barrier
 v_mfma_f32_16x16x32_bf16 v[128:131], a[96:99], a[48:51], v[128:131]
 ds_read_b64_tr_b16 a[64:65], v4 offset:32768
 ds_read_b64_tr_b16 a[66:67], v4 offset:36864
 v_mfma_f32_16x16x32_bf16 v[132:135], a[96:99], a[52:55], v[132:135]
 buffer_load_dwordx4 a[32:35], v12, s[8:11], s26 offen offset:2048 sc1
 v_mfma_f32_16x16x32_bf16 v[136:139], a[96:99], a[56:59], v[136:139]
 v_mfma_f32_16x16x32_bf16 v[140:143], a[96:99], a[60:63], v[140:143]
 v_mfma_f32_16x16x32_bf16 v[156:159], a[100:103], a[60:63], v[156:159]
 ds_read_b64_tr_b16 a[68:69], v5 offset:32768
 ds_read_b64_tr_b16 a[70:71], v5 offset:36864
 v_mfma_f32_16x16x32_bf16 v[152:155], a[100:103], a[56:59], v[152:155]
 buffer_load_dwordx4 a[36:39], v13, s[8:11], s26 offen offset:2048 sc1
 v_mfma_f32_16x16x32_bf16 v[148:151], a[100:103], a[52:55], v[148:151]
 v_mfma_f32_16x16x32_bf16 v[144:147], a[100:103], a[48:51], v[144:147]
 v_mfma_f32_16x16x32_bf16 v[160:163], a[104:107], a[48:51], v[160:163]
 ds_read_b64_tr_b16 a[72:73], v6 offset:32768
 ds_read_b64_tr_b16 a[74:75], v6 offset:36864
 v_mfma_f32_16x16x32_bf16 v[164:167], a[104:107], a[52:55], v[164:167]
 v_mfma_f32_16x16x32_bf16 v[168:171], a[104:107], a[56:59], v[168:171]
 v_mfma_f32_16x16x32_bf16 v[172:175], a[104:107], a[60:63], v[172:175]
 buffer_load_dwordx4 a[40:43], v14, s[8:11], s26 offen offset:2048 sc1
 v_mfma_f32_16x16x32_bf16 v[188:191], a[108:111], a[60:63], v[188:191]
 ds_read_b64_tr_b16 a[76:77], v7 offset:32768
 ds_read_b64_tr_b16 a[78:79], v7 offset:36864
 v_mfma_f32_16x16x32_bf16 v[184:187], a[108:111], a[56:59], v[184:187]
 v_mfma_f32_16x16x32_bf16 v[180:183], a[108:111], a[52:55], v[180:183]
 v_mfma_f32_16x16x32_bf16 v[176:179], a[108:111], a[48:51], v[176:179]
 v_mfma_f32_16x16x32_bf16 v[192:195], a[112:115], a[48:51], v[192:195]
 ds_read_b64_tr_b16 a[80:81], v8 offset:32768
 ds_read_b64_tr_b16 a[82:83], v8 offset:36864
 v_mfma_f32_16x16x32_bf16 v[196:199], a[112:115], a[52:55], v[196:199]
 buffer_load_dwordx4 a[44:47], v15, s[8:11], s26 offen offset:2048 sc1
 v_mfma_f32_16x16x32_bf16 v[200:203], a[112:115], a[56:59], v[200:203]
 v_mfma_f32_16x16x32_bf16 v[204:207], a[112:115], a[60:63], v[204:207]
 v_mfma_f32_16x16x32_bf16 v[220:223], a[116:119], a[60:63], v[220:223]
 ds_read_b64_tr_b16 a[84:85], v9 offset:32768
 ds_read_b64_tr_b16 a[86:87], v9 offset:36864
 v_mfma_f32_16x16x32_bf16 v[216:219], a[116:119], a[56:59], v[216:219]
 s_add_u32 m0, s27, 16384
 s_nop 0
 buffer_load_dwordx4 v2, s[12:15], s20 offen lds
 v_mfma_f32_16x16x32_bf16 v[212:215], a[116:119], a[52:55], v[212:215]
 v_mfma_f32_16x16x32_bf16 v[208:211], a[116:119], a[48:51], v[208:211]
 v_mfma_f32_16x16x32_bf16 v[224:227], a[120:123], a[48:51], v[224:227]
 ds_read_b64_tr_b16 a[88:89], v10 offset:32768
 ds_read_b64_tr_b16 a[90:91], v10 offset:36864
 v_mfma_f32_16x16x32_bf16 v[228:231], a[120:123], a[52:55], v[228:231]
 v_mfma_f32_16x16x32_bf16 v[232:235], a[120:123], a[56:59], v[232:235]
 v_mfma_f32_16x16x32_bf16 v[236:239], a[120:123], a[60:63], v[236:239]
 s_add_u32 s29, s20, 31744
 buffer_load_dwordx4 v3, s[12:15], s29 offen offset:1024 lds
 v_mfma_f32_16x16x32_bf16 v[252:255], a[124:127], a[60:63], v[252:255]
 ds_read_b64_tr_b16 a[92:93], v11 offset:32768
 ds_read_b64_tr_b16 a[94:95], v11 offset:36864
 v_mfma_f32_16x16x32_bf16 v[248:251], a[124:127], a[56:59], v[248:251]
 v_mfma_f32_16x16x32_bf16 v[244:247], a[124:127], a[52:55], v[244:247]
 v_mfma_f32_16x16x32_bf16 v[240:243], a[124:127], a[48:51], v[240:243]
 s_waitcnt vmcnt(14) lgkmcnt(0)
 v_mfma_f32_16x16x32_bf16 v[128:131], a[64:67], a[0:3], v[128:131]
 ds_read_b64_tr_b16 a[96:97], v4 offset:40960
 ds_read_b64_tr_b16 a[98:99], v4 offset:45056
 v_mfma_f32_16x16x32_bf16 v[132:135], a[64:67], a[4:7], v[132:135]
 buffer_load_dwordx4 a[48:51], v12, s[8:11], s26 offen offset:3072 sc1
 v_mfma_f32_16x16x32_bf16 v[136:139], a[64:67], a[8:11], v[136:139]
 v_mfma_f32_16x16x32_bf16 v[140:143], a[64:67], a[12:15], v[140:143]
 v_mfma_f32_16x16x32_bf16 v[156:159], a[68:71], a[12:15], v[156:159]
 ds_read_b64_tr_b16 a[100:101], v5 offset:40960
 ds_read_b64_tr_b16 a[102:103], v5 offset:45056
 v_mfma_f32_16x16x32_bf16 v[152:155], a[68:71], a[8:11], v[152:155]
 buffer_load_dwordx4 a[52:55], v13, s[8:11], s26 offen offset:3072 sc1
 v_mfma_f32_16x16x32_bf16 v[148:151], a[68:71], a[4:7], v[148:151]
 v_mfma_f32_16x16x32_bf16 v[144:147], a[68:71], a[0:3], v[144:147]
 v_mfma_f32_16x16x32_bf16 v[160:163], a[72:75], a[0:3], v[160:163]
 ds_read_b64_tr_b16 a[104:105], v6 offset:40960
 ds_read_b64_tr_b16 a[106:107], v6 offset:45056
 v_mfma_f32_16x16x32_bf16 v[164:167], a[72:75], a[4:7], v[164:167]
 v_mfma_f32_16x16x32_bf16 v[168:171], a[72:75], a[8:11], v[168:171]
 v_mfma_f32_16x16x32_bf16 v[172:175], a[72:75], a[12:15], v[172:175]
 buffer_load_dwordx4 a[56:59], v14, s[8:11], s26 offen offset:3072 sc1
 v_mfma_f32_16x16x32_bf16 v[188:191], a[76:79], a[12:15], v[188:191]
 ds_read_b64_tr_b16 a[108:109], v7 offset:40960
 ds_read_b64_tr_b16 a[110:111], v7 offset:45056
 v_mfma_f32_16x16x32_bf16 v[184:187], a[76:79], a[8:11], v[184:187]
 v_mfma_f32_16x16x32_bf16 v[180:183], a[76:79], a[4:7], v[180:183]
 v_mfma_f32_16x16x32_bf16 v[176:179], a[76:79], a[0:3], v[176:179]
 v_mfma_f32_16x16x32_bf16 v[192:195], a[80:83], a[0:3], v[192:195]
 ds_read_b64_tr_b16 a[112:113], v8 offset:40960
 ds_read_b64_tr_b16 a[114:115], v8 offset:45056
 v_mfma_f32_16x16x32_bf16 v[196:199], a[80:83], a[4:7], v[196:199]
 buffer_load_dwordx4 a[60:63], v15, s[8:11], s26 offen offset:3072 sc1
 s_add_u32 s26, s26, 4096
 v_mfma_f32_16x16x32_bf16 v[200:203], a[80:83], a[8:11], v[200:203]
 v_mfma_f32_16x16x32_bf16 v[204:207], a[80:83], a[12:15], v[204:207]
 v_mfma_f32_16x16x32_bf16 v[220:223], a[84:87], a[12:15], v[220:223]
 ds_read_b64_tr_b16 a[116:117], v9 offset:40960
 ds_read_b64_tr_b16 a[118:119], v9 offset:45056
 v_mfma_f32_16x16x32_bf16 v[216:219], a[84:87], a[8:11], v[216:219]
 s_add_u32 s29, s20, 63488
 buffer_load_dwordx4 v2, s[12:15], s29 offen offset:2048 lds
 v_mfma_f32_16x16x32_bf16 v[212:215], a[84:87], a[4:7], v[212:215]
 v_mfma_f32_16x16x32_bf16 v[208:211], a[84:87], a[0:3], v[208:211]
 v_mfma_f32_16x16x32_bf16 v[224:227], a[88:91], a[0:3], v[224:227]
 ds_read_b64_tr_b16 a[120:121], v10 offset:40960
 ds_read_b64_tr_b16 a[122:123], v10 offset:45056
 v_mfma_f32_16x16x32_bf16 v[228:231], a[88:91], a[4:7], v[228:231]
 v_mfma_f32_16x16x32_bf16 v[232:235], a[88:91], a[8:11], v[232:235]
 v_mfma_f32_16x16x32_bf16 v[236:239], a[88:91], a[12:15], v[236:239]
 s_add_u32 s29, s20, 95232
 buffer_load_dwordx4 v3, s[12:15], s29 offen offset:3072 lds
 s_add_u32 s20, s20, 524288
 v_mfma_f32_16x16x32_bf16 v[252:255], a[92:95], a[12:15], v[252:255]
 ds_read_b64_tr_b16 a[124:125], v11 offset:40960
 ds_read_b64_tr_b16 a[126:127], v11 offset:45056
 v_mfma_f32_16x16x32_bf16 v[248:251], a[92:95], a[8:11], v[248:251]
 v_mfma_f32_16x16x32_bf16 v[244:247], a[92:95], a[4:7], v[244:247]
 v_mfma_f32_16x16x32_bf16 v[240:243], a[92:95], a[0:3], v[240:243]
 s_waitcnt vmcnt(14) lgkmcnt(0)
 s_barrier
 v_mfma_f32_16x16x32_bf16 v[128:131], a[96:99], a[16:19], v[128:131]
 ds_read_b64_tr_b16 a[64:65], v4 offset:49152
 ds_read_b64_tr_b16 a[66:67], v4 offset:53248
 v_mfma_f32_16x16x32_bf16 v[132:135], a[96:99], a[20:23], v[132:135]
 buffer_load_dwordx4 a[0:3], v12, s[8:11], s26 offen sc1
 v_mfma_f32_16x16x32_bf16 v[136:139], a[96:99], a[24:27], v[136:139]
 v_mfma_f32_16x16x32_bf16 v[140:143], a[96:99], a[28:31], v[140:143]
 v_mfma_f32_16x16x32_bf16 v[156:159], a[100:103], a[28:31], v[156:159]
 ds_read_b64_tr_b16 a[68:69], v5 offset:49152
 ds_read_b64_tr_b16 a[70:71], v5 offset:53248
 v_mfma_f32_16x16x32_bf16 v[152:155], a[100:103], a[24:27], v[152:155]
 buffer_load_dwordx4 a[4:7], v13, s[8:11], s26 offen sc1
 v_mfma_f32_16x16x32_bf16 v[148:151], a[100:103], a[20:23], v[148:151]
 v_mfma_f32_16x16x32_bf16 v[144:147], a[100:103], a[16:19], v[144:147]
 v_mfma_f32_16x16x32_bf16 v[160:163], a[104:107], a[16:19], v[160:163]
 ds_read_b64_tr_b16 a[72:73], v6 offset:49152
 ds_read_b64_tr_b16 a[74:75], v6 offset:53248
 v_mfma_f32_16x16x32_bf16 v[164:167], a[104:107], a[20:23], v[164:167]
 v_mfma_f32_16x16x32_bf16 v[168:171], a[104:107], a[24:27], v[168:171]
 v_mfma_f32_16x16x32_bf16 v[172:175], a[104:107], a[28:31], v[172:175]
 buffer_load_dwordx4 a[8:11], v14, s[8:11], s26 offen sc1
 v_mfma_f32_16x16x32_bf16 v[188:191], a[108:111], a[28:31], v[188:191]
 ds_read_b64_tr_b16 a[76:77], v7 offset:49152
 ds_read_b64_tr_b16 a[78:79], v7 offset:53248
 v_mfma_f32_16x16x32_bf16 v[184:187], a[108:111], a[24:27], v[184:187]
 v_mfma_f32_16x16x32_bf16 v[180:183], a[108:111], a[20:23], v[180:183]
 v_mfma_f32_16x16x32_bf16 v[176:179], a[108:111], a[16:19], v[176:179]
 v_mfma_f32_16x16x32_bf16 v[192:195], a[112:115], a[16:19], v[192:195]
 ds_read_b64_tr_b16 a[80:81], v8 offset:49152
 ds_read_b64_tr_b16 a[82:83], v8 offset:53248
 v_mfma_f32_16x16x32_bf16 v[196:199], a[112:115], a[20:23], v[196:199]
 buffer_load_dwordx4 a[12:15], v15, s[8:11], s26 offen sc1
 v_mfma_f32_16x16x32_bf16 v[200:203], a[112:115], a[24:27], v[200:203]
 v_mfma_f32_16x16x32_bf16 v[204:207], a[112:115], a[28:31], v[204:207]
 v_mfma_f32_16x16x32_bf16 v[220:223], a[116:119], a[28:31], v[220:223]
 ds_read_b64_tr_b16 a[84:85], v9 offset:49152
 ds_read_b64_tr_b16 a[86:87], v9 offset:53248
 v_mfma_f32_16x16x32_bf16 v[216:219], a[116:119], a[24:27], v[216:219]
 s_add_u32 m0, s27, 32768
 s_nop 0
 buffer_load_dwordx4 v2, s[12:15], s20 offen lds
 v_mfma_f32_16x16x32_bf16 v[212:215], a[116:119], a[20:23], v[212:215]
 v_mfma_f32_16x16x32_bf16 v[208:211], a[116:119], a[16:19], v[208:211]
 v_mfma_f32_16x16x32_bf16 v[224:227], a[120:123], a[16:19], v[224:227]
 ds_read_b64_tr_b16 a[88:89], v10 offset:49152
 ds_read_b64_tr_b16 a[90:91], v10 offset:53248
 v_mfma_f32_16x16x32_bf16 v[228:231], a[120:123], a[20:23], v[228:231]
 v_mfma_f32_16x16x32_bf16 v[232:235], a[120:123], a[24:27], v[232:235]
 v_mfma_f32_16x16x32_bf16 v[236:239], a[120:123], a[28:31], v[236:239]
 s_add_u32 s29, s20, 31744
 buffer_load_dwordx4 v3, s[12:15], s29 offen offset:1024 lds
 v_mfma_f32_16x16x32_bf16 v[252:255], a[124:127], a[28:31], v[252:255]
 ds_read_b64_tr_b16 a[92:93], v11 offset:49152
 ds_read_b64_tr_b16 a[94:95], v11 offset:53248
 v_mfma_f32_16x16x32_bf16 v[248:251], a[124:127], a[24:27], v[248:251]
 v_mfma_f32_16x16x32_bf16 v[244:247], a[124:127], a[20:23], v[244:247]
 v_mfma_f32_16x16x32_bf16 v[240:243], a[124:127], a[16:19], v[240:243]
 s_waitcnt vmcnt(14) lgkmcnt(0)
 v_mfma_f32_16x16x32_bf16 v[128:131], a[64:67], a[32:35], v[128:131]
 ds_read_b64_tr_b16 a[96:97], v4 offset:57344
 ds_read_b64_tr_b16 a[98:99], v4 offset:61440
 v_mfma_f32_16x16x32_bf16 v[132:135], a[64:67], a[36:39], v[132:135]
 buffer_load_dwordx4 a[16:19], v12, s[8:11], s26 offen offset:1024 sc1
 v_mfma_f32_16x16x32_bf16 v[136:139], a[64:67], a[40:43], v[136:139]
 v_mfma_f32_16x16x32_bf16 v[140:143], a[64:67], a[44:47], v[140:143]
 v_mfma_f32_16x16x32_bf16 v[156:159], a[68:71], a[44:47], v[156:159]
 ds_read_b64_tr_b16 a[100:101], v5 offset:57344
 ds_read_b64_tr_b16 a[102:103], v5 offset:61440
 v_mfma_f32_16x16x32_bf16 v[152:155], a[68:71], a[40:43], v[152:155]
 buffer_load_dwordx4 a[20:23], v13, s[8:11], s26 offen offset:1024 sc1
 v_mfma_f32_16x16x32_bf16 v[148:151], a[68:71], a[36:39], v[148:151]
 v_mfma_f32_16x16x32_bf16 v[144:147], a[68:71], a[32:35], v[144:147]
 v_mfma_f32_16x16x32_bf16 v[160:163], a[72:75], a[32:35], v[160:163]
 ds_read_b64_tr_b16 a[104:105], v6 offset:57344
 ds_read_b64_tr_b16 a[106:107], v6 offset:61440
 v_mfma_f32_16x16x32_bf16 v[164:167], a[72:75], a[36:39], v[164:167]
 v_mfma_f32_16x16x32_bf16 v[168:171], a[72:75], a[40:43], v[168:171]
 v_mfma_f32_16x16x32_bf16 v[172:175], a[72:75], a[44:47], v[172:175]
 buffer_load_dwordx4 a[24:27], v14, s[8:11], s26 offen offset:1024 sc1
 v_mfma_f32_16x16x32_bf16 v[188:191], a[76:79], a[44:47], v[188:191]
 ds_read_b64_tr_b16 a[108:109], v7 offset:57344
 ds_read_b64_tr_b16 a[110:111], v7 offset:61440
 v_mfma_f32_16x16x32_bf16 v[184:187], a[76:79], a[40:43], v[184:187]
 v_mfma_f32_16x16x32_bf16 v[180:183], a[76:79], a[36:39], v[180:183]
 v_mfma_f32_16x16x32_bf16 v[176:179], a[76:79], a[32:35], v[176:179]
 v_mfma_f32_16x16x32_bf16 v[192:195], a[80:83], a[32:35], v[192:195]
 ds_read_b64_tr_b16 a[112:113], v8 offset:57344
 ds_read_b64_tr_b16 a[114:115], v8 offset:61440
 v_mfma_f32_16x16x32_bf16 v[196:199], a[80:83], a[36:39], v[196:199]
 buffer_load_dwordx4 a[28:31], v15, s[8:11], s26 offen offset:1024 sc1
 v_mfma_f32_16x16x32_bf16 v[200:203], a[80:83], a[40:43], v[200:203]
 v_mfma_f32_16x16x32_bf16 v[204:207], a[80:83], a[44:47], v[204:207]
 v_mfma_f32_16x16x32_bf16 v[220:223], a[84:87], a[44:47], v[220:223]
 ds_read_b64_tr_b16 a[116:117], v9 offset:57344
 ds_read_b64_tr_b16 a[118:119], v9 offset:61440
 v_mfma_f32_16x16x32_bf16 v[216:219], a[84:87], a[40:43], v[216:219]
 s_add_u32 s29, s20, 63488
 buffer_load_dwordx4 v2, s[12:15], s29 offen offset:2048 lds
 v_mfma_f32_16x16x32_bf16 v[212:215], a[84:87], a[36:39], v[212:215]
 v_mfma_f32_16x16x32_bf16 v[208:211], a[84:87], a[32:35], v[208:211]
 v_mfma_f32_16x16x32_bf16 v[224:227], a[88:91], a[32:35], v[224:227]
 ds_read_b64_tr_b16 a[120:121], v10 offset:57344
 ds_read_b64_tr_b16 a[122:123], v10 offset:61440
 v_mfma_f32_16x16x32_bf16 v[228:231], a[88:91], a[36:39], v[228:231]
 v_mfma_f32_16x16x32_bf16 v[232:235], a[88:91], a[40:43], v[232:235]
 v_mfma_f32_16x16x32_bf16 v[236:239], a[88:91], a[44:47], v[236:239]
 s_add_u32 s29, s20, 95232
 buffer_load_dwordx4 v3, s[12:15], s29 offen offset:3072 lds
 s_add_u32 s20, s20, 524288
 v_mfma_f32_16x16x32_bf16 v[252:255], a[92:95], a[44:47], v[252:255]
 ds_read_b64_tr_b16 a[124:125], v11 offset:57344
 ds_read_b64_tr_b16 a[126:127], v11 offset:61440
 v_mfma_f32_16x16x32_bf16 v[248:251], a[92:95], a[40:43], v[248:251]
 v_mfma_f32_16x16x32_bf16 v[244:247], a[92:95], a[36:39], v[244:247]
 v_mfma_f32_16x16x32_bf16 v[240:243], a[92:95], a[32:35], v[240:243]
 s_waitcnt vmcnt(14) lgkmcnt(0)
 s_barrier
 v_mfma_f32_16x16x32_bf16 v[128:131], a[96:99], a[48:51], v[128:131]
 ds_read_b64_tr_b16 a[64:65], v4 offset:0
 ds_read_b64_tr_b16 a[66:67], v4 offset:4096
 v_mfma_f32_16x16x32_bf16 v[132:135], a[96:99], a[52:55], v[132:135]
 buffer_load_dwordx4 a[32:35], v12, s[8:11], s26 offen offset:2048 sc1
 v_mfma_f32_16x16x32_bf16 v[136:139], a[96:99], a[56:59], v[136:139]
 v_mfma_f32_16x16x32_bf16 v[140:143], a[96:99], a[60:63], v[140:143]
 v_mfma_f32_16x16x32_bf16 v[156:159], a[100:103], a[60:63], v[156:159]
 ds_read_b64_tr_b16 a[68:69], v5 offset:0
 ds_read_b64_tr_b16 a[70:71], v5 offset:4096
 v_mfma_f32_16x16x32_bf16 v[152:155], a[100:103], a[56:59], v[152:155]
 buffer_load_dwordx4 a[36:39], v13, s[8:11], s26 offen offset:2048 sc1
 v_mfma_f32_16x16x32_bf16 v[148:151], a[100:103], a[52:55], v[148:151]
 v_mfma_f32_16x16x32_bf16 v[144:147], a[100:103], a[48:51], v[144:147]
 v_mfma_f32_16x16x32_bf16 v[160:163], a[104:107], a[48:51], v[160:163]
 ds_read_b64_tr_b16 a[72:73], v6 offset:0
 ds_read_b64_tr_b16 a[74:75], v6 offset:4096
 v_mfma_f32_16x16x32_bf16 v[164:167], a[104:107], a[52:55], v[164:167]
 v_mfma_f32_16x16x32_bf16 v[168:171], a[104:107], a[56:59], v[168:171]
 v_mfma_f32_16x16x32_bf16 v[172:175], a[104:107], a[60:63], v[172:175]
 buffer_load_dwordx4 a[40:43], v14, s[8:11], s26 offen offset:2048 sc1
 v_mfma_f32_16x16x32_bf16 v[188:191], a[108:111], a[60:63], v[188:191]
 ds_read_b64_tr_b16 a[76:77], v7 offset:0
 ds_read_b64_tr_b16 a[78:79], v7 offset:4096
 v_mfma_f32_16x16x32_bf16 v[184:187], a[108:111], a[56:59], v[184:187]
 v_mfma_f32_16x16x32_bf16 v[180:183], a[108:111], a[52:55], v[180:183]
 v_mfma_f32_16x16x32_bf16 v[176:179], a[108:111], a[48:51], v[176:179]
 v_mfma_f32_16x16x32_bf16 v[192:195], a[112:115], a[48:51], v[192:195]
 ds_read_b64_tr_b16 a[80:81], v8 offset:0
 ds_read_b64_tr_b16 a[82:83], v8 offset:4096
 v_mfma_f32_16x16x32_bf16 v[196:199], a[112:115], a[52:55], v[196:199]
 buffer_load_dwordx4 a[44:47], v15, s[8:11], s26 offen offset:2048 sc1
 v_mfma_f32_16x16x32_bf16 v[200:203], a[112:115], a[56:59], v[200:203]
 v_mfma_f32_16x16x32_bf16 v[204:207], a[112:115], a[60:63], v[204:207]
 v_mfma_f32_16x16x32_bf16 v[220:223], a[116:119], a[60:63], v[220:223]
 ds_read_b64_tr_b16 a[84:85], v9 offset:0
 ds_read_b64_tr_b16 a[86:87], v9 offset:4096
 v_mfma_f32_16x16x32_bf16 v[216:219], a[116:119], a[56:59], v[216:219]
 s_add_u32 m0, s27, 49152
 s_nop 0
 buffer_load_dwordx4 v2, s[12:15], s20 offen lds
 v_mfma_f32_16x16x32_bf16 v[212:215], a[116:119], a[52:55], v[212:215]
 v_mfma_f32_16x16x32_bf16 v[208:211], a[116:119], a[48:51], v[208:211]
 v_mfma_f32_16x16x32_bf16 v[224:227], a[120:123], a[48:51], v[224:227]
 ds_read_b64_tr_b16 a[88:89], v10 offset:0
 ds_read_b64_tr_b16 a[90:91], v10 offset:4096
 v_mfma_f32_16x16x32_bf16 v[228:231], a[120:123], a[52:55], v[228:231]
 v_mfma_f32_16x16x32_bf16 v[232:235], a[120:123], a[56:59], v[232:235]
 v_mfma_f32_16x16x32_bf16 v[236:239], a[120:123], a[60:63], v[236:239]
 s_add_u32 s29, s20, 31744
 buffer_load_dwordx4 v3, s[12:15], s29 offen offset:1024 lds
 v_mfma_f32_16x16x32_bf16 v[252:255], a[124:127], a[60:63], v[252:255]
 ds_read_b64_tr_b16 a[92:93], v11 offset:0
 ds_read_b64_tr_b16 a[94:95], v11 offset:4096
 v_mfma_f32_16x16x32_bf16 v[248:251], a[124:127], a[56:59], v[248:251]
 v_mfma_f32_16x16x32_bf16 v[244:247], a[124:127], a[52:55], v[244:247]
 v_mfma_f32_16x16x32_bf16 v[240:243], a[124:127], a[48:51], v[240:243]
 s_add_u32 s28, s28, 1
 s_cmp_lt_u32 s28, 4
 s_cbranch_scc1 qp_loop
 s_mov_b32 s32, s101
 v_cvt_pk_bf16_f32 v64, v128, v129
 v_cvt_pk_bf16_f32 v65, v130, v131
 v_cvt_pk_bf16_f32 v66, v144, v145
 v_cvt_pk_bf16_f32 v67, v146, v147
 v_cvt_pk_bf16_f32 v68, v160, v161
 v_cvt_pk_bf16_f32 v69, v162, v163
 v_cvt_pk_bf16_f32 v70, v176, v177
 v_cvt_pk_bf16_f32 v71, v178, v179
 v_cvt_pk_bf16_f32 v72, v192, v193
 v_cvt_pk_bf16_f32 v73, v194, v195
 v_cvt_pk_bf16_f32 v74, v208, v209
 v_cvt_pk_bf16_f32 v75, v210, v211
 v_cvt_pk_bf16_f32 v76, v224, v225
 v_cvt_pk_bf16_f32 v77, v226, v227
 v_cvt_pk_bf16_f32 v78, v240, v241
 v_cvt_pk_bf16_f32 v79, v242, v243
 v_cvt_pk_bf16_f32 v80, v132, v133
 v_cvt_pk_bf16_f32 v81, v134, v135
 v_cvt_pk_bf16_f32 v82, v148, v149
 v_cvt_pk_bf16_f32 v83, v150, v151
 v_cvt_pk_bf16_f32 v84, v164, v165
 v_cvt_pk_bf16_f32 v85, v166, v167
 v_cvt_pk_bf16_f32 v86, v180, v181
 v_cvt_pk_bf16_f32 v87, v182, v183
 v_cvt_pk_bf16_f32 v88, v196, v197
 v_cvt_pk_bf16_f32 v89, v198, v199
 v_cvt_pk_bf16_f32 v90, v212, v213
 v_cvt_pk_bf16_f32 v91, v214, v215
 v_cvt_pk_bf16_f32 v92, v228, v229
 v_cvt_pk_bf16_f32 v93, v230, v231
 v_cvt_pk_bf16_f32 v94, v244, v245
 v_cvt_pk_bf16_f32 v95, v246, v247
 v_cvt_pk_bf16_f32 v96, v136, v137
 v_cvt_pk_bf16_f32 v97, v138, v139
 v_cvt_pk_bf16_f32 v98, v152, v153
 v_cvt_pk_bf16_f32 v99, v154, v155
 v_cvt_pk_bf16_f32 v100, v168, v169
 v_cvt_pk_bf16_f32 v101, v170, v171
 v_cvt_pk_bf16_f32 v102, v184, v185
 v_cvt_pk_bf16_f32 v103, v186, v187
 v_cvt_pk_bf16_f32 v104, v200, v201
 v_cvt_pk_bf16_f32 v105, v202, v203
 v_cvt_pk_bf16_f32 v106, v216, v217
 v_cvt_pk_bf16_f32 v107, v218, v219
 v_cvt_pk_bf16_f32 v108, v232, v233
 v_cvt_pk_bf16_f32 v109, v234, v235
 v_cvt_pk_bf16_f32 v110, v248, v249
 v_cvt_pk_bf16_f32 v111, v250, v251
 v_cvt_pk_bf16_f32 v112, v140, v141
 v_cvt_pk_bf16_f32 v113, v142, v143
 v_cvt_pk_bf16_f32 v114, v156, v157
 v_cvt_pk_bf16_f32 v115, v158, v159
 v_cvt_pk_bf16_f32 v116, v172, v173
 v_cvt_pk_bf16_f32 v117, v174, v175
 v_cvt_pk_bf16_f32 v118, v188, v189
 v_cvt_pk_bf16_f32 v119, v190, v191
 v_cvt_pk_bf16_f32 v120, v204, v205
 v_cvt_pk_bf16_f32 v121, v206, v207
 v_cvt_pk_bf16_f32 v122, v220, v221
 v_cvt_pk_bf16_f32 v123, v222, v223
 v_cvt_pk_bf16_f32 v124, v236, v237
 v_cvt_pk_bf16_f32 v125, v238, v239
 v_cvt_pk_bf16_f32 v126, v252, v253
 v_cvt_pk_bf16_f32 v127, v254, v255
 s_waitcnt vmcnt(0) lgkmcnt(0)
 s_barrier
 ds_read_b128 a[0:3], v17 offset:0
 ds_read_b128 a[4:7], v17 offset:1024
 ds_read_b128 a[8:11], v17 offset:2048
 ds_read_b128 a[12:15], v17 offset:3072
 s_waitcnt lgkmcnt(2)
 v_mfma_f32_16x16x32_bf16 v[128:131], a[0:3], v[64:67], v[24:27]
 ds_read_b128 a[16:19], v17 offset:4096
 v_mfma_f32_16x16x32_bf16 v[132:135], a[0:3], v[80:83], v[28:31]
 s_add_u32 m0, s55, s58
 s_add_u32 s56, s56, 16384
 buffer_load_dwordx4 v16, s[8:11], s56 offen lds
 buffer_load_dwordx4 v16, s[8:11], s56 offen offset:1024 lds
 v_mfma_f32_16x16x32_bf16 v[136:139], a[0:3], v[96:99], v[32:35]
 v_mfma_f32_16x16x32_bf16 v[140:143], a[0:3], v[112:115], v[36:39]
 v_mfma_f32_16x16x32_bf16 v[140:143], a[4:7], v[116:119], v[140:143]
 ds_read_b128 a[20:23], v17 offset:5120
 v_mfma_f32_16x16x32_bf16 v[136:139], a[4:7], v[100:103], v[136:139]
 s_add_u32 m0, s49, s59
 s_add_u32 s57, s57, 16384
 buffer_load_dwordx4 v16, s[8:11], s57 offen lds
 buffer_load_dwordx4 v16, s[8:11], s57 offen offset:1024 lds
 v_mfma_f32_16x16x32_bf16 v[132:135], a[4:7], v[84:87], v[132:135]
 v_mfma_f32_16x16x32_bf16 v[128:131], a[4:7], v[68:71], v[128:131]
 s_waitcnt lgkmcnt(2)
 v_mfma_f32_16x16x32_bf16 v[128:131], a[8:11], v[72:75], v[128:131]
 ds_read_b128 a[24:27], v17 offset:6144
 v_mfma_f32_16x16x32_bf16 v[132:135], a[8:11], v[88:91], v[132:135]
 s_mov_b64 exec, 0xffff
 global_load_dword v52, v[48:49], off
 s_mov_b64 exec, -1
 v_lshl_add_u64 v[48:49], v[50:51], 0, v[48:49]
 v_mfma_f32_16x16x32_bf16 v[136:139], a[8:11], v[104:107], v[136:139]
 v_mfma_f32_16x16x32_bf16 v[140:143], a[8:11], v[120:123], v[140:143]
 v_mfma_f32_16x16x32_bf16 v[140:143], a[12:15], v[124:127], v[140:143]
 ds_read_b128 a[28:31], v17 offset:7168
 v_mfma_f32_16x16x32_bf16 v[136:139], a[12:15], v[108:111], v[136:139]
 v_mfma_f32_16x16x32_bf16 v[132:135], a[12:15], v[92:95], v[132:135]
 v_mfma_f32_16x16x32_bf16 v[128:131], a[12:15], v[76:79], v[128:131]
 s_waitcnt vmcnt(11) lgkmcnt(0)
 s_barrier
 v_add_u32 v17, s49, v19
 v_mfma_f32_16x16x32_bf16 v[144:147], a[16:19], v[64:67], v[24:27]
 ds_read_b128 a[0:3], v17 offset:0
 v_mfma_f32_16x16x32_bf16 v[148:151], a[16:19], v[80:83], v[28:31]
 s_add_u32 s52, s55, 32768
 v_add_u32 v18, s52, v19
 v_mfma_f32_16x16x32_bf16 v[152:155], a[16:19], v[96:99], v[32:35]
 s_add_u32 s55, s55, 8192
 v_mfma_f32_16x16x32_bf16 v[156:159], a[16:19], v[112:115], v[36:39]
 v_mfma_f32_16x16x32_bf16 v[156:159], a[20:23], v[116:119], v[156:159]
 ds_read_b128 a[4:7], v17 offset:1024
 v_mfma_f32_16x16x32_bf16 v[152:155], a[20:23], v[100:103], v[152:155]
 s_and_b32 s55, s55, 0x7fff
 v_mfma_f32_16x16x32_bf16 v[148:151], a[20:23], v[84:87], v[148:151]
 s_xor_b32 s49, s55, 16384
 v_mfma_f32_16x16x32_bf16 v[144:147], a[20:23], v[68:71], v[144:147]
 s_waitcnt lgkmcnt(2)
 v_mfma_f32_16x16x32_bf16 v[144:147], a[24:27], v[72:75], v[144:147]
 ds_read_b128 a[8:11], v17 offset:2048
 v_mfma_f32_16x16x32_bf16 v[148:151], a[24:27], v[88:91], v[148:151]
 s_add_u32 s51, s51, 1
 v_mfma_f32_16x16x32_bf16 v[152:155], a[24:27], v[104:107], v[152:155]
 v_mfma_f32_16x16x32_bf16 v[156:159], a[24:27], v[120:123], v[156:159]
 v_mfma_f32_16x16x32_bf16 v[156:159], a[28:31], v[124:127], v[156:159]
 ds_read_b128 a[12:15], v17 offset:3072
 v_mfma_f32_16x16x32_bf16 v[152:155], a[28:31], v[108:111], v[152:155]
 v_mfma_f32_16x16x32_bf16 v[148:151], a[28:31], v[92:95], v[148:151]
 v_mfma_f32_16x16x32_bf16 v[144:147], a[28:31], v[76:79], v[144:147]
 v_max3_f32 v40, v128, v129, v130
 s_nop 6
 v_max3_f32 v40, v40, v131, v144
 v_max3_f32 v40, v40, v145, v146
 v_max_f32 v40, v40, v147
 v_max3_f32 v41, v132, v133, v134
 v_max3_f32 v41, v41, v135, v148
 v_max3_f32 v41, v41, v149, v150
 v_max_f32 v41, v41, v151
 v_max3_f32 v42, v136, v137, v138
 v_max3_f32 v42, v42, v139, v152
 v_max3_f32 v42, v42, v153, v154
 v_max_f32 v42, v42, v155
 v_max3_f32 v43, v140, v141, v142
 v_max3_f32 v43, v43, v143, v156
 v_max3_f32 v43, v43, v157, v158
 v_max_f32 v43, v43, v159
 v_mov_b32 v44, v40
 v_mov_b32 v45, v41
 v_mov_b32 v46, v42
 v_mov_b32 v47, v43
 v_permlane16_swap_b32 v40, v44
 v_permlane16_swap_b32 v41, v45
 v_permlane16_swap_b32 v42, v46
 v_permlane16_swap_b32 v43, v47
 v_max_f32 v40, v40, v44
 v_max_f32 v41, v41, v45
 v_max_f32 v42, v42, v46
 v_max_f32 v43, v43, v47
 v_mov_b32 v44, v40
 v_mov_b32 v45, v41
 v_mov_b32 v46, v42
 v_mov_b32 v47, v43
 v_permlane32_swap_b32 v40, v44
 v_permlane32_swap_b32 v41, v45
 v_permlane32_swap_b32 v42, v46
 v_permlane32_swap_b32 v43, v47
 v_max_f32 v40, v40, v44
 v_max_f32 v41, v41, v45
 v_max_f32 v42, v42, v46
 v_max_f32 v43, v43, v47
 v_sub_f32 v24, 0, v40
 v_sub_f32 v25, 0, v40
 v_sub_f32 v26, 0, v40
 v_sub_f32 v27, 0, v40
 v_sub_f32 v128, v128, v40
 v_sub_f32 v129, v129, v40
 v_sub_f32 v130, v130, v40
 v_sub_f32 v131, v131, v40
 v_sub_f32 v144, v144, v40
 v_sub_f32 v145, v145, v40
 v_sub_f32 v146, v146, v40
 v_sub_f32 v147, v147, v40
 v_sub_f32 v28, 0, v41
 v_sub_f32 v29, 0, v41
 v_sub_f32 v30, 0, v41
 v_sub_f32 v31, 0, v41
 v_sub_f32 v132, v132, v41
 v_sub_f32 v133, v133, v41
 v_sub_f32 v134, v134, v41
 v_sub_f32 v135, v135, v41
 v_sub_f32 v148, v148, v41
 v_sub_f32 v149, v149, v41
 v_sub_f32 v150, v150, v41
 v_sub_f32 v151, v151, v41
 v_sub_f32 v32, 0, v42
 v_sub_f32 v33, 0, v42
 v_sub_f32 v34, 0, v42
 v_sub_f32 v35, 0, v42
 v_sub_f32 v136, v136, v42
 v_sub_f32 v137, v137, v42
 v_sub_f32 v138, v138, v42
 v_sub_f32 v139, v139, v42
 v_sub_f32 v152, v152, v42
 v_sub_f32 v153, v153, v42
 v_sub_f32 v154, v154, v42
 v_sub_f32 v155, v155, v42
 v_sub_f32 v36, 0, v43
 v_sub_f32 v37, 0, v43
 v_sub_f32 v38, 0, v43
 v_sub_f32 v39, 0, v43
 v_sub_f32 v140, v140, v43
 v_sub_f32 v141, v141, v43
 v_sub_f32 v142, v142, v43
 v_sub_f32 v143, v143, v43
 v_sub_f32 v156, v156, v43
 v_sub_f32 v157, v157, v43
 v_sub_f32 v158, v158, v43
 v_sub_f32 v159, v159, v43
 s_waitcnt lgkmcnt(2)
 v_mfma_f32_16x16x32_bf16 v[160:163], a[0:3], v[64:67], v[24:27]
 ds_read_b128 a[16:19], v17 offset:4096
 v_exp_f32 v128, v128
 v_exp_f32 v129, v129
 v_mfma_f32_16x16x32_bf16 v[164:167], a[0:3], v[80:83], v[28:31]
 s_add_u32 m0, s55, s58
 s_add_u32 s56, s56, 16384
 buffer_load_dwordx4 v16, s[8:11], s56 offen lds
 buffer_load_dwordx4 v16, s[8:11], s56 offen offset:1024 lds
 v_add_f32 v20, v20, v128
 v_add_f32 v20, v20, v129
 v_exp_f32 v130, v130
 v_mfma_f32_16x16x32_bf16 v[168:171], a[0:3], v[96:99], v[32:35]
 v_exp_f32 v131, v131
 v_add_f32 v20, v20, v130
 v_add_f32 v20, v20, v131
 v_mfma_f32_16x16x32_bf16 v[172:175], a[0:3], v[112:115], v[36:39]
 v_exp_f32 v144, v144
 v_mfma_f32_16x16x32_bf16 v[172:175], a[4:7], v[116:119], v[172:175]
 ds_read_b128 a[20:23], v17 offset:5120
 v_exp_f32 v145, v145
 v_add_f32 v20, v20, v144
 v_add_f32 v20, v20, v145
 v_mfma_f32_16x16x32_bf16 v[168:171], a[4:7], v[100:103], v[168:171]
 s_add_u32 m0, s49, s59
 s_add_u32 s57, s57, 16384
 buffer_load_dwordx4 v16, s[8:11], s57 offen lds
 buffer_load_dwordx4 v16, s[8:11], s57 offen offset:1024 lds
 v_exp_f32 v146, v146
 v_exp_f32 v147, v147
 v_mfma_f32_16x16x32_bf16 v[164:167], a[4:7], v[84:87], v[164:167]
 v_add_f32 v20, v20, v146
 v_add_f32 v20, v20, v147
 v_cvt_pk_bf16_f32 v192, v128, v129
 v_cvt_pk_bf16_f32 v193, v130, v131
 v_mfma_f32_16x16x32_bf16 v[160:163], a[4:7], v[68:71], v[160:163]
 s_waitcnt lgkmcnt(2)
 v_cvt_pk_bf16_f32 v194, v144, v145
 v_cvt_pk_bf16_f32 v195, v146, v147
 v_mfma_f32_16x16x32_bf16 v[160:163], a[8:11], v[72:75], v[160:163]
 ds_read_b128 a[24:27], v17 offset:6144
 v_exp_f32 v132, v132
 v_exp_f32 v133, v133
 v_mfma_f32_16x16x32_bf16 v[164:167], a[8:11], v[88:91], v[164:167]
 s_mov_b64 exec, 0xffff
 global_load_dword v52, v[48:49], off
 s_mov_b64 exec, -1
 v_lshl_add_u64 v[48:49], v[50:51], 0, v[48:49]
 v_add_f32 v21, v21, v132
 v_add_f32 v21, v21, v133
 v_exp_f32 v134, v134
 v_mfma_f32_16x16x32_bf16 v[168:171], a[8:11], v[104:107], v[168:171]
 v_exp_f32 v135, v135
 v_add_f32 v21, v21, v134
 v_add_f32 v21, v21, v135
 v_mfma_f32_16x16x32_bf16 v[172:175], a[8:11], v[120:123], v[172:175]
 v_exp_f32 v148, v148
 v_mfma_f32_16x16x32_bf16 v[172:175], a[12:15], v[124:127], v[172:175]
 ds_read_b128 a[28:31], v17 offset:7168
 v_exp_f32 v149, v149
 v_add_f32 v21, v21, v148
 v_add_f32 v21, v21, v149
 v_mfma_f32_16x16x32_bf16 v[168:171], a[12:15], v[108:111], v[168:171]
 v_exp_f32 v150, v150
 v_exp_f32 v151, v151
 v_mfma_f32_16x16x32_bf16 v[164:167], a[12:15], v[92:95], v[164:167]
 v_add_f32 v21, v21, v150
 v_add_f32 v21, v21, v151
 v_cvt_pk_bf16_f32 v196, v132, v133
 v_cvt_pk_bf16_f32 v197, v134, v135
 v_mfma_f32_16x16x32_bf16 v[160:163], a[12:15], v[76:79], v[160:163]
 s_waitcnt vmcnt(11) lgkmcnt(0)
 s_barrier
 v_add_u32 v17, s49, v19
 v_cvt_pk_bf16_f32 v198, v148, v149
 v_cvt_pk_bf16_f32 v199, v150, v151
 v_mfma_f32_16x16x32_bf16 v[176:179], a[16:19], v[64:67], v[24:27]
 ds_read_b128 a[0:3], v17 offset:0
 v_exp_f32 v136, v136
 v_exp_f32 v137, v137
 v_mfma_f32_16x16x32_bf16 v[180:183], a[16:19], v[80:83], v[28:31]
 s_add_u32 s52, s55, 32768
 v_add_u32 v18, s52, v19
 v_add_f32 v22, v22, v136
 v_add_f32 v22, v22, v137
 v_exp_f32 v138, v138
 v_mfma_f32_16x16x32_bf16 v[184:187], a[16:19], v[96:99], v[32:35]
 s_add_u32 s55, s55, 8192
 v_exp_f32 v139, v139
 v_add_f32 v22, v22, v138
 v_add_f32 v22, v22, v139
 v_mfma_f32_16x16x32_bf16 v[188:191], a[16:19], v[112:115], v[36:39]
 v_exp_f32 v152, v152
 v_mfma_f32_16x16x32_bf16 v[188:191], a[20:23], v[116:119], v[188:191]
 ds_read_b128 a[4:7], v17 offset:1024
 v_exp_f32 v153, v153
 v_add_f32 v22, v22, v152
 v_add_f32 v22, v22, v153
 v_mfma_f32_16x16x32_bf16 v[184:187], a[20:23], v[100:103], v[184:187]
 s_and_b32 s55, s55, 0x7fff
 v_exp_f32 v154, v154
 v_exp_f32 v155, v155
 v_mfma_f32_16x16x32_bf16 v[180:183], a[20:23], v[84:87], v[180:183]
 s_xor_b32 s49, s55, 16384
 v_add_f32 v22, v22, v154
 v_add_f32 v22, v22, v155
 v_cvt_pk_bf16_f32 v200, v136, v137
 v_cvt_pk_bf16_f32 v201, v138, v139
 v_mfma_f32_16x16x32_bf16 v[176:179], a[20:23], v[68:71], v[176:179]
 s_waitcnt lgkmcnt(2)
 v_cvt_pk_bf16_f32 v202, v152, v153
 v_cvt_pk_bf16_f32 v203, v154, v155
 v_mfma_f32_16x16x32_bf16 v[176:179], a[24:27], v[72:75], v[176:179]
 ds_read_b128 a[8:11], v17 offset:2048
 v_exp_f32 v140, v140
 v_exp_f32 v141, v141
 v_mfma_f32_16x16x32_bf16 v[180:183], a[24:27], v[88:91], v[180:183]
 s_add_u32 s51, s51, 1
 v_add_f32 v23, v23, v140
 v_add_f32 v23, v23, v141
 v_exp_f32 v142, v142
 v_mfma_f32_16x16x32_bf16 v[184:187], a[24:27], v[104:107], v[184:187]
 v_exp_f32 v143, v143
 v_add_f32 v23, v23, v142
 v_add_f32 v23, v23, v143
 v_mfma_f32_16x16x32_bf16 v[188:191], a[24:27], v[120:123], v[188:191]
 v_exp_f32 v156, v156
 v_mfma_f32_16x16x32_bf16 v[188:191], a[28:31], v[124:127], v[188:191]
 ds_read_b128 a[12:15], v17 offset:3072
 v_exp_f32 v157, v157
 v_add_f32 v23, v23, v156
 v_add_f32 v23, v23, v157
 v_mfma_f32_16x16x32_bf16 v[184:187], a[28:31], v[108:111], v[184:187]
 v_exp_f32 v158, v158
 v_exp_f32 v159, v159
 v_mfma_f32_16x16x32_bf16 v[180:183], a[28:31], v[92:95], v[180:183]
 v_add_f32 v23, v23, v158
 v_add_f32 v23, v23, v159
 v_cvt_pk_bf16_f32 v204, v140, v141
 v_cvt_pk_bf16_f32 v205, v142, v143
 v_mfma_f32_16x16x32_bf16 v[176:179], a[28:31], v[76:79], v[176:179]
 v_cvt_pk_bf16_f32 v206, v156, v157
 v_cvt_pk_bf16_f32 v207, v158, v159
main_kernel_att:
 s_waitcnt lgkmcnt(2)
 v_mfma_f32_16x16x32_bf16 v[128:131], a[0:3], v[64:67], v[24:27]
 ds_read_b128 a[16:19], v17 offset:4096
 v_exp_f32 v160, v160
 v_mfma_f32_16x16x32_bf16 v[132:135], a[0:3], v[80:83], v[28:31]
 s_add_u32 m0, s55, s58
 v_exp_f32 v161, v161
 v_mfma_f32_16x16x32_bf16 v[136:139], a[0:3], v[96:99], v[32:35]
 s_add_u32 s56, s56, 16384
 v_add_f32 v20, v20, v160
 v_add_f32 v20, v20, v161
 v_mfma_f32_16x16x32_bf16 v[140:143], a[0:3], v[112:115], v[36:39]
 v_exp_f32 v162, v162
 v_mfma_f32_16x16x32_bf16 v[140:143], a[4:7], v[116:119], v[140:143]
 ds_read_b128 a[20:23], v17 offset:5120
 v_exp_f32 v163, v163
 v_mfma_f32_16x16x32_bf16 v[136:139], a[4:7], v[100:103], v[136:139]
 buffer_load_dwordx4 v16, s[8:11], s56 offen lds
 v_mfma_f32_16x16x32_bf16 v[132:135], a[4:7], v[84:87], v[132:135]
 buffer_load_dwordx4 v16, s[8:11], s56 offen offset:1024 lds
 v_mfma_f32_16x16x32_bf16 v[128:131], a[4:7], v[68:71], v[128:131]
 s_waitcnt lgkmcnt(2)
 v_add_f32 v20, v20, v162
 v_add_f32 v20, v20, v163
 v_mfma_f32_16x16x32_bf16 v[128:131], a[8:11], v[72:75], v[128:131]
 ds_read_b128 a[24:27], v17 offset:6144
 v_exp_f32 v176, v176
 v_mfma_f32_16x16x32_bf16 v[132:135], a[8:11], v[88:91], v[132:135]
 v_exp_f32 v177, v177
 v_mfma_f32_16x16x32_bf16 v[136:139], a[8:11], v[104:107], v[136:139]
 v_add_f32 v20, v20, v176
 v_add_f32 v20, v20, v177
 v_mfma_f32_16x16x32_bf16 v[140:143], a[8:11], v[120:123], v[140:143]
 v_exp_f32 v178, v178
 v_mfma_f32_16x16x32_bf16 v[140:143], a[12:15], v[124:127], v[140:143]
 ds_read_b128 a[28:31], v17 offset:7168
 v_exp_f32 v179, v179
 v_mfma_f32_16x16x32_bf16 v[136:139], a[12:15], v[108:111], v[136:139]
 v_add_f32 v20, v20, v178
 v_add_f32 v20, v20, v179
 v_mfma_f32_16x16x32_bf16 v[132:135], a[12:15], v[92:95], v[132:135]
 v_cvt_pk_bf16_f32 v208, v160, v161
 v_cvt_pk_bf16_f32 v209, v162, v163
 v_mfma_f32_16x16x32_bf16 v[128:131], a[12:15], v[76:79], v[128:131]
 s_waitcnt lgkmcnt(2)
 v_cvt_pk_bf16_f32 v210, v176, v177
 v_cvt_pk_bf16_f32 v211, v178, v179
 v_mfma_f32_16x16x32_bf16 v[144:147], a[16:19], v[64:67], v[24:27]
 ds_read_b128 a[0:3], v18 offset:0
 v_exp_f32 v164, v164
 v_mfma_f32_16x16x32_bf16 v[148:151], a[16:19], v[80:83], v[28:31]
 s_add_u32 m0, s49, s59
 v_exp_f32 v165, v165
 v_mfma_f32_16x16x32_bf16 v[152:155], a[16:19], v[96:99], v[32:35]
 s_add_u32 s57, s57, 16384
 v_add_f32 v21, v21, v164
 v_add_f32 v21, v21, v165
 v_mfma_f32_16x16x32_bf16 v[156:159], a[16:19], v[112:115], v[36:39]
 v_exp_f32 v166, v166
 v_mfma_f32_16x16x32_bf16 v[156:159], a[20:23], v[116:119], v[156:159]
 ds_read_b128 a[4:7], v18 offset:1024
 v_exp_f32 v167, v167
 v_mfma_f32_16x16x32_bf16 v[152:155], a[20:23], v[100:103], v[152:155]
 buffer_load_dwordx4 v16, s[8:11], s57 offen lds
 v_mfma_f32_16x16x32_bf16 v[148:151], a[20:23], v[84:87], v[148:151]
 buffer_load_dwordx4 v16, s[8:11], s57 offen offset:1024 lds
 v_mfma_f32_16x16x32_bf16 v[144:147], a[20:23], v[68:71], v[144:147]
 s_waitcnt lgkmcnt(2)
 v_add_f32 v21, v21, v166
 v_add_f32 v21, v21, v167
 v_mfma_f32_16x16x32_bf16 v[144:147], a[24:27], v[72:75], v[144:147]
 ds_read_b128 a[8:11], v18 offset:2048
 v_exp_f32 v180, v180
 v_mfma_f32_16x16x32_bf16 v[148:151], a[24:27], v[88:91], v[148:151]
 v_exp_f32 v181, v181
 v_mfma_f32_16x16x32_bf16 v[152:155], a[24:27], v[104:107], v[152:155]
 v_add_f32 v21, v21, v180
 v_add_f32 v21, v21, v181
 v_mfma_f32_16x16x32_bf16 v[156:159], a[24:27], v[120:123], v[156:159]
 v_exp_f32 v182, v182
 v_mfma_f32_16x16x32_bf16 v[156:159], a[28:31], v[124:127], v[156:159]
 ds_read_b128 a[12:15], v18 offset:3072
 v_exp_f32 v183, v183
 v_mfma_f32_16x16x32_bf16 v[152:155], a[28:31], v[108:111], v[152:155]
 v_add_f32 v21, v21, v182
 v_add_f32 v21, v21, v183
 v_mfma_f32_16x16x32_bf16 v[148:151], a[28:31], v[92:95], v[148:151]
 v_cvt_pk_bf16_f32 v212, v164, v165
 v_cvt_pk_bf16_f32 v213, v166, v167
 v_mfma_f32_16x16x32_bf16 v[144:147], a[28:31], v[76:79], v[144:147]
 s_waitcnt lgkmcnt(2)
 v_cvt_pk_bf16_f32 v214, v180, v181
 v_cvt_pk_bf16_f32 v215, v182, v183
 v_mfma_f32_16x16x32_bf16 a[128:131], a[0:3], v[192:195], a[128:131]
 ds_read_b128 a[16:19], v18 offset:4096
 v_exp_f32 v168, v168
 v_mfma_f32_16x16x32_bf16 a[132:135], a[0:3], v[196:199], a[132:135]
 s_mov_b64 exec, 0xffff
 global_load_dword v52, v[48:49], off
 s_mov_b64 exec, -1
 v_lshl_add_u64 v[48:49], v[50:51], 0, v[48:49]
 v_mfma_f32_16x16x32_bf16 a[136:139], a[0:3], v[200:203], a[136:139]
 v_exp_f32 v169, v169
 v_mfma_f32_16x16x32_bf16 a[140:143], a[0:3], v[204:207], a[140:143]
 v_add_f32 v22, v22, v168
 v_add_f32 v22, v22, v169
 v_mfma_f32_16x16x32_bf16 a[156:159], a[4:7], v[204:207], a[156:159]
 ds_read_b128 a[20:23], v18 offset:5120
 v_exp_f32 v170, v170
 v_mfma_f32_16x16x32_bf16 a[152:155], a[4:7], v[200:203], a[152:155]
 v_exp_f32 v171, v171
 v_mfma_f32_16x16x32_bf16 a[148:151], a[4:7], v[196:199], a[148:151]
 v_add_f32 v22, v22, v170
 v_add_f32 v22, v22, v171
 v_mfma_f32_16x16x32_bf16 a[144:147], a[4:7], v[192:195], a[144:147]
 s_waitcnt lgkmcnt(2)
 v_exp_f32 v184, v184
 v_mfma_f32_16x16x32_bf16 a[160:163], a[8:11], v[192:195], a[160:163]
 ds_read_b128 a[24:27], v18 offset:6144
 v_exp_f32 v185, v185
 v_mfma_f32_16x16x32_bf16 a[164:167], a[8:11], v[196:199], a[164:167]
 v_add_f32 v22, v22, v184
 v_add_f32 v22, v22, v185
 v_mfma_f32_16x16x32_bf16 a[168:171], a[8:11], v[200:203], a[168:171]
 v_exp_f32 v186, v186
 v_mfma_f32_16x16x32_bf16 a[172:175], a[8:11], v[204:207], a[172:175]
 v_exp_f32 v187, v187
 v_mfma_f32_16x16x32_bf16 a[188:191], a[12:15], v[204:207], a[188:191]
 ds_read_b128 a[28:31], v18 offset:7168
 v_add_f32 v22, v22, v186
 v_add_f32 v22, v22, v187
 v_mfma_f32_16x16x32_bf16 a[184:187], a[12:15], v[200:203], a[184:187]
 v_cvt_pk_bf16_f32 v216, v168, v169
 v_cvt_pk_bf16_f32 v217, v170, v171
 v_mfma_f32_16x16x32_bf16 a[180:183], a[12:15], v[196:199], a[180:183]
 v_cvt_pk_bf16_f32 v218, v184, v185
 v_cvt_pk_bf16_f32 v219, v186, v187
 v_mfma_f32_16x16x32_bf16 a[176:179], a[12:15], v[192:195], a[176:179]
 s_waitcnt vmcnt(11) lgkmcnt(0)
 s_barrier
 v_add_u32 v17, s49, v19
 v_mfma_f32_16x16x32_bf16 a[192:195], a[16:19], v[192:195], a[192:195]
 ds_read_b128 a[0:3], v17 offset:0
 v_exp_f32 v172, v172
 v_mfma_f32_16x16x32_bf16 a[196:199], a[16:19], v[196:199], a[196:199]
 s_add_u32 s52, s55, 32768
 v_add_u32 v18, s52, v19
 v_mfma_f32_16x16x32_bf16 a[200:203], a[16:19], v[200:203], a[200:203]
 s_add_u32 s55, s55, 8192
 v_exp_f32 v173, v173
 v_mfma_f32_16x16x32_bf16 a[204:207], a[16:19], v[204:207], a[204:207]
 v_add_f32 v23, v23, v172
 v_add_f32 v23, v23, v173
 v_mfma_f32_16x16x32_bf16 a[220:223], a[20:23], v[204:207], a[220:223]
 ds_read_b128 a[4:7], v17 offset:1024
 v_exp_f32 v174, v174
 v_mfma_f32_16x16x32_bf16 a[216:219], a[20:23], v[200:203], a[216:219]
 s_and_b32 s55, s55, 0x7fff
 v_exp_f32 v175, v175
 v_mfma_f32_16x16x32_bf16 a[212:215], a[20:23], v[196:199], a[212:215]
 s_xor_b32 s49, s55, 16384
 v_add_f32 v23, v23, v174
 v_add_f32 v23, v23, v175
 v_mfma_f32_16x16x32_bf16 a[208:211], a[20:23], v[192:195], a[208:211]
 s_waitcnt lgkmcnt(2)
 v_exp_f32 v188, v188
 v_mfma_f32_16x16x32_bf16 a[224:227], a[24:27], v[192:195], a[224:227]
 ds_read_b128 a[8:11], v17 offset:2048
 v_exp_f32 v189, v189
 v_mfma_f32_16x16x32_bf16 a[228:231], a[24:27], v[196:199], a[228:231]
 s_add_u32 s51, s51, 1
 v_add_f32 v23, v23, v188
 v_add_f32 v23, v23, v189
 v_mfma_f32_16x16x32_bf16 a[232:235], a[24:27], v[200:203], a[232:235]
 v_exp_f32 v190, v190
 v_mfma_f32_16x16x32_bf16 a[236:239], a[24:27], v[204:207], a[236:239]
 v_exp_f32 v191, v191
 v_mfma_f32_16x16x32_bf16 a[252:255], a[28:31], v[204:207], a[252:255]
 ds_read_b128 a[12:15], v17 offset:3072
 v_add_f32 v23, v23, v190
 v_add_f32 v23, v23, v191
 v_mfma_f32_16x16x32_bf16 a[248:251], a[28:31], v[200:203], a[248:251]
 v_cvt_pk_bf16_f32 v220, v172, v173
 v_cvt_pk_bf16_f32 v221, v174, v175
 v_mfma_f32_16x16x32_bf16 a[244:247], a[28:31], v[196:199], a[244:247]
 v_cvt_pk_bf16_f32 v222, v188, v189
 v_cvt_pk_bf16_f32 v223, v190, v191
 v_mfma_f32_16x16x32_bf16 a[240:243], a[28:31], v[192:195], a[240:243]
 s_waitcnt lgkmcnt(2)
 v_mfma_f32_16x16x32_bf16 v[160:163], a[0:3], v[64:67], v[24:27]
 ds_read_b128 a[16:19], v17 offset:4096
 v_exp_f32 v128, v128
 v_mfma_f32_16x16x32_bf16 v[164:167], a[0:3], v[80:83], v[28:31]
 s_add_u32 m0, s55, s58
 v_exp_f32 v129, v129
 v_mfma_f32_16x16x32_bf16 v[168:171], a[0:3], v[96:99], v[32:35]
 s_add_u32 s56, s56, 16384
 v_add_f32 v20, v20, v128
 v_add_f32 v20, v20, v129
 v_mfma_f32_16x16x32_bf16 v[172:175], a[0:3], v[112:115], v[36:39]
 v_exp_f32 v130, v130
 v_mfma_f32_16x16x32_bf16 v[172:175], a[4:7], v[116:119], v[172:175]
 ds_read_b128 a[20:23], v17 offset:5120
 v_exp_f32 v131, v131
 v_mfma_f32_16x16x32_bf16 v[168:171], a[4:7], v[100:103], v[168:171]
 buffer_load_dwordx4 v16, s[8:11], s56 offen lds
 v_mfma_f32_16x16x32_bf16 v[164:167], a[4:7], v[84:87], v[164:167]
 buffer_load_dwordx4 v16, s[8:11], s56 offen offset:1024 lds
 v_mfma_f32_16x16x32_bf16 v[160:163], a[4:7], v[68:71], v[160:163]
 s_waitcnt lgkmcnt(2)
 v_add_f32 v20, v20, v130
 v_add_f32 v20, v20, v131
 v_mfma_f32_16x16x32_bf16 v[160:163], a[8:11], v[72:75], v[160:163]
 ds_read_b128 a[24:27], v17 offset:6144
 v_exp_f32 v144, v144
 v_mfma_f32_16x16x32_bf16 v[164:167], a[8:11], v[88:91], v[164:167]
 v_exp_f32 v145, v145
 v_mfma_f32_16x16x32_bf16 v[168:171], a[8:11], v[104:107], v[168:171]
 v_add_f32 v20, v20, v144
 v_add_f32 v20, v20, v145
 v_mfma_f32_16x16x32_bf16 v[172:175], a[8:11], v[120:123], v[172:175]
 v_exp_f32 v146, v146
 v_mfma_f32_16x16x32_bf16 v[172:175], a[12:15], v[124:127], v[172:175]
 ds_read_b128 a[28:31], v17 offset:7168
 v_exp_f32 v147, v147
 v_mfma_f32_16x16x32_bf16 v[168:171], a[12:15], v[108:111], v[168:171]
 v_add_f32 v20, v20, v146
 v_add_f32 v20, v20, v147
 v_mfma_f32_16x16x32_bf16 v[164:167], a[12:15], v[92:95], v[164:167]
 v_cvt_pk_bf16_f32 v192, v128, v129
 v_cvt_pk_bf16_f32 v193, v130, v131
 v_mfma_f32_16x16x32_bf16 v[160:163], a[12:15], v[76:79], v[160:163]
 s_waitcnt lgkmcnt(2)
 v_cvt_pk_bf16_f32 v194, v144, v145
 v_cvt_pk_bf16_f32 v195, v146, v147
 v_mfma_f32_16x16x32_bf16 v[176:179], a[16:19], v[64:67], v[24:27]
 ds_read_b128 a[0:3], v18 offset:0
 v_exp_f32 v132, v132
 v_mfma_f32_16x16x32_bf16 v[180:183], a[16:19], v[80:83], v[28:31]
 s_add_u32 m0, s49, s59
 v_exp_f32 v133, v133
 v_mfma_f32_16x16x32_bf16 v[184:187], a[16:19], v[96:99], v[32:35]
 s_add_u32 s57, s57, 16384
 v_add_f32 v21, v21, v132
 v_add_f32 v21, v21, v133
 v_mfma_f32_16x16x32_bf16 v[188:191], a[16:19], v[112:115], v[36:39]
 v_exp_f32 v134, v134
 v_mfma_f32_16x16x32_bf16 v[188:191], a[20:23], v[116:119], v[188:191]
 ds_read_b128 a[4:7], v18 offset:1024
 v_exp_f32 v135, v135
 v_mfma_f32_16x16x32_bf16 v[184:187], a[20:23], v[100:103], v[184:187]
 buffer_load_dwordx4 v16, s[8:11], s57 offen lds
 v_mfma_f32_16x16x32_bf16 v[180:183], a[20:23], v[84:87], v[180:183]
 buffer_load_dwordx4 v16, s[8:11], s57 offen offset:1024 lds
 v_mfma_f32_16x16x32_bf16 v[176:179], a[20:23], v[68:71], v[176:179]
 s_waitcnt lgkmcnt(2)
 v_add_f32 v21, v21, v134
 v_add_f32 v21, v21, v135
 v_mfma_f32_16x16x32_bf16 v[176:179], a[24:27], v[72:75], v[176:179]
 ds_read_b128 a[8:11], v18 offset:2048
 v_exp_f32 v148, v148
 v_mfma_f32_16x16x32_bf16 v[180:183], a[24:27], v[88:91], v[180:183]
 v_exp_f32 v149, v149
 v_mfma_f32_16x16x32_bf16 v[184:187], a[24:27], v[104:107], v[184:187]
 v_add_f32 v21, v21, v148
 v_add_f32 v21, v21, v149
 v_mfma_f32_16x16x32_bf16 v[188:191], a[24:27], v[120:123], v[188:191]
 v_exp_f32 v150, v150
 v_mfma_f32_16x16x32_bf16 v[188:191], a[28:31], v[124:127], v[188:191]
 ds_read_b128 a[12:15], v18 offset:3072
 v_exp_f32 v151, v151
 v_mfma_f32_16x16x32_bf16 v[184:187], a[28:31], v[108:111], v[184:187]
 v_add_f32 v21, v21, v150
 v_add_f32 v21, v21, v151
 v_mfma_f32_16x16x32_bf16 v[180:183], a[28:31], v[92:95], v[180:183]
 v_cvt_pk_bf16_f32 v196, v132, v133
 v_cvt_pk_bf16_f32 v197, v134, v135
 v_mfma_f32_16x16x32_bf16 v[176:179], a[28:31], v[76:79], v[176:179]
 s_waitcnt lgkmcnt(2)
 v_cvt_pk_bf16_f32 v198, v148, v149
 v_cvt_pk_bf16_f32 v199, v150, v151
 v_mfma_f32_16x16x32_bf16 a[128:131], a[0:3], v[208:211], a[128:131]
 ds_read_b128 a[16:19], v18 offset:4096
 v_exp_f32 v136, v136
 v_mfma_f32_16x16x32_bf16 a[132:135], a[0:3], v[212:215], a[132:135]
 s_mov_b64 exec, 0xffff
 global_load_dword v52, v[48:49], off
 s_mov_b64 exec, -1
 v_lshl_add_u64 v[48:49], v[50:51], 0, v[48:49]
 v_mfma_f32_16x16x32_bf16 a[136:139], a[0:3], v[216:219], a[136:139]
 v_exp_f32 v137, v137
 v_mfma_f32_16x16x32_bf16 a[140:143], a[0:3], v[220:223], a[140:143]
 v_add_f32 v22, v22, v136
 v_add_f32 v22, v22, v137
 v_mfma_f32_16x16x32_bf16 a[156:159], a[4:7], v[220:223], a[156:159]
 ds_read_b128 a[20:23], v18 offset:5120
 v_exp_f32 v138, v138
 v_mfma_f32_16x16x32_bf16 a[152:155], a[4:7], v[216:219], a[152:155]
 v_exp_f32 v139, v139
 v_mfma_f32_16x16x32_bf16 a[148:151], a[4:7], v[212:215], a[148:151]
 v_add_f32 v22, v22, v138
 v_add_f32 v22, v22, v139
 v_mfma_f32_16x16x32_bf16 a[144:147], a[4:7], v[208:211], a[144:147]
 s_waitcnt lgkmcnt(2)
 v_exp_f32 v152, v152
 v_mfma_f32_16x16x32_bf16 a[160:163], a[8:11], v[208:211], a[160:163]
 ds_read_b128 a[24:27], v18 offset:6144
 v_exp_f32 v153, v153
 v_mfma_f32_16x16x32_bf16 a[164:167], a[8:11], v[212:215], a[164:167]
 v_add_f32 v22, v22, v152
 v_add_f32 v22, v22, v153
 v_mfma_f32_16x16x32_bf16 a[168:171], a[8:11], v[216:219], a[168:171]
 v_exp_f32 v154, v154
 v_mfma_f32_16x16x32_bf16 a[172:175], a[8:11], v[220:223], a[172:175]
 v_exp_f32 v155, v155
 v_mfma_f32_16x16x32_bf16 a[188:191], a[12:15], v[220:223], a[188:191]
 ds_read_b128 a[28:31], v18 offset:7168
 v_add_f32 v22, v22, v154
 v_add_f32 v22, v22, v155
 v_mfma_f32_16x16x32_bf16 a[184:187], a[12:15], v[216:219], a[184:187]
 v_cvt_pk_bf16_f32 v200, v136, v137
 v_cvt_pk_bf16_f32 v201, v138, v139
 v_mfma_f32_16x16x32_bf16 a[180:183], a[12:15], v[212:215], a[180:183]
 v_cvt_pk_bf16_f32 v202, v152, v153
 v_cvt_pk_bf16_f32 v203, v154, v155
 v_mfma_f32_16x16x32_bf16 a[176:179], a[12:15], v[208:211], a[176:179]
 s_waitcnt vmcnt(11) lgkmcnt(0)
 s_barrier
 v_add_u32 v17, s49, v19
 v_mfma_f32_16x16x32_bf16 a[192:195], a[16:19], v[208:211], a[192:195]
 ds_read_b128 a[0:3], v17 offset:0
 v_exp_f32 v140, v140
 v_mfma_f32_16x16x32_bf16 a[196:199], a[16:19], v[212:215], a[196:199]
 s_add_u32 s52, s55, 32768
 v_add_u32 v18, s52, v19
 v_mfma_f32_16x16x32_bf16 a[200:203], a[16:19], v[216:219], a[200:203]
 s_add_u32 s55, s55, 8192
 v_exp_f32 v141, v141
 v_mfma_f32_16x16x32_bf16 a[204:207], a[16:19], v[220:223], a[204:207]
 v_add_f32 v23, v23, v140
 v_add_f32 v23, v23, v141
 v_mfma_f32_16x16x32_bf16 a[220:223], a[20:23], v[220:223], a[220:223]
 ds_read_b128 a[4:7], v17 offset:1024
 v_exp_f32 v142, v142
 v_mfma_f32_16x16x32_bf16 a[216:219], a[20:23], v[216:219], a[216:219]
 s_and_b32 s55, s55, 0x7fff
 v_exp_f32 v143, v143
 v_mfma_f32_16x16x32_bf16 a[212:215], a[20:23], v[212:215], a[212:215]
 s_xor_b32 s49, s55, 16384
 v_add_f32 v23, v23, v142
 v_add_f32 v23, v23, v143
 v_mfma_f32_16x16x32_bf16 a[208:211], a[20:23], v[208:211], a[208:211]
 s_waitcnt lgkmcnt(2)
 v_exp_f32 v156, v156
 v_mfma_f32_16x16x32_bf16 a[224:227], a[24:27], v[208:211], a[224:227]
 ds_read_b128 a[8:11], v17 offset:2048
 v_exp_f32 v157, v157
 v_mfma_f32_16x16x32_bf16 a[228:231], a[24:27], v[212:215], a[228:231]
 s_add_u32 s51, s51, 1
 v_add_f32 v23, v23, v156
 v_add_f32 v23, v23, v157
 v_mfma_f32_16x16x32_bf16 a[232:235], a[24:27], v[216:219], a[232:235]
 v_exp_f32 v158, v158
 v_mfma_f32_16x16x32_bf16 a[236:239], a[24:27], v[220:223], a[236:239]
 v_exp_f32 v159, v159
 v_mfma_f32_16x16x32_bf16 a[252:255], a[28:31], v[220:223], a[252:255]
 ds_read_b128 a[12:15], v17 offset:3072
 v_add_f32 v23, v23, v158
 v_add_f32 v23, v23, v159
 v_mfma_f32_16x16x32_bf16 a[248:251], a[28:31], v[216:219], a[248:251]
 v_cvt_pk_bf16_f32 v204, v140, v141
 v_cvt_pk_bf16_f32 v205, v142, v143
 v_mfma_f32_16x16x32_bf16 a[244:247], a[28:31], v[212:215], a[244:247]
 v_cvt_pk_bf16_f32 v206, v156, v157
 v_cvt_pk_bf16_f32 v207, v158, v159
 v_mfma_f32_16x16x32_bf16 a[240:243], a[28:31], v[208:211], a[240:243]
 s_cmp_lt_u32 s51, 15
 s_cbranch_scc1 main_kernel_att
 s_waitcnt lgkmcnt(0)
 ds_read_b128 a[0:3], v18 offset:0
 ds_read_b128 a[4:7], v18 offset:1024
 ds_read_b128 a[8:11], v18 offset:2048
 ds_read_b128 a[12:15], v18 offset:3072
 s_waitcnt lgkmcnt(2)
 v_mfma_f32_16x16x32_bf16 a[128:131], a[0:3], v[192:195], a[128:131]
 ds_read_b128 a[16:19], v18 offset:4096
 v_exp_f32 v160, v160
 v_exp_f32 v161, v161
 v_mfma_f32_16x16x32_bf16 a[132:135], a[0:3], v[196:199], a[132:135]
 v_add_f32 v20, v20, v160
 v_add_f32 v20, v20, v161
 v_exp_f32 v162, v162
 v_mfma_f32_16x16x32_bf16 a[136:139], a[0:3], v[200:203], a[136:139]
 v_exp_f32 v163, v163
 v_add_f32 v20, v20, v162
 v_add_f32 v20, v20, v163
 v_mfma_f32_16x16x32_bf16 a[140:143], a[0:3], v[204:207], a[140:143]
 v_exp_f32 v176, v176
 v_mfma_f32_16x16x32_bf16 a[156:159], a[4:7], v[204:207], a[156:159]
 ds_read_b128 a[20:23], v18 offset:5120
 v_exp_f32 v177, v177
 v_add_f32 v20, v20, v176
 v_add_f32 v20, v20, v177
 v_mfma_f32_16x16x32_bf16 a[152:155], a[4:7], v[200:203], a[152:155]
 v_exp_f32 v178, v178
 v_exp_f32 v179, v179
 v_mfma_f32_16x16x32_bf16 a[148:151], a[4:7], v[196:199], a[148:151]
 v_add_f32 v20, v20, v178
 v_add_f32 v20, v20, v179
 v_cvt_pk_bf16_f32 v208, v160, v161
 v_cvt_pk_bf16_f32 v209, v162, v163
 v_mfma_f32_16x16x32_bf16 a[144:147], a[4:7], v[192:195], a[144:147]
 s_waitcnt lgkmcnt(2)
 v_cvt_pk_bf16_f32 v210, v176, v177
 v_cvt_pk_bf16_f32 v211, v178, v179
 v_mfma_f32_16x16x32_bf16 a[160:163], a[8:11], v[192:195], a[160:163]
 ds_read_b128 a[24:27], v18 offset:6144
 v_exp_f32 v164, v164
 v_exp_f32 v165, v165
 v_mfma_f32_16x16x32_bf16 a[164:167], a[8:11], v[196:199], a[164:167]
 v_add_f32 v21, v21, v164
 v_add_f32 v21, v21, v165
 v_exp_f32 v166, v166
 v_mfma_f32_16x16x32_bf16 a[168:171], a[8:11], v[200:203], a[168:171]
 v_exp_f32 v167, v167
 v_add_f32 v21, v21, v166
 v_add_f32 v21, v21, v167
 v_mfma_f32_16x16x32_bf16 a[172:175], a[8:11], v[204:207], a[172:175]
 v_exp_f32 v180, v180
 v_mfma_f32_16x16x32_bf16 a[188:191], a[12:15], v[204:207], a[188:191]
 ds_read_b128 a[28:31], v18 offset:7168
 v_exp_f32 v181, v181
 v_add_f32 v21, v21, v180
 v_add_f32 v21, v21, v181
 v_mfma_f32_16x16x32_bf16 a[184:187], a[12:15], v[200:203], a[184:187]
 v_exp_f32 v182, v182
 v_exp_f32 v183, v183
 v_mfma_f32_16x16x32_bf16 a[180:183], a[12:15], v[196:199], a[180:183]
 v_add_f32 v21, v21, v182
 v_add_f32 v21, v21, v183
 v_cvt_pk_bf16_f32 v212, v164, v165
 v_cvt_pk_bf16_f32 v213, v166, v167
 v_mfma_f32_16x16x32_bf16 a[176:179], a[12:15], v[192:195], a[176:179]
 s_waitcnt lgkmcnt(2)
 v_cvt_pk_bf16_f32 v214, v180, v181
 v_cvt_pk_bf16_f32 v215, v182, v183
 v_mfma_f32_16x16x32_bf16 a[192:195], a[16:19], v[192:195], a[192:195]
 v_exp_f32 v168, v168
 v_exp_f32 v169, v169
 v_mfma_f32_16x16x32_bf16 a[196:199], a[16:19], v[196:199], a[196:199]
 v_add_f32 v22, v22, v168
 v_add_f32 v22, v22, v169
 v_exp_f32 v170, v170
 v_mfma_f32_16x16x32_bf16 a[200:203], a[16:19], v[200:203], a[200:203]
 v_exp_f32 v171, v171
 v_add_f32 v22, v22, v170
 v_add_f32 v22, v22, v171
 v_mfma_f32_16x16x32_bf16 a[204:207], a[16:19], v[204:207], a[204:207]
 v_exp_f32 v184, v184
 v_mfma_f32_16x16x32_bf16 a[220:223], a[20:23], v[204:207], a[220:223]
 v_exp_f32 v185, v185
 v_add_f32 v22, v22, v184
 v_add_f32 v22, v22, v185
 v_mfma_f32_16x16x32_bf16 a[216:219], a[20:23], v[200:203], a[216:219]
 v_exp_f32 v186, v186
 v_exp_f32 v187, v187
 v_mfma_f32_16x16x32_bf16 a[212:215], a[20:23], v[196:199], a[212:215]
 v_add_f32 v22, v22, v186
 v_add_f32 v22, v22, v187
 v_cvt_pk_bf16_f32 v216, v168, v169
 v_cvt_pk_bf16_f32 v217, v170, v171
 v_mfma_f32_16x16x32_bf16 a[208:211], a[20:23], v[192:195], a[208:211]
 s_waitcnt lgkmcnt(0)
 v_cvt_pk_bf16_f32 v218, v184, v185
 v_cvt_pk_bf16_f32 v219, v186, v187
 v_mfma_f32_16x16x32_bf16 a[224:227], a[24:27], v[192:195], a[224:227]
 v_exp_f32 v172, v172
 v_exp_f32 v173, v173
 v_mfma_f32_16x16x32_bf16 a[228:231], a[24:27], v[196:199], a[228:231]
 v_add_f32 v23, v23, v172
 v_add_f32 v23, v23, v173
 v_exp_f32 v174, v174
 v_mfma_f32_16x16x32_bf16 a[232:235], a[24:27], v[200:203], a[232:235]
 v_exp_f32 v175, v175
 v_add_f32 v23, v23, v174
 v_add_f32 v23, v23, v175
 v_mfma_f32_16x16x32_bf16 a[236:239], a[24:27], v[204:207], a[236:239]
 v_exp_f32 v188, v188
 v_mfma_f32_16x16x32_bf16 a[252:255], a[28:31], v[204:207], a[252:255]
 v_exp_f32 v189, v189
 v_add_f32 v23, v23, v188
 v_add_f32 v23, v23, v189
 v_mfma_f32_16x16x32_bf16 a[248:251], a[28:31], v[200:203], a[248:251]
 v_exp_f32 v190, v190
 v_exp_f32 v191, v191
 v_mfma_f32_16x16x32_bf16 a[244:247], a[28:31], v[196:199], a[244:247]
 v_add_f32 v23, v23, v190
 v_add_f32 v23, v23, v191
 v_cvt_pk_bf16_f32 v220, v172, v173
 v_cvt_pk_bf16_f32 v221, v174, v175
 v_mfma_f32_16x16x32_bf16 a[240:243], a[28:31], v[192:195], a[240:243]
 v_cvt_pk_bf16_f32 v222, v188, v189
 v_cvt_pk_bf16_f32 v223, v190, v191
 s_waitcnt vmcnt(6)
 s_barrier
 v_add_u32 v18, 122880, v16
 ds_read_b128 a[0:3], v18 offset:0
 ds_read_b128 a[4:7], v18 offset:1024
 ds_read_b128 a[8:11], v18 offset:2048
 ds_read_b128 a[12:15], v18 offset:3072
 s_waitcnt lgkmcnt(2)
 v_mfma_f32_16x16x32_bf16 a[128:131], a[0:3], v[208:211], a[128:131]
 ds_read_b128 a[16:19], v18 offset:4096
 v_mfma_f32_16x16x32_bf16 a[132:135], a[0:3], v[212:215], a[132:135]
 v_mfma_f32_16x16x32_bf16 a[136:139], a[0:3], v[216:219], a[136:139]
 v_mfma_f32_16x16x32_bf16 a[140:143], a[0:3], v[220:223], a[140:143]
 v_mfma_f32_16x16x32_bf16 a[156:159], a[4:7], v[220:223], a[156:159]
 ds_read_b128 a[20:23], v18 offset:5120
 v_mfma_f32_16x16x32_bf16 a[152:155], a[4:7], v[216:219], a[152:155]
 v_mfma_f32_16x16x32_bf16 a[148:151], a[4:7], v[212:215], a[148:151]
 v_mfma_f32_16x16x32_bf16 a[144:147], a[4:7], v[208:211], a[144:147]
 s_waitcnt lgkmcnt(2)
 v_mfma_f32_16x16x32_bf16 a[160:163], a[8:11], v[208:211], a[160:163]
 ds_read_b128 a[24:27], v18 offset:6144
 v_mfma_f32_16x16x32_bf16 a[164:167], a[8:11], v[212:215], a[164:167]
 v_mfma_f32_16x16x32_bf16 a[168:171], a[8:11], v[216:219], a[168:171]
 v_mfma_f32_16x16x32_bf16 a[172:175], a[8:11], v[220:223], a[172:175]
 v_mfma_f32_16x16x32_bf16 a[188:191], a[12:15], v[220:223], a[188:191]
 ds_read_b128 a[28:31], v18 offset:7168
 v_mfma_f32_16x16x32_bf16 a[184:187], a[12:15], v[216:219], a[184:187]
 v_mfma_f32_16x16x32_bf16 a[180:183], a[12:15], v[212:215], a[180:183]
 v_mfma_f32_16x16x32_bf16 a[176:179], a[12:15], v[208:211], a[176:179]
 s_waitcnt lgkmcnt(2)
 v_mfma_f32_16x16x32_bf16 a[192:195], a[16:19], v[208:211], a[192:195]
 v_mfma_f32_16x16x32_bf16 a[196:199], a[16:19], v[212:215], a[196:199]
 v_mfma_f32_16x16x32_bf16 a[200:203], a[16:19], v[216:219], a[200:203]
 v_mfma_f32_16x16x32_bf16 a[204:207], a[16:19], v[220:223], a[204:207]
 v_mfma_f32_16x16x32_bf16 a[220:223], a[20:23], v[220:223], a[220:223]
 v_mfma_f32_16x16x32_bf16 a[216:219], a[20:23], v[216:219], a[216:219]
 v_mfma_f32_16x16x32_bf16 a[212:215], a[20:23], v[212:215], a[212:215]
 v_mfma_f32_16x16x32_bf16 a[208:211], a[20:23], v[208:211], a[208:211]
 s_waitcnt lgkmcnt(0)
 v_mfma_f32_16x16x32_bf16 a[224:227], a[24:27], v[208:211], a[224:227]
 v_mfma_f32_16x16x32_bf16 a[228:231], a[24:27], v[212:215], a[228:231]
 v_mfma_f32_16x16x32_bf16 a[232:235], a[24:27], v[216:219], a[232:235]
 v_mfma_f32_16x16x32_bf16 a[236:239], a[24:27], v[220:223], a[236:239]
 v_mfma_f32_16x16x32_bf16 a[252:255], a[28:31], v[220:223], a[252:255]
 v_mfma_f32_16x16x32_bf16 a[248:251], a[28:31], v[216:219], a[248:251]
 v_mfma_f32_16x16x32_bf16 a[244:247], a[28:31], v[212:215], a[244:247]
 v_mfma_f32_16x16x32_bf16 a[240:243], a[28:31], v[208:211], a[240:243]
 v_mov_b32 v44, v20
 v_mov_b32 v45, v21
 v_mov_b32 v46, v22
 v_mov_b32 v47, v23
 v_permlane16_swap_b32 v20, v44
 v_permlane16_swap_b32 v21, v45
 v_permlane16_swap_b32 v22, v46
 v_permlane16_swap_b32 v23, v47
 v_add_f32 v20, v20, v44
 v_add_f32 v21, v21, v45
 v_add_f32 v22, v22, v46
 v_add_f32 v23, v23, v47
 v_mov_b32 v44, v20
 v_mov_b32 v45, v21
 v_mov_b32 v46, v22
 v_mov_b32 v47, v23
 v_permlane32_swap_b32 v20, v44
 v_permlane32_swap_b32 v21, v45
 v_permlane32_swap_b32 v22, v46
 v_permlane32_swap_b32 v23, v47
 v_add_f32 v20, v20, v44
 v_add_f32 v21, v21, v45
 v_add_f32 v22, v22, v46
 v_add_f32 v23, v23, v47
 s_mov_b32 s52, 0x71800000
 v_add_f32 v41, v20, v21
 v_add_f32 v42, v22, v23
 v_add_f32 v41, v41, v42
 v_cmp_nle_f32 vcc, v41, s52
 s_nop 4
 s_cbranch_vccz main_kernel_norm
 s_sub_u32 s50, s50, s54
 s_waitcnt vmcnt(0) lgkmcnt(0)
 v_mov_b32 v40, 0xff800000
 v_mov_b32 v41, 0xff800000
 v_mov_b32 v42, 0xff800000
 v_mov_b32 v43, 0xff800000
 s_mov_b32 s51, 0
main_kernel_slow1:
 s_lshl_b32 s52, s51, 14
 s_add_u32 s52, s52, s50
 s_add_u32 s53, s52, 0
 buffer_load_dwordx4 a[0:3], v16, s[8:11], s53 offen offset:0
 s_add_u32 s53, s52, 0
 buffer_load_dwordx4 a[4:7], v16, s[8:11], s53 offen offset:1024
 s_add_u32 s53, s52, 0
 buffer_load_dwordx4 a[8:11], v16, s[8:11], s53 offen offset:2048
 s_add_u32 s53, s52, 0
 buffer_load_dwordx4 a[12:15], v16, s[8:11], s53 offen offset:3072
 s_add_u32 s53, s52, 4096
 buffer_load_dwordx4 a[16:19], v16, s[8:11], s53 offen offset:0
 s_add_u32 s53, s52, 4096
 buffer_load_dwordx4 a[20:23], v16, s[8:11], s53 offen offset:1024
 s_add_u32 s53, s52, 4096
 buffer_load_dwordx4 a[24:27], v16, s[8:11], s53 offen offset:2048
 s_add_u32 s53, s52, 4096
 buffer_load_dwordx4 a[28:31], v16, s[8:11], s53 offen offset:3072
 s_waitcnt vmcnt(0)
 v_mfma_f32_16x16x32_bf16 v[128:131], a[0:3], v[64:67], 0
 v_mfma_f32_16x16x32_bf16 v[132:135], a[0:3], v[80:83], 0
 v_mfma_f32_16x16x32_bf16 v[136:139], a[0:3], v[96:99], 0
 v_mfma_f32_16x16x32_bf16 v[140:143], a[0:3], v[112:115], 0
 v_mfma_f32_16x16x32_bf16 v[128:131], a[4:7], v[68:71], v[128:131]
 v_mfma_f32_16x16x32_bf16 v[132:135], a[4:7], v[84:87], v[132:135]
 v_mfma_f32_16x16x32_bf16 v[136:139], a[4:7], v[100:103], v[136:139]
 v_mfma_f32_16x16x32_bf16 v[140:143], a[4:7], v[116:119], v[140:143]
 v_mfma_f32_16x16x32_bf16 v[128:131], a[8:11], v[72:75], v[128:131]
 v_mfma_f32_16x16x32_bf16 v[132:135], a[8:11], v[88:91], v[132:135]
 v_mfma_f32_16x16x32_bf16 v[136:139], a[8:11], v[104:107], v[136:139]
 v_mfma_f32_16x16x32_bf16 v[140:143], a[8:11], v[120:123], v[140:143]
 v_mfma_f32_16x16x32_bf16 v[128:131], a[12:15], v[76:79], v[128:131]
 v_mfma_f32_16x16x32_bf16 v[132:135], a[12:15], v[92:95], v[132:135]
 v_mfma_f32_16x16x32_bf16 v[136:139], a[12:15], v[108:111], v[136:139]
 v_mfma_f32_16x16x32_bf16 v[140:143], a[12:15], v[124:127], v[140:143]
 v_mfma_f32_16x16x32_bf16 v[144:147], a[16:19], v[64:67], 0
 v_mfma_f32_16x16x32_bf16 v[148:151], a[16:19], v[80:83], 0
 v_mfma_f32_16x16x32_bf16 v[152:155], a[16:19], v[96:99], 0
 v_mfma_f32_16x16x32_bf16 v[156:159], a[16:19], v[112:115], 0
 v_mfma_f32_16x16x32_bf16 v[144:147], a[20:23], v[68:71], v[144:147]
 v_mfma_f32_16x16x32_bf16 v[148:151], a[20:23], v[84:87], v[148:151]
 v_mfma_f32_16x16x32_bf16 v[152:155], a[20:23], v[100:103], v[152:155]
 v_mfma_f32_16x16x32_bf16 v[156:159], a[20:23], v[116:119], v[156:159]
 v_mfma_f32_16x16x32_bf16 v[144:147], a[24:27], v[72:75], v[144:147]
 v_mfma_f32_16x16x32_bf16 v[148:151], a[24:27], v[88:91], v[148:151]
 v_mfma_f32_16x16x32_bf16 v[152:155], a[24:27], v[104:107], v[152:155]
 v_mfma_f32_16x16x32_bf16 v[156:159], a[24:27], v[120:123], v[156:159]
 v_mfma_f32_16x16x32_bf16 v[144:147], a[28:31], v[76:79], v[144:147]
 v_mfma_f32_16x16x32_bf16 v[148:151], a[28:31], v[92:95], v[148:151]
 v_mfma_f32_16x16x32_bf16 v[152:155], a[28:31], v[108:111], v[152:155]
 v_mfma_f32_16x16x32_bf16 v[156:159], a[28:31], v[124:127], v[156:159]
 s_nop 7
 v_max3_f32 v40, v40, v128, v129
 v_max3_f32 v40, v40, v130, v131
 v_max3_f32 v40, v40, v144, v145
 v_max3_f32 v40, v40, v146, v147
 v_max3_f32 v41, v41, v132, v133
 v_max3_f32 v41, v41, v134, v135
 v_max3_f32 v41, v41, v148, v149
 v_max3_f32 v41, v41, v150, v151
 v_max3_f32 v42, v42, v136, v137
 v_max3_f32 v42, v42, v138, v139
 v_max3_f32 v42, v42, v152, v153
 v_max3_f32 v42, v42, v154, v155
 v_max3_f32 v43, v43, v140, v141
 v_max3_f32 v43, v43, v142, v143
 v_max3_f32 v43, v43, v156, v157
 v_max3_f32 v43, v43, v158, v159
 s_add_u32 s51, s51, 1
 s_cmp_lt_u32 s51, 16
 s_cbranch_scc1 main_kernel_slow1
 v_mov_b32 v44, v40
 v_mov_b32 v45, v41
 v_mov_b32 v46, v42
 v_mov_b32 v47, v43
 v_permlane16_swap_b32 v40, v44
 v_permlane16_swap_b32 v41, v45
 v_permlane16_swap_b32 v42, v46
 v_permlane16_swap_b32 v43, v47
 v_max_f32 v40, v40, v44
 v_max_f32 v41, v41, v45
 v_max_f32 v42, v42, v46
 v_max_f32 v43, v43, v47
 v_mov_b32 v44, v40
 v_mov_b32 v45, v41
 v_mov_b32 v46, v42
 v_mov_b32 v47, v43
 v_permlane32_swap_b32 v40, v44
 v_permlane32_swap_b32 v41, v45
 v_permlane32_swap_b32 v42, v46
 v_permlane32_swap_b32 v43, v47
 v_max_f32 v40, v40, v44
 v_max_f32 v41, v41, v45
 v_max_f32 v42, v42, v46
 v_max_f32 v43, v43, v47
 v_sub_f32 v24, 0, v40
 v_sub_f32 v25, 0, v40
 v_sub_f32 v26, 0, v40
 v_sub_f32 v27, 0, v40
 v_mov_b32 v20, 0
 v_sub_f32 v28, 0, v41
 v_sub_f32 v29, 0, v41
 v_sub_f32 v30, 0, v41
 v_sub_f32 v31, 0, v41
 v_mov_b32 v21, 0
 v_sub_f32 v32, 0, v42
 v_sub_f32 v33, 0, v42
 v_sub_f32 v34, 0, v42
 v_sub_f32 v35, 0, v42
 v_mov_b32 v22, 0
 v_sub_f32 v36, 0, v43
 v_sub_f32 v37, 0, v43
 v_sub_f32 v38, 0, v43
 v_sub_f32 v39, 0, v43
 v_mov_b32 v23, 0
 v_accvgpr_write_b32 a128, 0
 v_accvgpr_write_b32 a129, 0
 v_accvgpr_write_b32 a130, 0
 v_accvgpr_write_b32 a131, 0
 v_accvgpr_write_b32 a132, 0
 v_accvgpr_write_b32 a133, 0
 v_accvgpr_write_b32 a134, 0
 v_accvgpr_write_b32 a135, 0
 v_accvgpr_write_b32 a136, 0
 v_accvgpr_write_b32 a137, 0
 v_accvgpr_write_b32 a138, 0
 v_accvgpr_write_b32 a139, 0
 v_accvgpr_write_b32 a140, 0
 v_accvgpr_write_b32 a141, 0
 v_accvgpr_write_b32 a142, 0
 v_accvgpr_write_b32 a143, 0
 v_accvgpr_write_b32 a144, 0
 v_accvgpr_write_b32 a145, 0
 v_accvgpr_write_b32 a146, 0
 v_accvgpr_write_b32 a147, 0
 v_accvgpr_write_b32 a148, 0
 v_accvgpr_write_b32 a149, 0
 v_accvgpr_write_b32 a150, 0
 v_accvgpr_write_b32 a151, 0
 v_accvgpr_write_b32 a152, 0
 v_accvgpr_write_b32 a153, 0
 v_accvgpr_write_b32 a154, 0
 v_accvgpr_write_b32 a155, 0
 v_accvgpr_write_b32 a156, 0
 v_accvgpr_write_b32 a157, 0
 v_accvgpr_write_b32 a158, 0
 v_accvgpr_write_b32 a159, 0
 v_accvgpr_write_b32 a160, 0
 v_accvgpr_write_b32 a161, 0
 v_accvgpr_write_b32 a162, 0
 v_accvgpr_write_b32 a163, 0
 v_accvgpr_write_b32 a164, 0
 v_accvgpr_write_b32 a165, 0
 v_accvgpr_write_b32 a166, 0
 v_accvgpr_write_b32 a167, 0
 v_accvgpr_write_b32 a168, 0
 v_accvgpr_write_b32 a169, 0
 v_accvgpr_write_b32 a170, 0
 v_accvgpr_write_b32 a171, 0
 v_accvgpr_write_b32 a172, 0
 v_accvgpr_write_b32 a173, 0
 v_accvgpr_write_b32 a174, 0
 v_accvgpr_write_b32 a175, 0
 v_accvgpr_write_b32 a176, 0
 v_accvgpr_write_b32 a177, 0
 v_accvgpr_write_b32 a178, 0
 v_accvgpr_write_b32 a179, 0
 v_accvgpr_write_b32 a180, 0
 v_accvgpr_write_b32 a181, 0
 v_accvgpr_write_b32 a182, 0
 v_accvgpr_write_b32 a183, 0
 v_accvgpr_write_b32 a184, 0
 v_accvgpr_write_b32 a185, 0
 v_accvgpr_write_b32 a186, 0
 v_accvgpr_write_b32 a187, 0
 v_accvgpr_write_b32 a188, 0
 v_accvgpr_write_b32 a189, 0
 v_accvgpr_write_b32 a190, 0
 v_accvgpr_write_b32 a191, 0
 v_accvgpr_write_b32 a192, 0
 v_accvgpr_write_b32 a193, 0
 v_accvgpr_write_b32 a194, 0
 v_accvgpr_write_b32 a195, 0
 v_accvgpr_write_b32 a196, 0
 v_accvgpr_write_b32 a197, 0
 v_accvgpr_write_b32 a198, 0
 v_accvgpr_write_b32 a199, 0
 v_accvgpr_write_b32 a200, 0
 v_accvgpr_write_b32 a201, 0
 v_accvgpr_write_b32 a202, 0
 v_accvgpr_write_b32 a203, 0
 v_accvgpr_write_b32 a204, 0
 v_accvgpr_write_b32 a205, 0
 v_accvgpr_write_b32 a206, 0
 v_accvgpr_write_b32 a207, 0
 v_accvgpr_write_b32 a208, 0
 v_accvgpr_write_b32 a209, 0
 v_accvgpr_write_b32 a210, 0
 v_accvgpr_write_b32 a211, 0
 v_accvgpr_write_b32 a212, 0
 v_accvgpr_write_b32 a213, 0
 v_accvgpr_write_b32 a214, 0
 v_accvgpr_write_b32 a215, 0
 v_accvgpr_write_b32 a216, 0
 v_accvgpr_write_b32 a217, 0
 v_accvgpr_write_b32 a218, 0
 v_accvgpr_write_b32 a219, 0
 v_accvgpr_write_b32 a220, 0
 v_accvgpr_write_b32 a221, 0
 v_accvgpr_write_b32 a222, 0
 v_accvgpr_write_b32 a223, 0
 v_accvgpr_write_b32 a224, 0
 v_accvgpr_write_b32 a225, 0
 v_accvgpr_write_b32 a226, 0
 v_accvgpr_write_b32 a227, 0
 v_accvgpr_write_b32 a228, 0
 v_accvgpr_write_b32 a229, 0
 v_accvgpr_write_b32 a230, 0
 v_accvgpr_write_b32 a231, 0
 v_accvgpr_write_b32 a232, 0
 v_accvgpr_write_b32 a233, 0
 v_accvgpr_write_b32 a234, 0
 v_accvgpr_write_b32 a235, 0
 v_accvgpr_write_b32 a236, 0
 v_accvgpr_write_b32 a237, 0
 v_accvgpr_write_b32 a238, 0
 v_accvgpr_write_b32 a239, 0
 v_accvgpr_write_b32 a240, 0
 v_accvgpr_write_b32 a241, 0
 v_accvgpr_write_b32 a242, 0
 v_accvgpr_write_b32 a243, 0
 v_accvgpr_write_b32 a244, 0
 v_accvgpr_write_b32 a245, 0
 v_accvgpr_write_b32 a246, 0
 v_accvgpr_write_b32 a247, 0
 v_accvgpr_write_b32 a248, 0
 v_accvgpr_write_b32 a249, 0
 v_accvgpr_write_b32 a250, 0
 v_accvgpr_write_b32 a251, 0
 v_accvgpr_write_b32 a252, 0
 v_accvgpr_write_b32 a253, 0
 v_accvgpr_write_b32 a254, 0
 v_accvgpr_write_b32 a255, 0
 s_mov_b32 s51, 0
main_kernel_slow2:
 s_lshl_b32 s52, s51, 14
 s_add_u32 s52, s52, s50
 s_add_u32 s53, s52, 0
 buffer_load_dwordx4 a[0:3], v16, s[8:11], s53 offen offset:0
 s_add_u32 s53, s52, 0
 buffer_load_dwordx4 a[4:7], v16, s[8:11], s53 offen offset:1024
 s_add_u32 s53, s52, 0
 buffer_load_dwordx4 a[8:11], v16, s[8:11], s53 offen offset:2048
 s_add_u32 s53, s52, 0
 buffer_load_dwordx4 a[12:15], v16, s[8:11], s53 offen offset:3072
 s_add_u32 s53, s52, 4096
 buffer_load_dwordx4 a[16:19], v16, s[8:11], s53 offen offset:0
 s_add_u32 s53, s52, 4096
 buffer_load_dwordx4 a[20:23], v16, s[8:11], s53 offen offset:1024
 s_add_u32 s53, s52, 4096
 buffer_load_dwordx4 a[24:27], v16, s[8:11], s53 offen offset:2048
 s_add_u32 s53, s52, 4096
 buffer_load_dwordx4 a[28:31], v16, s[8:11], s53 offen offset:3072
 s_waitcnt vmcnt(0)
 v_mfma_f32_16x16x32_bf16 v[128:131], a[0:3], v[64:67], v[24:27]
 v_mfma_f32_16x16x32_bf16 v[132:135], a[0:3], v[80:83], v[28:31]
 v_mfma_f32_16x16x32_bf16 v[136:139], a[0:3], v[96:99], v[32:35]
 v_mfma_f32_16x16x32_bf16 v[140:143], a[0:3], v[112:115], v[36:39]
 v_mfma_f32_16x16x32_bf16 v[128:131], a[4:7], v[68:71], v[128:131]
 v_mfma_f32_16x16x32_bf16 v[132:135], a[4:7], v[84:87], v[132:135]
 v_mfma_f32_16x16x32_bf16 v[136:139], a[4:7], v[100:103], v[136:139]
 v_mfma_f32_16x16x32_bf16 v[140:143], a[4:7], v[116:119], v[140:143]
 v_mfma_f32_16x16x32_bf16 v[128:131], a[8:11], v[72:75], v[128:131]
 v_mfma_f32_16x16x32_bf16 v[132:135], a[8:11], v[88:91], v[132:135]
 v_mfma_f32_16x16x32_bf16 v[136:139], a[8:11], v[104:107], v[136:139]
 v_mfma_f32_16x16x32_bf16 v[140:143], a[8:11], v[120:123], v[140:143]
 v_mfma_f32_16x16x32_bf16 v[128:131], a[12:15], v[76:79], v[128:131]
 v_mfma_f32_16x16x32_bf16 v[132:135], a[12:15], v[92:95], v[132:135]
 v_mfma_f32_16x16x32_bf16 v[136:139], a[12:15], v[108:111], v[136:139]
 v_mfma_f32_16x16x32_bf16 v[140:143], a[12:15], v[124:127], v[140:143]
 v_mfma_f32_16x16x32_bf16 v[144:147], a[16:19], v[64:67], v[24:27]
 v_mfma_f32_16x16x32_bf16 v[148:151], a[16:19], v[80:83], v[28:31]
 v_mfma_f32_16x16x32_bf16 v[152:155], a[16:19], v[96:99], v[32:35]
 v_mfma_f32_16x16x32_bf16 v[156:159], a[16:19], v[112:115], v[36:39]
 v_mfma_f32_16x16x32_bf16 v[144:147], a[20:23], v[68:71], v[144:147]
 v_mfma_f32_16x16x32_bf16 v[148:151], a[20:23], v[84:87], v[148:151]
 v_mfma_f32_16x16x32_bf16 v[152:155], a[20:23], v[100:103], v[152:155]
 v_mfma_f32_16x16x32_bf16 v[156:159], a[20:23], v[116:119], v[156:159]
 v_mfma_f32_16x16x32_bf16 v[144:147], a[24:27], v[72:75], v[144:147]
 v_mfma_f32_16x16x32_bf16 v[148:151], a[24:27], v[88:91], v[148:151]
 v_mfma_f32_16x16x32_bf16 v[152:155], a[24:27], v[104:107], v[152:155]
 v_mfma_f32_16x16x32_bf16 v[156:159], a[24:27], v[120:123], v[156:159]
 v_mfma_f32_16x16x32_bf16 v[144:147], a[28:31], v[76:79], v[144:147]
 v_mfma_f32_16x16x32_bf16 v[148:151], a[28:31], v[92:95], v[148:151]
 v_mfma_f32_16x16x32_bf16 v[152:155], a[28:31], v[108:111], v[152:155]
 v_mfma_f32_16x16x32_bf16 v[156:159], a[28:31], v[124:127], v[156:159]
 s_nop 7
 v_exp_f32 v128, v128
 v_exp_f32 v129, v129
 s_nop 0
 v_add_f32 v20, v20, v128
 v_add_f32 v20, v20, v129
 v_exp_f32 v130, v130
 v_exp_f32 v131, v131
 s_nop 0
 v_add_f32 v20, v20, v130
 v_add_f32 v20, v20, v131
 v_exp_f32 v144, v144
 v_exp_f32 v145, v145
 s_nop 0
 v_add_f32 v20, v20, v144
 v_add_f32 v20, v20, v145
 v_exp_f32 v146, v146
 v_exp_f32 v147, v147
 s_nop 0
 v_add_f32 v20, v20, v146
 v_add_f32 v20, v20, v147
 s_nop 0
 v_cvt_pk_bf16_f32 v192, v128, v129
 v_cvt_pk_bf16_f32 v193, v130, v131
 s_nop 0
 v_cvt_pk_bf16_f32 v194, v144, v145
 v_cvt_pk_bf16_f32 v195, v146, v147
 v_exp_f32 v132, v132
 v_exp_f32 v133, v133
 s_nop 0
 v_add_f32 v21, v21, v132
 v_add_f32 v21, v21, v133
 v_exp_f32 v134, v134
 v_exp_f32 v135, v135
 s_nop 0
 v_add_f32 v21, v21, v134
 v_add_f32 v21, v21, v135
 v_exp_f32 v148, v148
 v_exp_f32 v149, v149
 s_nop 0
 v_add_f32 v21, v21, v148
 v_add_f32 v21, v21, v149
 v_exp_f32 v150, v150
 v_exp_f32 v151, v151
 s_nop 0
 v_add_f32 v21, v21, v150
 v_add_f32 v21, v21, v151
 s_nop 0
 v_cvt_pk_bf16_f32 v196, v132, v133
 v_cvt_pk_bf16_f32 v197, v134, v135
 s_nop 0
 v_cvt_pk_bf16_f32 v198, v148, v149
 v_cvt_pk_bf16_f32 v199, v150, v151
 v_exp_f32 v136, v136
 v_exp_f32 v137, v137
 s_nop 0
 v_add_f32 v22, v22, v136
 v_add_f32 v22, v22, v137
 v_exp_f32 v138, v138
 v_exp_f32 v139, v139
 s_nop 0
 v_add_f32 v22, v22, v138
 v_add_f32 v22, v22, v139
 v_exp_f32 v152, v152
 v_exp_f32 v153, v153
 s_nop 0
 v_add_f32 v22, v22, v152
 v_add_f32 v22, v22, v153
 v_exp_f32 v154, v154
 v_exp_f32 v155, v155
 s_nop 0
 v_add_f32 v22, v22, v154
 v_add_f32 v22, v22, v155
 s_nop 0
 v_cvt_pk_bf16_f32 v200, v136, v137
 v_cvt_pk_bf16_f32 v201, v138, v139
 s_nop 0
 v_cvt_pk_bf16_f32 v202, v152, v153
 v_cvt_pk_bf16_f32 v203, v154, v155
 v_exp_f32 v140, v140
 v_exp_f32 v141, v141
 s_nop 0
 v_add_f32 v23, v23, v140
 v_add_f32 v23, v23, v141
 v_exp_f32 v142, v142
 v_exp_f32 v143, v143
 s_nop 0
 v_add_f32 v23, v23, v142
 v_add_f32 v23, v23, v143
 v_exp_f32 v156, v156
 v_exp_f32 v157, v157
 s_nop 0
 v_add_f32 v23, v23, v156
 v_add_f32 v23, v23, v157
 v_exp_f32 v158, v158
 v_exp_f32 v159, v159
 s_nop 0
 v_add_f32 v23, v23, v158
 v_add_f32 v23, v23, v159
 s_nop 0
 v_cvt_pk_bf16_f32 v204, v140, v141
 v_cvt_pk_bf16_f32 v205, v142, v143
 s_nop 0
 v_cvt_pk_bf16_f32 v206, v156, v157
 v_cvt_pk_bf16_f32 v207, v158, v159
 s_add_u32 s53, s52, 8192
 buffer_load_dwordx4 a[0:3], v16, s[8:11], s53 offen offset:0
 s_add_u32 s53, s52, 8192
 buffer_load_dwordx4 a[4:7], v16, s[8:11], s53 offen offset:1024
 s_add_u32 s53, s52, 8192
 buffer_load_dwordx4 a[8:11], v16, s[8:11], s53 offen offset:2048
 s_add_u32 s53, s52, 8192
 buffer_load_dwordx4 a[12:15], v16, s[8:11], s53 offen offset:3072
 s_add_u32 s53, s52, 12288
 buffer_load_dwordx4 a[16:19], v16, s[8:11], s53 offen offset:0
 s_add_u32 s53, s52, 12288
 buffer_load_dwordx4 a[20:23], v16, s[8:11], s53 offen offset:1024
 s_add_u32 s53, s52, 12288
 buffer_load_dwordx4 a[24:27], v16, s[8:11], s53 offen offset:2048
 s_add_u32 s53, s52, 12288
 buffer_load_dwordx4 a[28:31], v16, s[8:11], s53 offen offset:3072
 s_waitcnt vmcnt(0)
 v_mfma_f32_16x16x32_bf16 a[128:131], a[0:3], v[192:195], a[128:131]
 v_mfma_f32_16x16x32_bf16 a[132:135], a[0:3], v[196:199], a[132:135]
 v_mfma_f32_16x16x32_bf16 a[136:139], a[0:3], v[200:203], a[136:139]
 v_mfma_f32_16x16x32_bf16 a[140:143], a[0:3], v[204:207], a[140:143]
 v_mfma_f32_16x16x32_bf16 a[144:147], a[4:7], v[192:195], a[144:147]
 v_mfma_f32_16x16x32_bf16 a[148:151], a[4:7], v[196:199], a[148:151]
 v_mfma_f32_16x16x32_bf16 a[152:155], a[4:7], v[200:203], a[152:155]
 v_mfma_f32_16x16x32_bf16 a[156:159], a[4:7], v[204:207], a[156:159]
 v_mfma_f32_16x16x32_bf16 a[160:163], a[8:11], v[192:195], a[160:163]
 v_mfma_f32_16x16x32_bf16 a[164:167], a[8:11], v[196:199], a[164:167]
 v_mfma_f32_16x16x32_bf16 a[168:171], a[8:11], v[200:203], a[168:171]
 v_mfma_f32_16x16x32_bf16 a[172:175], a[8:11], v[204:207], a[172:175]
 v_mfma_f32_16x16x32_bf16 a[176:179], a[12:15], v[192:195], a[176:179]
 v_mfma_f32_16x16x32_bf16 a[180:183], a[12:15], v[196:199], a[180:183]
 v_mfma_f32_16x16x32_bf16 a[184:187], a[12:15], v[200:203], a[184:187]
 v_mfma_f32_16x16x32_bf16 a[188:191], a[12:15], v[204:207], a[188:191]
 v_mfma_f32_16x16x32_bf16 a[192:195], a[16:19], v[192:195], a[192:195]
 v_mfma_f32_16x16x32_bf16 a[196:199], a[16:19], v[196:199], a[196:199]
 v_mfma_f32_16x16x32_bf16 a[200:203], a[16:19], v[200:203], a[200:203]
 v_mfma_f32_16x16x32_bf16 a[204:207], a[16:19], v[204:207], a[204:207]
 v_mfma_f32_16x16x32_bf16 a[208:211], a[20:23], v[192:195], a[208:211]
 v_mfma_f32_16x16x32_bf16 a[212:215], a[20:23], v[196:199], a[212:215]
 v_mfma_f32_16x16x32_bf16 a[216:219], a[20:23], v[200:203], a[216:219]
 v_mfma_f32_16x16x32_bf16 a[220:223], a[20:23], v[204:207], a[220:223]
 v_mfma_f32_16x16x32_bf16 a[224:227], a[24:27], v[192:195], a[224:227]
 v_mfma_f32_16x16x32_bf16 a[228:231], a[24:27], v[196:199], a[228:231]
 v_mfma_f32_16x16x32_bf16 a[232:235], a[24:27], v[200:203], a[232:235]
 v_mfma_f32_16x16x32_bf16 a[236:239], a[24:27], v[204:207], a[236:239]
 v_mfma_f32_16x16x32_bf16 a[240:243], a[28:31], v[192:195], a[240:243]
 v_mfma_f32_16x16x32_bf16 a[244:247], a[28:31], v[196:199], a[244:247]
 v_mfma_f32_16x16x32_bf16 a[248:251], a[28:31], v[200:203], a[248:251]
 v_mfma_f32_16x16x32_bf16 a[252:255], a[28:31], v[204:207], a[252:255]
 s_add_u32 s51, s51, 1
 s_cmp_lt_u32 s51, 16
 s_cbranch_scc1 main_kernel_slow2
 s_nop 7
 v_mov_b32 v44, v20
 v_mov_b32 v45, v21
 v_mov_b32 v46, v22
 v_mov_b32 v47, v23
 v_permlane16_swap_b32 v20, v44
 v_permlane16_swap_b32 v21, v45
 v_permlane16_swap_b32 v22, v46
 v_permlane16_swap_b32 v23, v47
 v_add_f32 v20, v20, v44
 v_add_f32 v21, v21, v45
 v_add_f32 v22, v22, v46
 v_add_f32 v23, v23, v47
 v_mov_b32 v44, v20
 v_mov_b32 v45, v21
 v_mov_b32 v46, v22
 v_mov_b32 v47, v23
 v_permlane32_swap_b32 v20, v44
 v_permlane32_swap_b32 v21, v45
 v_permlane32_swap_b32 v22, v46
 v_permlane32_swap_b32 v23, v47
 v_add_f32 v20, v20, v44
 v_add_f32 v21, v21, v45
 v_add_f32 v22, v22, v46
 v_add_f32 v23, v23, v47
main_kernel_norm:
 v_rcp_f32 v40, v20
 v_rcp_f32 v42, v21
 v_rcp_f32 v44, v22
 v_rcp_f32 v46, v23
 s_nop 0
 v_mov_b32 v41, v40
 v_mov_b32 v43, v42
 v_mov_b32 v45, v44
 v_mov_b32 v47, v46
 s_lshl_b32 s52, s35, 17
 s_lshl_b32 s53, s32, 12
 s_add_u32 s52, s52, s53
 s_add_u32 s52, s52, 8388608
 v_accvgpr_read_b32 v128, a128
 v_accvgpr_read_b32 v129, a129
 v_accvgpr_read_b32 v130, a130
 v_accvgpr_read_b32 v131, a131
 v_accvgpr_read_b32 v132, a144
 v_accvgpr_read_b32 v133, a145
 v_accvgpr_read_b32 v134, a146
 v_accvgpr_read_b32 v135, a147
 v_pk_mul_f32 v[128:129], v[128:129], v[40:41]
 v_pk_mul_f32 v[130:131], v[130:131], v[40:41]
 v_pk_mul_f32 v[132:133], v[132:133], v[40:41]
 v_pk_mul_f32 v[134:135], v[134:135], v[40:41]
 v_cvt_pk_bf16_f32 v160, v128, v129
 v_cvt_pk_bf16_f32 v161, v130, v131
 v_cvt_pk_bf16_f32 v162, v132, v133
 v_cvt_pk_bf16_f32 v163, v134, v135
 buffer_store_dwordx4 v[160:163], v16, s[8:11], s52 offen offset:0 sc1
 v_accvgpr_read_b32 v136, a160
 v_accvgpr_read_b32 v137, a161
 v_accvgpr_read_b32 v138, a162
 v_accvgpr_read_b32 v139, a163
 v_accvgpr_read_b32 v140, a176
 v_accvgpr_read_b32 v141, a177
 v_accvgpr_read_b32 v142, a178
 v_accvgpr_read_b32 v143, a179
 v_pk_mul_f32 v[136:137], v[136:137], v[40:41]
 v_pk_mul_f32 v[138:139], v[138:139], v[40:41]
 v_pk_mul_f32 v[140:141], v[140:141], v[40:41]
 v_pk_mul_f32 v[142:143], v[142:143], v[40:41]
 v_cvt_pk_bf16_f32 v164, v136, v137
 v_cvt_pk_bf16_f32 v165, v138, v139
 v_cvt_pk_bf16_f32 v166, v140, v141
 v_cvt_pk_bf16_f32 v167, v142, v143
 buffer_store_dwordx4 v[164:167], v16, s[8:11], s52 offen offset:1024 sc1
 v_accvgpr_read_b32 v144, a192
 v_accvgpr_read_b32 v145, a193
 v_accvgpr_read_b32 v146, a194
 v_accvgpr_read_b32 v147, a195
 v_accvgpr_read_b32 v148, a208
 v_accvgpr_read_b32 v149, a209
 v_accvgpr_read_b32 v150, a210
 v_accvgpr_read_b32 v151, a211
 v_pk_mul_f32 v[144:145], v[144:145], v[40:41]
 v_pk_mul_f32 v[146:147], v[146:147], v[40:41]
 v_pk_mul_f32 v[148:149], v[148:149], v[40:41]
 v_pk_mul_f32 v[150:151], v[150:151], v[40:41]
 v_cvt_pk_bf16_f32 v168, v144, v145
 v_cvt_pk_bf16_f32 v169, v146, v147
 v_cvt_pk_bf16_f32 v170, v148, v149
 v_cvt_pk_bf16_f32 v171, v150, v151
 buffer_store_dwordx4 v[168:171], v16, s[8:11], s52 offen offset:2048 sc1
 v_accvgpr_read_b32 v152, a224
 v_accvgpr_read_b32 v153, a225
 v_accvgpr_read_b32 v154, a226
 v_accvgpr_read_b32 v155, a227
 v_accvgpr_read_b32 v156, a240
 v_accvgpr_read_b32 v157, a241
 v_accvgpr_read_b32 v158, a242
 v_accvgpr_read_b32 v159, a243
 v_pk_mul_f32 v[152:153], v[152:153], v[40:41]
 v_pk_mul_f32 v[154:155], v[154:155], v[40:41]
 v_pk_mul_f32 v[156:157], v[156:157], v[40:41]
 v_pk_mul_f32 v[158:159], v[158:159], v[40:41]
 v_cvt_pk_bf16_f32 v172, v152, v153
 v_cvt_pk_bf16_f32 v173, v154, v155
 v_cvt_pk_bf16_f32 v174, v156, v157
 v_cvt_pk_bf16_f32 v175, v158, v159
 buffer_store_dwordx4 v[172:175], v16, s[8:11], s52 offen offset:3072 sc1
 s_add_u32 s52, s52, 131072
 v_accvgpr_read_b32 v128, a132
 v_accvgpr_read_b32 v129, a133
 v_accvgpr_read_b32 v130, a134
 v_accvgpr_read_b32 v131, a135
 v_accvgpr_read_b32 v132, a148
 v_accvgpr_read_b32 v133, a149
 v_accvgpr_read_b32 v134, a150
 v_accvgpr_read_b32 v135, a151
 v_pk_mul_f32 v[128:129], v[128:129], v[42:43]
 v_pk_mul_f32 v[130:131], v[130:131], v[42:43]
 v_pk_mul_f32 v[132:133], v[132:133], v[42:43]
 v_pk_mul_f32 v[134:135], v[134:135], v[42:43]
 v_cvt_pk_bf16_f32 v160, v128, v129
 v_cvt_pk_bf16_f32 v161, v130, v131
 v_cvt_pk_bf16_f32 v162, v132, v133
 v_cvt_pk_bf16_f32 v163, v134, v135
 buffer_store_dwordx4 v[160:163], v16, s[8:11], s52 offen offset:0 sc1
 v_accvgpr_read_b32 v136, a164
 v_accvgpr_read_b32 v137, a165
 v_accvgpr_read_b32 v138, a166
 v_accvgpr_read_b32 v139, a167
 v_accvgpr_read_b32 v140, a180
 v_accvgpr_read_b32 v141, a181
 v_accvgpr_read_b32 v142, a182
 v_accvgpr_read_b32 v143, a183
 v_pk_mul_f32 v[136:137], v[136:137], v[42:43]
 v_pk_mul_f32 v[138:139], v[138:139], v[42:43]
 v_pk_mul_f32 v[140:141], v[140:141], v[42:43]
 v_pk_mul_f32 v[142:143], v[142:143], v[42:43]
 v_cvt_pk_bf16_f32 v164, v136, v137
 v_cvt_pk_bf16_f32 v165, v138, v139
 v_cvt_pk_bf16_f32 v166, v140, v141
 v_cvt_pk_bf16_f32 v167, v142, v143
 buffer_store_dwordx4 v[164:167], v16, s[8:11], s52 offen offset:1024 sc1
 v_accvgpr_read_b32 v144, a196
 v_accvgpr_read_b32 v145, a197
 v_accvgpr_read_b32 v146, a198
 v_accvgpr_read_b32 v147, a199
 v_accvgpr_read_b32 v148, a212
 v_accvgpr_read_b32 v149, a213
 v_accvgpr_read_b32 v150, a214
 v_accvgpr_read_b32 v151, a215
 v_pk_mul_f32 v[144:145], v[144:145], v[42:43]
 v_pk_mul_f32 v[146:147], v[146:147], v[42:43]
 v_pk_mul_f32 v[148:149], v[148:149], v[42:43]
 v_pk_mul_f32 v[150:151], v[150:151], v[42:43]
 v_cvt_pk_bf16_f32 v168, v144, v145
 v_cvt_pk_bf16_f32 v169, v146, v147
 v_cvt_pk_bf16_f32 v170, v148, v149
 v_cvt_pk_bf16_f32 v171, v150, v151
 buffer_store_dwordx4 v[168:171], v16, s[8:11], s52 offen offset:2048 sc1
 v_accvgpr_read_b32 v152, a228
 v_accvgpr_read_b32 v153, a229
 v_accvgpr_read_b32 v154, a230
 v_accvgpr_read_b32 v155, a231
 v_accvgpr_read_b32 v156, a244
 v_accvgpr_read_b32 v157, a245
 v_accvgpr_read_b32 v158, a246
 v_accvgpr_read_b32 v159, a247
 v_pk_mul_f32 v[152:153], v[152:153], v[42:43]
 v_pk_mul_f32 v[154:155], v[154:155], v[42:43]
 v_pk_mul_f32 v[156:157], v[156:157], v[42:43]
 v_pk_mul_f32 v[158:159], v[158:159], v[42:43]
 v_cvt_pk_bf16_f32 v172, v152, v153
 v_cvt_pk_bf16_f32 v173, v154, v155
 v_cvt_pk_bf16_f32 v174, v156, v157
 v_cvt_pk_bf16_f32 v175, v158, v159
 buffer_store_dwordx4 v[172:175], v16, s[8:11], s52 offen offset:3072 sc1
 s_add_u32 s52, s52, 131072
 v_accvgpr_read_b32 v128, a136
 v_accvgpr_read_b32 v129, a137
 v_accvgpr_read_b32 v130, a138
 v_accvgpr_read_b32 v131, a139
 v_accvgpr_read_b32 v132, a152
 v_accvgpr_read_b32 v133, a153
 v_accvgpr_read_b32 v134, a154
 v_accvgpr_read_b32 v135, a155
 v_pk_mul_f32 v[128:129], v[128:129], v[44:45]
 v_pk_mul_f32 v[130:131], v[130:131], v[44:45]
 v_pk_mul_f32 v[132:133], v[132:133], v[44:45]
 v_pk_mul_f32 v[134:135], v[134:135], v[44:45]
 v_cvt_pk_bf16_f32 v160, v128, v129
 v_cvt_pk_bf16_f32 v161, v130, v131
 v_cvt_pk_bf16_f32 v162, v132, v133
 v_cvt_pk_bf16_f32 v163, v134, v135
 buffer_store_dwordx4 v[160:163], v16, s[8:11], s52 offen offset:0 sc1
 v_accvgpr_read_b32 v136, a168
 v_accvgpr_read_b32 v137, a169
 v_accvgpr_read_b32 v138, a170
 v_accvgpr_read_b32 v139, a171
 v_accvgpr_read_b32 v140, a184
 v_accvgpr_read_b32 v141, a185
 v_accvgpr_read_b32 v142, a186
 v_accvgpr_read_b32 v143, a187
 v_pk_mul_f32 v[136:137], v[136:137], v[44:45]
 v_pk_mul_f32 v[138:139], v[138:139], v[44:45]
 v_pk_mul_f32 v[140:141], v[140:141], v[44:45]
 v_pk_mul_f32 v[142:143], v[142:143], v[44:45]
 v_cvt_pk_bf16_f32 v164, v136, v137
 v_cvt_pk_bf16_f32 v165, v138, v139
 v_cvt_pk_bf16_f32 v166, v140, v141
 v_cvt_pk_bf16_f32 v167, v142, v143
 buffer_store_dwordx4 v[164:167], v16, s[8:11], s52 offen offset:1024 sc1
 v_accvgpr_read_b32 v144, a200
 v_accvgpr_read_b32 v145, a201
 v_accvgpr_read_b32 v146, a202
 v_accvgpr_read_b32 v147, a203
 v_accvgpr_read_b32 v148, a216
 v_accvgpr_read_b32 v149, a217
 v_accvgpr_read_b32 v150, a218
 v_accvgpr_read_b32 v151, a219
 v_pk_mul_f32 v[144:145], v[144:145], v[44:45]
 v_pk_mul_f32 v[146:147], v[146:147], v[44:45]
 v_pk_mul_f32 v[148:149], v[148:149], v[44:45]
 v_pk_mul_f32 v[150:151], v[150:151], v[44:45]
 v_cvt_pk_bf16_f32 v168, v144, v145
 v_cvt_pk_bf16_f32 v169, v146, v147
 v_cvt_pk_bf16_f32 v170, v148, v149
 v_cvt_pk_bf16_f32 v171, v150, v151
 buffer_store_dwordx4 v[168:171], v16, s[8:11], s52 offen offset:2048 sc1
 v_accvgpr_read_b32 v152, a232
 v_accvgpr_read_b32 v153, a233
 v_accvgpr_read_b32 v154, a234
 v_accvgpr_read_b32 v155, a235
 v_accvgpr_read_b32 v156, a248
 v_accvgpr_read_b32 v157, a249
 v_accvgpr_read_b32 v158, a250
 v_accvgpr_read_b32 v159, a251
 v_pk_mul_f32 v[152:153], v[152:153], v[44:45]
 v_pk_mul_f32 v[154:155], v[154:155], v[44:45]
 v_pk_mul_f32 v[156:157], v[156:157], v[44:45]
 v_pk_mul_f32 v[158:159], v[158:159], v[44:45]
 v_cvt_pk_bf16_f32 v172, v152, v153
 v_cvt_pk_bf16_f32 v173, v154, v155
 v_cvt_pk_bf16_f32 v174, v156, v157
 v_cvt_pk_bf16_f32 v175, v158, v159
 buffer_store_dwordx4 v[172:175], v16, s[8:11], s52 offen offset:3072 sc1
 s_add_u32 s52, s52, 131072
 v_accvgpr_read_b32 v128, a140
 v_accvgpr_read_b32 v129, a141
 v_accvgpr_read_b32 v130, a142
 v_accvgpr_read_b32 v131, a143
 v_accvgpr_read_b32 v132, a156
 v_accvgpr_read_b32 v133, a157
 v_accvgpr_read_b32 v134, a158
 v_accvgpr_read_b32 v135, a159
 v_pk_mul_f32 v[128:129], v[128:129], v[46:47]
 v_pk_mul_f32 v[130:131], v[130:131], v[46:47]
 v_pk_mul_f32 v[132:133], v[132:133], v[46:47]
 v_pk_mul_f32 v[134:135], v[134:135], v[46:47]
 v_cvt_pk_bf16_f32 v160, v128, v129
 v_cvt_pk_bf16_f32 v161, v130, v131
 v_cvt_pk_bf16_f32 v162, v132, v133
 v_cvt_pk_bf16_f32 v163, v134, v135
 buffer_store_dwordx4 v[160:163], v16, s[8:11], s52 offen offset:0 sc1
 v_accvgpr_read_b32 v136, a172
 v_accvgpr_read_b32 v137, a173
 v_accvgpr_read_b32 v138, a174
 v_accvgpr_read_b32 v139, a175
 v_accvgpr_read_b32 v140, a188
 v_accvgpr_read_b32 v141, a189
 v_accvgpr_read_b32 v142, a190
 v_accvgpr_read_b32 v143, a191
 v_pk_mul_f32 v[136:137], v[136:137], v[46:47]
 v_pk_mul_f32 v[138:139], v[138:139], v[46:47]
 v_pk_mul_f32 v[140:141], v[140:141], v[46:47]
 v_pk_mul_f32 v[142:143], v[142:143], v[46:47]
 v_cvt_pk_bf16_f32 v164, v136, v137
 v_cvt_pk_bf16_f32 v165, v138, v139
 v_cvt_pk_bf16_f32 v166, v140, v141
 v_cvt_pk_bf16_f32 v167, v142, v143
 buffer_store_dwordx4 v[164:167], v16, s[8:11], s52 offen offset:1024 sc1
 v_accvgpr_read_b32 v144, a204
 v_accvgpr_read_b32 v145, a205
 v_accvgpr_read_b32 v146, a206
 v_accvgpr_read_b32 v147, a207
 v_accvgpr_read_b32 v148, a220
 v_accvgpr_read_b32 v149, a221
 v_accvgpr_read_b32 v150, a222
 v_accvgpr_read_b32 v151, a223
 v_pk_mul_f32 v[144:145], v[144:145], v[46:47]
 v_pk_mul_f32 v[146:147], v[146:147], v[46:47]
 v_pk_mul_f32 v[148:149], v[148:149], v[46:47]
 v_pk_mul_f32 v[150:151], v[150:151], v[46:47]
 v_cvt_pk_bf16_f32 v168, v144, v145
 v_cvt_pk_bf16_f32 v169, v146, v147
 v_cvt_pk_bf16_f32 v170, v148, v149
 v_cvt_pk_bf16_f32 v171, v150, v151
 buffer_store_dwordx4 v[168:171], v16, s[8:11], s52 offen offset:2048 sc1
 v_accvgpr_read_b32 v152, a236
 v_accvgpr_read_b32 v153, a237
 v_accvgpr_read_b32 v154, a238
 v_accvgpr_read_b32 v155, a239
 v_accvgpr_read_b32 v156, a252
 v_accvgpr_read_b32 v157, a253
 v_accvgpr_read_b32 v158, a254
 v_accvgpr_read_b32 v159, a255
 v_pk_mul_f32 v[152:153], v[152:153], v[46:47]
 v_pk_mul_f32 v[154:155], v[154:155], v[46:47]
 v_pk_mul_f32 v[156:157], v[156:157], v[46:47]
 v_pk_mul_f32 v[158:159], v[158:159], v[46:47]
 v_cvt_pk_bf16_f32 v172, v152, v153
 v_cvt_pk_bf16_f32 v173, v154, v155
 v_cvt_pk_bf16_f32 v174, v156, v157
 v_cvt_pk_bf16_f32 v175, v158, v159
 buffer_store_dwordx4 v[172:175], v16, s[8:11], s52 offen offset:3072 sc1
 s_and_b32 s69, s2, 1
 s_bfe_u32 s31, s2, 0x20001
 s_lshl_b32 s31, s31, 2
 s_bfe_u32 s33, s2, 0x20003
 s_add_u32 s31, s31, s33
 s_lshr_b32 s68, s2, 5
 s_lshl_b32 s32, s68, 1
 s_add_u32 s32, s32, s69
 s_lshl_b32 s70, s69, 2
 s_mul_i32 s71, s69, 4194304
 s_mul_i32 s72, s69, 65536
 s_lshl_b32 s33, s32, 7
 s_lshl_b32 s67, s68, 8
 s_lshl_b32 s35, s31, 3
 s_lshl_b32 s41, s30, 1
 s_add_u32 s35, s35, s41
 s_lshl_b32 s34, s32, 8
 v_lshrrev_b32 v17, 4, v1
 v_lshlrev_b32 v17, 4, v17
 v_lshlrev_b32 v16, 4, v1
 s_load_dwordx2 s[36:37], s[0:1], 32
 s_load_dwordx2 s[58:59], s[0:1], 48
 s_load_dwordx2 s[38:39], s[0:1], 0
 s_waitcnt lgkmcnt(0)
 s_mov_b32 s12, s36
 s_mov_b32 s13, s37
 s_mov_b32 s14, 0x800000
 s_mov_b32 s15, 0x20000
 s_lshl_b32 s40, s100, 1
 s_lshr_b32 s41, s101, 4
 s_add_u32 s40, s40, s41
 s_waitcnt vmcnt(0)
 s_barrier
 s_cmp_eq_u32 s30, 0
 s_cbranch_scc0 w0_5
 s_lshl_b32 s78, s40, 7
 s_add_u32 s78, s78, 52692992
 v_mov_b32 v30, 1
 v_mov_b32 v31, 0
 s_mov_b64 exec, 1
 buffer_atomic_add v30, v31, s[8:11], s78 offen sc1
 s_mov_b64 exec, -1
w0_5:
 v_lshrrev_b32 v40, 4, v1
 v_and_b32 v41, 15, v1
 v_and_b32 v42, 3, v40
 v_lshlrev_b32 v42, 1, v42
 v_xor_b32 v41, v41, v42
 s_mul_i32 s29, s30, 16
 v_add_u32 v40, s29, v40
 s_mov_b32 s29, 2048
 v_mul_lo_u32 v40, v40, s29
 v_add_u32 v40, s67, v40
 v_lshl_add_u32 v2, v41, 4, v40
 v_xor_b32 v41, 8, v41
 v_lshl_add_u32 v3, v41, 4, v40
 s_mul_i32 s27, s30, 4096
 v_lshrrev_b32 v41, 2, v1
 v_mul_u32_u24 v40, 256, v41
 v_and_b32 v42, 3, v1
 v_lshl_add_u32 v40, v42, 3, v40
 v_and_b32 v41, 7, v41
 v_xor_b32 v41, s70, v41
 v_xor_b32 v42, 0, v41
 v_lshlrev_b32 v42, 5, v42
 v_add_u32 v4, v40, v42
 v_xor_b32 v42, 1, v41
 v_lshlrev_b32 v42, 5, v42
 v_add_u32 v5, v40, v42
 v_xor_b32 v42, 2, v41
 v_lshlrev_b32 v42, 5, v42
 v_add_u32 v6, v40, v42
 v_xor_b32 v42, 3, v41
 v_lshlrev_b32 v42, 5, v42
 v_add_u32 v7, v40, v42
 v_xor_b32 v42, 4, v41
 v_lshlrev_b32 v42, 5, v42
 v_add_u32 v8, v40, v42
 v_xor_b32 v42, 5, v41
 v_lshlrev_b32 v42, 5, v42
 v_add_u32 v9, v40, v42
 v_xor_b32 v42, 6, v41
 v_lshlrev_b32 v42, 5, v42
 v_add_u32 v10, v40, v42
 v_xor_b32 v42, 7, v41
 v_lshlrev_b32 v42, 5, v42
 v_add_u32 v11, v40, v42
 s_mov_b32 s20, s71
 s_add_u32 m0, s27, 0
 s_nop 0
 buffer_load_dwordx4 v2, s[12:15], s20 offen lds
 s_add_u32 s29, s20, 7168
 buffer_load_dwordx4 v3, s[12:15], s29 offen offset:1024 lds
 s_add_u32 s29, s20, 14336
 buffer_load_dwordx4 v2, s[12:15], s29 offen offset:2048 lds
 s_add_u32 s29, s20, 21504
 buffer_load_dwordx4 v3, s[12:15], s29 offen offset:3072 lds
 s_add_u32 s20, s20, 131072
 s_add_u32 m0, s27, 16384
 s_nop 0
 buffer_load_dwordx4 v2, s[12:15], s20 offen lds
 s_add_u32 s29, s20, 7168
 buffer_load_dwordx4 v3, s[12:15], s29 offen offset:1024 lds
 s_add_u32 s29, s20, 14336
 buffer_load_dwordx4 v2, s[12:15], s29 offen offset:2048 lds
 s_add_u32 s29, s20, 21504
 buffer_load_dwordx4 v3, s[12:15], s29 offen offset:3072 lds
 s_add_u32 s20, s20, 131072
 s_add_u32 m0, s27, 32768
 s_nop 0
 buffer_load_dwordx4 v2, s[12:15], s20 offen lds
 s_add_u32 s29, s20, 7168
 buffer_load_dwordx4 v3, s[12:15], s29 offen offset:1024 lds
 s_add_u32 s29, s20, 14336
 buffer_load_dwordx4 v2, s[12:15], s29 offen offset:2048 lds
 s_add_u32 s29, s20, 21504
 buffer_load_dwordx4 v3, s[12:15], s29 offen offset:3072 lds
 s_add_u32 s20, s20, 131072
 s_add_u32 m0, s27, 49152
 s_nop 0
 buffer_load_dwordx4 v2, s[12:15], s20 offen lds
 s_add_u32 s29, s20, 7168
 buffer_load_dwordx4 v3, s[12:15], s29 offen offset:1024 lds
 s_mul_hi_u32 s48, s2, 0x924924A
 s_mul_i32 s49, s48, 28
 s_sub_u32 s49, s2, s49
 s_lshl_b32 s47, s48, 9
 s_min_u32 s47, s47, 3584
 v_and_b32 v19, 127, v0
 v_lshlrev_b32 v19, 2, v19
 v_lshrrev_b32 v120, 7, v0
 v_and_b32 v120, 1, v120
 v_xor_b32 v120, 1, v120
 v_mul_u32_u24 v120, 4096, v120
 v_add_u32 v19, v19, v120
 s_add_u32 s40, s47, 51720192
 buffer_load_dword v120, v19, s[8:11], s40 offen
 s_add_u32 s40, s40, 24576
 buffer_load_dword v121, v19, s[8:11], s40 offen
 s_add_u32 s40, s40, 24576
 buffer_load_dword v122, v19, s[8:11], s40 offen
 s_add_u32 s40, s40, 24576
 buffer_load_dword v123, v19, s[8:11], s40 offen
 s_add_u32 s40, s40, 24576
 buffer_load_dword v124, v19, s[8:11], s40 offen
 s_add_u32 s40, s40, 24576
 buffer_load_dword v125, v19, s[8:11], s40 offen
 s_add_u32 s40, s40, 24576
 buffer_load_dword v126, v19, s[8:11], s40 offen
 s_add_u32 s40, s40, 24576
 buffer_load_dword v127, v19, s[8:11], s40 offen
 s_mov_b32 s16, s58
 s_mov_b32 s17, s59
 s_mov_b32 s18, 0x700000
 s_mov_b32 s19, 0x20000
 s_min_u32 s50, s48, 7
 s_mul_i32 s50, s50, 917504
 s_lshl_b32 s51, s49, 8
 s_add_u32 s50, s50, s51
 v_and_b32 v20, 15, v0
 v_lshrrev_b32 v21, 4, v0
 s_mov_b32 s52, 7168
 v_mul_lo_u32 v22, v21, s52
 v_lshl_add_u32 v22, v20, 4, v22
 s_mov_b32 s53, s50
 buffer_load_dwordx4 v[32:35], v22, s[16:19], s53 offen
 s_add_u32 s53, s53, 114688
 buffer_load_dwordx4 v[36:39], v22, s[16:19], s53 offen
 s_add_u32 s53, s53, 114688
 buffer_load_dwordx4 v[40:43], v22, s[16:19], s53 offen
 s_add_u32 s53, s53, 114688
 buffer_load_dwordx4 v[44:47], v22, s[16:19], s53 offen
 s_add_u32 s53, s53, 114688
 buffer_load_dwordx4 v[48:51], v22, s[16:19], s53 offen
 s_add_u32 s53, s53, 114688
 buffer_load_dwordx4 v[52:55], v22, s[16:19], s53 offen
 s_add_u32 s53, s53, 114688
 buffer_load_dwordx4 v[56:59], v22, s[16:19], s53 offen
 s_add_u32 s53, s53, 114688
 buffer_load_dwordx4 v[60:63], v22, s[16:19], s53 offen
 s_cmp_ge_u32 s2, 224
 s_cbranch_scc1 main_kernel_nouv
 s_waitcnt vmcnt(8)
 v_add_f32 v120, v120, v121
 v_add_f32 v122, v122, v123
 v_add_f32 v124, v124, v125
 v_add_f32 v126, v126, v127
 v_add_f32 v120, v120, v122
 v_add_f32 v124, v124, v126
 v_add_f32 v120, v120, v124
 v_cvt_pk_bf16_f32 v120, v120, v120
 v_lshlrev_b32 v120, 16, v120
 v_add_f32 v121, 1.0, v120
 v_cvt_pk_bf16_f32 v121, v121, v121
 v_lshlrev_b32 v121, 16, v121
 v_lshrrev_b32 v19, 7, v0
 v_and_b32 v19, 1, v19
 v_cmp_eq_u32 vcc, 0, v19
 s_nop 1
 v_cndmask_b32 v120, v120, v121, vcc
 v_lshlrev_b32 v19, 2, v0
 v_add_u32 v19, 132096, v19
 ds_write_b32 v19, v120
 s_waitcnt lgkmcnt(0)
 s_barrier
 v_lshlrev_b32 v23, 2, v21
 v_add_u32 v23, 132096, v23
 ds_read_b32 v224, v23 offset:0
 ds_read_b32 v225, v23 offset:64
 ds_read_b32 v226, v23 offset:128
 ds_read_b32 v227, v23 offset:192
 ds_read_b32 v228, v23 offset:256
 ds_read_b32 v229, v23 offset:320
 ds_read_b32 v230, v23 offset:384
 ds_read_b32 v231, v23 offset:448
 ds_read_b32 v232, v23 offset:512
 ds_read_b32 v233, v23 offset:576
 ds_read_b32 v234, v23 offset:640
 ds_read_b32 v235, v23 offset:704
 ds_read_b32 v236, v23 offset:768
 ds_read_b32 v237, v23 offset:832
 ds_read_b32 v238, v23 offset:896
 ds_read_b32 v239, v23 offset:960
 v_mov_b32 v240, 0
 v_mov_b32 v241, 0
 v_mov_b32 v242, 0
 v_mov_b32 v243, 0
 v_mov_b32 v244, 0
 v_mov_b32 v245, 0
 v_mov_b32 v246, 0
 v_mov_b32 v247, 0
 v_mov_b32 v248, 0
 v_mov_b32 v249, 0
 v_mov_b32 v250, 0
 v_mov_b32 v251, 0
 v_mov_b32 v252, 0
 v_mov_b32 v253, 0
 v_mov_b32 v254, 0
 v_mov_b32 v255, 0
 s_waitcnt lgkmcnt(0)
 s_waitcnt vmcnt(7)
 v_lshlrev_b32 v25, 16, v32
 v_and_b32 v26, 0xffff0000, v32
 v_fmac_f32 v240, v25, v224
 v_fmac_f32 v241, v26, v224
 v_fmac_f32 v248, v25, v232
 v_fmac_f32 v249, v26, v232
 v_lshlrev_b32 v25, 16, v33
 v_and_b32 v26, 0xffff0000, v33
 v_fmac_f32 v242, v25, v224
 v_fmac_f32 v243, v26, v224
 v_fmac_f32 v250, v25, v232
 v_fmac_f32 v251, v26, v232
 v_lshlrev_b32 v25, 16, v34
 v_and_b32 v26, 0xffff0000, v34
 v_fmac_f32 v244, v25, v224
 v_fmac_f32 v245, v26, v224
 v_fmac_f32 v252, v25, v232
 v_fmac_f32 v253, v26, v232
 v_lshlrev_b32 v25, 16, v35
 v_and_b32 v26, 0xffff0000, v35
 v_fmac_f32 v246, v25, v224
 v_fmac_f32 v247, v26, v224
 v_fmac_f32 v254, v25, v232
 v_fmac_f32 v255, v26, v232
 s_waitcnt vmcnt(6)
 v_lshlrev_b32 v25, 16, v36
 v_and_b32 v26, 0xffff0000, v36
 v_fmac_f32 v240, v25, v225
 v_fmac_f32 v241, v26, v225
 v_fmac_f32 v248, v25, v233
 v_fmac_f32 v249, v26, v233
 v_lshlrev_b32 v25, 16, v37
 v_and_b32 v26, 0xffff0000, v37
 v_fmac_f32 v242, v25, v225
 v_fmac_f32 v243, v26, v225
 v_fmac_f32 v250, v25, v233
 v_fmac_f32 v251, v26, v233
 v_lshlrev_b32 v25, 16, v38
 v_and_b32 v26, 0xffff0000, v38
 v_fmac_f32 v244, v25, v225
 v_fmac_f32 v245, v26, v225
 v_fmac_f32 v252, v25, v233
 v_fmac_f32 v253, v26, v233
 v_lshlrev_b32 v25, 16, v39
 v_and_b32 v26, 0xffff0000, v39
 v_fmac_f32 v246, v25, v225
 v_fmac_f32 v247, v26, v225
 v_fmac_f32 v254, v25, v233
 v_fmac_f32 v255, v26, v233
 s_waitcnt vmcnt(5)
 v_lshlrev_b32 v25, 16, v40
 v_and_b32 v26, 0xffff0000, v40
 v_fmac_f32 v240, v25, v226
 v_fmac_f32 v241, v26, v226
 v_fmac_f32 v248, v25, v234
 v_fmac_f32 v249, v26, v234
 v_lshlrev_b32 v25, 16, v41
 v_and_b32 v26, 0xffff0000, v41
 v_fmac_f32 v242, v25, v226
 v_fmac_f32 v243, v26, v226
 v_fmac_f32 v250, v25, v234
 v_fmac_f32 v251, v26, v234
 v_lshlrev_b32 v25, 16, v42
 v_and_b32 v26, 0xffff0000, v42
 v_fmac_f32 v244, v25, v226
 v_fmac_f32 v245, v26, v226
 v_fmac_f32 v252, v25, v234
 v_fmac_f32 v253, v26, v234
 v_lshlrev_b32 v25, 16, v43
 v_and_b32 v26, 0xffff0000, v43
 v_fmac_f32 v246, v25, v226
 v_fmac_f32 v247, v26, v226
 v_fmac_f32 v254, v25, v234
 v_fmac_f32 v255, v26, v234
 s_waitcnt vmcnt(4)
 v_lshlrev_b32 v25, 16, v44
 v_and_b32 v26, 0xffff0000, v44
 v_fmac_f32 v240, v25, v227
 v_fmac_f32 v241, v26, v227
 v_fmac_f32 v248, v25, v235
 v_fmac_f32 v249, v26, v235
 v_lshlrev_b32 v25, 16, v45
 v_and_b32 v26, 0xffff0000, v45
 v_fmac_f32 v242, v25, v227
 v_fmac_f32 v243, v26, v227
 v_fmac_f32 v250, v25, v235
 v_fmac_f32 v251, v26, v235
 v_lshlrev_b32 v25, 16, v46
 v_and_b32 v26, 0xffff0000, v46
 v_fmac_f32 v244, v25, v227
 v_fmac_f32 v245, v26, v227
 v_fmac_f32 v252, v25, v235
 v_fmac_f32 v253, v26, v235
 v_lshlrev_b32 v25, 16, v47
 v_and_b32 v26, 0xffff0000, v47
 v_fmac_f32 v246, v25, v227
 v_fmac_f32 v247, v26, v227
 v_fmac_f32 v254, v25, v235
 v_fmac_f32 v255, v26, v235
 s_waitcnt vmcnt(3)
 v_lshlrev_b32 v25, 16, v48
 v_and_b32 v26, 0xffff0000, v48
 v_fmac_f32 v240, v25, v228
 v_fmac_f32 v241, v26, v228
 v_fmac_f32 v248, v25, v236
 v_fmac_f32 v249, v26, v236
 v_lshlrev_b32 v25, 16, v49
 v_and_b32 v26, 0xffff0000, v49
 v_fmac_f32 v242, v25, v228
 v_fmac_f32 v243, v26, v228
 v_fmac_f32 v250, v25, v236
 v_fmac_f32 v251, v26, v236
 v_lshlrev_b32 v25, 16, v50
 v_and_b32 v26, 0xffff0000, v50
 v_fmac_f32 v244, v25, v228
 v_fmac_f32 v245, v26, v228
 v_fmac_f32 v252, v25, v236
 v_fmac_f32 v253, v26, v236
 v_lshlrev_b32 v25, 16, v51
 v_and_b32 v26, 0xffff0000, v51
 v_fmac_f32 v246, v25, v228
 v_fmac_f32 v247, v26, v228
 v_fmac_f32 v254, v25, v236
 v_fmac_f32 v255, v26, v236
 s_waitcnt vmcnt(2)
 v_lshlrev_b32 v25, 16, v52
 v_and_b32 v26, 0xffff0000, v52
 v_fmac_f32 v240, v25, v229
 v_fmac_f32 v241, v26, v229
 v_fmac_f32 v248, v25, v237
 v_fmac_f32 v249, v26, v237
 v_lshlrev_b32 v25, 16, v53
 v_and_b32 v26, 0xffff0000, v53
 v_fmac_f32 v242, v25, v229
 v_fmac_f32 v243, v26, v229
 v_fmac_f32 v250, v25, v237
 v_fmac_f32 v251, v26, v237
 v_lshlrev_b32 v25, 16, v54
 v_and_b32 v26, 0xffff0000, v54
 v_fmac_f32 v244, v25, v229
 v_fmac_f32 v245, v26, v229
 v_fmac_f32 v252, v25, v237
 v_fmac_f32 v253, v26, v237
 v_lshlrev_b32 v25, 16, v55
 v_and_b32 v26, 0xffff0000, v55
 v_fmac_f32 v246, v25, v229
 v_fmac_f32 v247, v26, v229
 v_fmac_f32 v254, v25, v237
 v_fmac_f32 v255, v26, v237
 s_waitcnt vmcnt(1)
 v_lshlrev_b32 v25, 16, v56
 v_and_b32 v26, 0xffff0000, v56
 v_fmac_f32 v240, v25, v230
 v_fmac_f32 v241, v26, v230
 v_fmac_f32 v248, v25, v238
 v_fmac_f32 v249, v26, v238
 v_lshlrev_b32 v25, 16, v57
 v_and_b32 v26, 0xffff0000, v57
 v_fmac_f32 v242, v25, v230
 v_fmac_f32 v243, v26, v230
 v_fmac_f32 v250, v25, v238
 v_fmac_f32 v251, v26, v238
 v_lshlrev_b32 v25, 16, v58
 v_and_b32 v26, 0xffff0000, v58
 v_fmac_f32 v244, v25, v230
 v_fmac_f32 v245, v26, v230
 v_fmac_f32 v252, v25, v238
 v_fmac_f32 v253, v26, v238
 v_lshlrev_b32 v25, 16, v59
 v_and_b32 v26, 0xffff0000, v59
 v_fmac_f32 v246, v25, v230
 v_fmac_f32 v247, v26, v230
 v_fmac_f32 v254, v25, v238
 v_fmac_f32 v255, v26, v238
 s_waitcnt vmcnt(0)
 v_lshlrev_b32 v25, 16, v60
 v_and_b32 v26, 0xffff0000, v60
 v_fmac_f32 v240, v25, v231
 v_fmac_f32 v241, v26, v231
 v_fmac_f32 v248, v25, v239
 v_fmac_f32 v249, v26, v239
 v_lshlrev_b32 v25, 16, v61
 v_and_b32 v26, 0xffff0000, v61
 v_fmac_f32 v242, v25, v231
 v_fmac_f32 v243, v26, v231
 v_fmac_f32 v250, v25, v239
 v_fmac_f32 v251, v26, v239
 v_lshlrev_b32 v25, 16, v62
 v_and_b32 v26, 0xffff0000, v62
 v_fmac_f32 v244, v25, v231
 v_fmac_f32 v245, v26, v231
 v_fmac_f32 v252, v25, v239
 v_fmac_f32 v253, v26, v239
 v_lshlrev_b32 v25, 16, v63
 v_and_b32 v26, 0xffff0000, v63
 v_fmac_f32 v246, v25, v231
 v_fmac_f32 v247, v26, v231
 v_fmac_f32 v254, v25, v239
 v_fmac_f32 v255, v26, v239
 v_mov_b32 v208, v240
 v_mov_b32 v209, v241
 v_mov_b32 v210, v242
 v_mov_b32 v211, v243
 v_mov_b32 v212, v244
 v_mov_b32 v213, v245
 v_mov_b32 v214, v246
 v_mov_b32 v215, v247
 v_mov_b32 v216, v248
 v_mov_b32 v217, v249
 v_mov_b32 v218, v250
 v_mov_b32 v219, v251
 v_mov_b32 v220, v252
 v_mov_b32 v221, v253
 v_mov_b32 v222, v254
 v_mov_b32 v223, v255
 v_permlane16_swap_b32 v240, v208
 v_permlane16_swap_b32 v241, v209
 v_permlane16_swap_b32 v242, v210
 v_permlane16_swap_b32 v243, v211
 v_permlane16_swap_b32 v244, v212
 v_permlane16_swap_b32 v245, v213
 v_permlane16_swap_b32 v246, v214
 v_permlane16_swap_b32 v247, v215
 v_permlane16_swap_b32 v248, v216
 v_permlane16_swap_b32 v249, v217
 v_permlane16_swap_b32 v250, v218
 v_permlane16_swap_b32 v251, v219
 v_permlane16_swap_b32 v252, v220
 v_permlane16_swap_b32 v253, v221
 v_permlane16_swap_b32 v254, v222
 v_permlane16_swap_b32 v255, v223
 v_add_f32 v240, v240, v208
 v_add_f32 v241, v241, v209
 v_add_f32 v242, v242, v210
 v_add_f32 v243, v243, v211
 v_add_f32 v244, v244, v212
 v_add_f32 v245, v245, v213
 v_add_f32 v246, v246, v214
 v_add_f32 v247, v247, v215
 v_add_f32 v248, v248, v216
 v_add_f32 v249, v249, v217
 v_add_f32 v250, v250, v218
 v_add_f32 v251, v251, v219
 v_add_f32 v252, v252, v220
 v_add_f32 v253, v253, v221
 v_add_f32 v254, v254, v222
 v_add_f32 v255, v255, v223
 v_mov_b32 v208, v240
 v_mov_b32 v209, v241
 v_mov_b32 v210, v242
 v_mov_b32 v211, v243
 v_mov_b32 v212, v244
 v_mov_b32 v213, v245
 v_mov_b32 v214, v246
 v_mov_b32 v215, v247
 v_mov_b32 v216, v248
 v_mov_b32 v217, v249
 v_mov_b32 v218, v250
 v_mov_b32 v219, v251
 v_mov_b32 v220, v252
 v_mov_b32 v221, v253
 v_mov_b32 v222, v254
 v_mov_b32 v223, v255
 v_permlane32_swap_b32 v240, v208
 v_permlane32_swap_b32 v241, v209
 v_permlane32_swap_b32 v242, v210
 v_permlane32_swap_b32 v243, v211
 v_permlane32_swap_b32 v244, v212
 v_permlane32_swap_b32 v245, v213
 v_permlane32_swap_b32 v246, v214
 v_permlane32_swap_b32 v247, v215
 v_permlane32_swap_b32 v248, v216
 v_permlane32_swap_b32 v249, v217
 v_permlane32_swap_b32 v250, v218
 v_permlane32_swap_b32 v251, v219
 v_permlane32_swap_b32 v252, v220
 v_permlane32_swap_b32 v253, v221
 v_permlane32_swap_b32 v254, v222
 v_permlane32_swap_b32 v255, v223
 v_add_f32 v240, v240, v208
 v_add_f32 v241, v241, v209
 v_add_f32 v242, v242, v210
 v_add_f32 v243, v243, v211
 v_add_f32 v244, v244, v212
 v_add_f32 v245, v245, v213
 v_add_f32 v246, v246, v214
 v_add_f32 v247, v247, v215
 v_add_f32 v248, v248, v216
 v_add_f32 v249, v249, v217
 v_add_f32 v250, v250, v218
 v_add_f32 v251, v251, v219
 v_add_f32 v252, v252, v220
 v_add_f32 v253, v253, v221
 v_add_f32 v254, v254, v222
 v_add_f32 v255, v255, v223
 v_lshlrev_b32 v24, 5, v20
 s_lshl_b32 s52, s30, 9
 s_add_u32 s52, s52, 133120
 v_add_u32 v24, s52, v24
 v_cmp_gt_u32 vcc, 16, v1
 s_and_saveexec_b64 s[54:55], vcc
 ds_write_b128 v24, v[240:243] offset:0
 ds_write_b128 v24, v[244:247] offset:16
 ds_write_b128 v24, v[248:251] offset:2048
 ds_write_b128 v24, v[252:255] offset:2064
 s_mov_b64 exec, s[54:55]
 s_waitcnt lgkmcnt(0)
 s_barrier
 v_and_b32 v24, 127, v0
 v_lshlrev_b32 v24, 2, v24
 v_lshrrev_b32 v25, 7, v0
 v_lshl_add_u32 v24, v25, 11, v24
 v_add_u32 v24, 133120, v24
 ds_read_b32 v28, v24 offset:0
 ds_read_b32 v29, v24 offset:512
 ds_read_b32 v30, v24 offset:1024
 ds_read_b32 v31, v24 offset:1536
 s_waitcnt lgkmcnt(0)
 v_add_f32 v28, v28, v29
 v_add_f32 v30, v30, v31
 v_add_f32 v27, v28, v30
 s_mul_i32 s50, s48, 28672
 s_lshl_b32 s51, s49, 9
 s_add_u32 s50, s50, s51
 s_add_u32 s50, s50, 51904512
 v_and_b32 v24, 127, v0
 v_lshlrev_b32 v24, 2, v24
 v_lshrrev_b32 v25, 7, v0
 s_mov_b32 s52, 14336
 v_mul_lo_u32 v25, v25, s52
 v_add_u32 v24, v24, v25
 buffer_store_dword v27, v24, s[8:11], s50 offen sc1
 s_branch main_kernel_nouv2
main_kernel_nouv:
 s_waitcnt vmcnt(0)
main_kernel_nouv2:
 v_lshlrev_b32 v40, 4, v1
 s_mul_i32 s29, s35, 131072
 v_add_u32 v12, s29, v40
 s_add_u32 s29, s29, 131072
 v_add_u32 v13, s29, v40
 v_mov_b32 v128, 0
 v_mov_b32 v129, 0
 v_mov_b32 v130, 0
 v_mov_b32 v131, 0
 v_mov_b32 v132, 0
 v_mov_b32 v133, 0
 v_mov_b32 v134, 0
 v_mov_b32 v135, 0
 v_mov_b32 v136, 0
 v_mov_b32 v137, 0
 v_mov_b32 v138, 0
 v_mov_b32 v139, 0
 v_mov_b32 v140, 0
 v_mov_b32 v141, 0
 v_mov_b32 v142, 0
 v_mov_b32 v143, 0
 v_mov_b32 v144, 0
 v_mov_b32 v145, 0
 v_mov_b32 v146, 0
 v_mov_b32 v147, 0
 v_mov_b32 v148, 0
 v_mov_b32 v149, 0
 v_mov_b32 v150, 0
 v_mov_b32 v151, 0
 v_mov_b32 v152, 0
 v_mov_b32 v153, 0
 v_mov_b32 v154, 0
 v_mov_b32 v155, 0
 v_mov_b32 v156, 0
 v_mov_b32 v157, 0
 v_mov_b32 v158, 0
 v_mov_b32 v159, 0
 v_mov_b32 v160, 0
 v_mov_b32 v161, 0
 v_mov_b32 v162, 0
 v_mov_b32 v163, 0
 v_mov_b32 v164, 0
 v_mov_b32 v165, 0
 v_mov_b32 v166, 0
 v_mov_b32 v167, 0
 v_mov_b32 v168, 0
 v_mov_b32 v169, 0
 v_mov_b32 v170, 0
 v_mov_b32 v171, 0
 v_mov_b32 v172, 0
 v_mov_b32 v173, 0
 v_mov_b32 v174, 0
 v_mov_b32 v175, 0
 v_mov_b32 v176, 0
 v_mov_b32 v177, 0
 v_mov_b32 v178, 0
 v_mov_b32 v179, 0
 v_mov_b32 v180, 0
 v_mov_b32 v181, 0
 v_mov_b32 v182, 0
 v_mov_b32 v183, 0
 v_mov_b32 v184, 0
 v_mov_b32 v185, 0
 v_mov_b32 v186, 0
 v_mov_b32 v187, 0
 v_mov_b32 v188, 0
 v_mov_b32 v189, 0
 v_mov_b32 v190, 0
 v_mov_b32 v191, 0
 s_lshr_b32 s40, s31, 1
 s_lshl_b32 s40, s40, 1
 s_add_u32 s40, s40, s69
 s_cmp_eq_u32 s30, 0
 s_cbranch_scc0 w0_6
 s_lshl_b32 s78, s40, 7
 s_add_u32 s78, s78, 52692992
 v_mov_b32 v31, 0
 s_mov_b64 exec, 1
 s_mov_b32 s76, 0
pl_7:
 buffer_load_dword v30, v31, s[8:11], s78 offen sc1
 s_waitcnt vmcnt(0)
 v_readfirstlane_b32 s77, v30
 s_add_u32 s76, s76, 1
 s_cmp_ge_u32 s77, 16
 s_cbranch_scc1 pd_8
 s_cmp_lt_u32 s76, 0x40000
 s_cbranch_scc1 pl_7
pd_8:
 s_mov_b64 exec, -1
w0_6:
 s_barrier
 s_add_u32 s26, s72, 0x800000
 buffer_load_dwordx4 a[0:3], v12, s[8:11], s26 offen sc1
 buffer_load_dwordx4 a[4:7], v13, s[8:11], s26 offen sc1
 buffer_load_dwordx4 a[8:11], v12, s[8:11], s26 offen offset:1024 sc1
 buffer_load_dwordx4 a[12:15], v13, s[8:11], s26 offen offset:1024 sc1
 buffer_load_dwordx4 a[16:19], v12, s[8:11], s26 offen offset:2048 sc1
 buffer_load_dwordx4 a[20:23], v13, s[8:11], s26 offen offset:2048 sc1
 buffer_load_dwordx4 a[24:27], v12, s[8:11], s26 offen offset:3072 sc1
 buffer_load_dwordx4 a[28:31], v13, s[8:11], s26 offen offset:3072 sc1
 s_add_u32 s26, s26, 4096
 buffer_load_dwordx4 a[32:35], v12, s[8:11], s26 offen sc1
 buffer_load_dwordx4 a[36:39], v13, s[8:11], s26 offen sc1
 buffer_load_dwordx4 a[40:43], v12, s[8:11], s26 offen offset:1024 sc1
 buffer_load_dwordx4 a[44:47], v13, s[8:11], s26 offen offset:1024 sc1
 buffer_load_dwordx4 a[48:51], v12, s[8:11], s26 offen offset:2048 sc1
 buffer_load_dwordx4 a[52:55], v13, s[8:11], s26 offen offset:2048 sc1
 s_add_u32 m0, s27, 49152
 s_mov_b32 s28, 0
 s_waitcnt vmcnt(8)
 s_barrier
 ds_read_b64_tr_b16 a[128:129], v4 offset:0
 ds_read_b64_tr_b16 a[130:131], v4 offset:4096
 ds_read_b64_tr_b16 a[132:133], v5 offset:0
 ds_read_b64_tr_b16 a[134:135], v5 offset:4096
 ds_read_b64_tr_b16 a[136:137], v6 offset:0
 ds_read_b64_tr_b16 a[138:139], v6 offset:4096
 ds_read_b64_tr_b16 a[140:141], v7 offset:0
 ds_read_b64_tr_b16 a[142:143], v7 offset:4096
 ds_read_b64_tr_b16 a[144:145], v8 offset:0
 ds_read_b64_tr_b16 a[146:147], v8 offset:4096
 ds_read_b64_tr_b16 a[148:149], v9 offset:0
 ds_read_b64_tr_b16 a[150:151], v9 offset:4096
 ds_read_b64_tr_b16 a[152:153], v10 offset:0
 ds_read_b64_tr_b16 a[154:155], v10 offset:4096
 ds_read_b64_tr_b16 a[156:157], v11 offset:0
 ds_read_b64_tr_b16 a[158:159], v11 offset:4096
wo_loop:
 s_waitcnt vmcnt(26) lgkmcnt(0)
 v_mfma_f32_16x16x32_bf16 v[128:131], a[128:131], a[0:3], v[128:131]
 ds_read_b64_tr_b16 a[160:161], v4 offset:8192
 ds_read_b64_tr_b16 a[162:163], v4 offset:12288
 v_mfma_f32_16x16x32_bf16 v[132:135], a[128:131], a[4:7], v[132:135]
 ds_read_b64_tr_b16 a[164:165], v5 offset:8192
 v_mfma_f32_16x16x32_bf16 v[140:143], a[132:135], a[4:7], v[140:143]
 ds_read_b64_tr_b16 a[166:167], v5 offset:12288
 v_mfma_f32_16x16x32_bf16 v[136:139], a[132:135], a[0:3], v[136:139]
 ds_read_b64_tr_b16 a[168:169], v6 offset:8192
 ds_read_b64_tr_b16 a[170:171], v6 offset:12288
 v_mfma_f32_16x16x32_bf16 v[144:147], a[136:139], a[0:3], v[144:147]
 ds_read_b64_tr_b16 a[172:173], v7 offset:8192
 v_mfma_f32_16x16x32_bf16 v[148:151], a[136:139], a[4:7], v[148:151]
 ds_read_b64_tr_b16 a[174:175], v7 offset:12288
 v_mfma_f32_16x16x32_bf16 v[156:159], a[140:143], a[4:7], v[156:159]
 ds_read_b64_tr_b16 a[176:177], v8 offset:8192
 ds_read_b64_tr_b16 a[178:179], v8 offset:12288
 v_mfma_f32_16x16x32_bf16 v[152:155], a[140:143], a[0:3], v[152:155]
 ds_read_b64_tr_b16 a[180:181], v9 offset:8192
 v_mfma_f32_16x16x32_bf16 v[160:163], a[144:147], a[0:3], v[160:163]
 ds_read_b64_tr_b16 a[182:183], v9 offset:12288
 buffer_load_dwordx4 a[56:59], v12, s[8:11], s26 offen offset:3072 sc1
 v_mfma_f32_16x16x32_bf16 v[164:167], a[144:147], a[4:7], v[164:167]
 ds_read_b64_tr_b16 a[184:185], v10 offset:8192
 ds_read_b64_tr_b16 a[186:187], v10 offset:12288
 v_mfma_f32_16x16x32_bf16 v[172:175], a[148:151], a[4:7], v[172:175]
 ds_read_b64_tr_b16 a[188:189], v11 offset:8192
 buffer_load_dwordx4 a[60:63], v13, s[8:11], s26 offen offset:3072 sc1
 s_add_u32 s26, s26, 4096
 v_mfma_f32_16x16x32_bf16 v[168:171], a[148:151], a[0:3], v[168:171]
 ds_read_b64_tr_b16 a[190:191], v11 offset:12288
 v_mfma_f32_16x16x32_bf16 v[176:179], a[152:155], a[0:3], v[176:179]
 s_add_u32 s29, s20, 14336
 buffer_load_dwordx4 v2, s[12:15], s29 offen offset:2048 lds
 v_mfma_f32_16x16x32_bf16 v[180:183], a[152:155], a[4:7], v[180:183]
 v_mfma_f32_16x16x32_bf16 v[188:191], a[156:159], a[4:7], v[188:191]
 s_add_u32 s29, s20, 21504
 buffer_load_dwordx4 v3, s[12:15], s29 offen offset:3072 lds
 s_add_u32 s20, s20, 131072
 v_mfma_f32_16x16x32_bf16 v[184:187], a[156:159], a[0:3], v[184:187]
 s_waitcnt vmcnt(16) lgkmcnt(0)
 s_barrier
 v_mfma_f32_16x16x32_bf16 v[128:131], a[160:163], a[8:11], v[128:131]
 ds_read_b64_tr_b16 a[128:129], v4 offset:16384
 ds_read_b64_tr_b16 a[130:131], v4 offset:20480
 v_mfma_f32_16x16x32_bf16 v[132:135], a[160:163], a[12:15], v[132:135]
 ds_read_b64_tr_b16 a[132:133], v5 offset:16384
 v_mfma_f32_16x16x32_bf16 v[140:143], a[164:167], a[12:15], v[140:143]
 ds_read_b64_tr_b16 a[134:135], v5 offset:20480
 v_mfma_f32_16x16x32_bf16 v[136:139], a[164:167], a[8:11], v[136:139]
 ds_read_b64_tr_b16 a[136:137], v6 offset:16384
 ds_read_b64_tr_b16 a[138:139], v6 offset:20480
 v_mfma_f32_16x16x32_bf16 v[144:147], a[168:171], a[8:11], v[144:147]
 ds_read_b64_tr_b16 a[140:141], v7 offset:16384
 v_mfma_f32_16x16x32_bf16 v[148:151], a[168:171], a[12:15], v[148:151]
 ds_read_b64_tr_b16 a[142:143], v7 offset:20480
 v_mfma_f32_16x16x32_bf16 v[156:159], a[172:175], a[12:15], v[156:159]
 ds_read_b64_tr_b16 a[144:145], v8 offset:16384
 ds_read_b64_tr_b16 a[146:147], v8 offset:20480
 v_mfma_f32_16x16x32_bf16 v[152:155], a[172:175], a[8:11], v[152:155]
 ds_read_b64_tr_b16 a[148:149], v9 offset:16384
 v_mfma_f32_16x16x32_bf16 v[160:163], a[176:179], a[8:11], v[160:163]
 ds_read_b64_tr_b16 a[150:151], v9 offset:20480
 buffer_load_dwordx4 a[0:3], v12, s[8:11], s26 offen sc1
 v_mfma_f32_16x16x32_bf16 v[164:167], a[176:179], a[12:15], v[164:167]
 ds_read_b64_tr_b16 a[152:153], v10 offset:16384
 ds_read_b64_tr_b16 a[154:155], v10 offset:20480
 v_mfma_f32_16x16x32_bf16 v[172:175], a[180:183], a[12:15], v[172:175]
 ds_read_b64_tr_b16 a[156:157], v11 offset:16384
 buffer_load_dwordx4 a[4:7], v13, s[8:11], s26 offen sc1
 v_mfma_f32_16x16x32_bf16 v[168:171], a[180:183], a[8:11], v[168:171]
 ds_read_b64_tr_b16 a[158:159], v11 offset:20480
 v_mfma_f32_16x16x32_bf16 v[176:179], a[184:187], a[8:11], v[176:179]
 s_add_u32 m0, s27, 0
 s_nop 0
 buffer_load_dwordx4 v2, s[12:15], s20 offen lds
 v_mfma_f32_16x16x32_bf16 v[180:183], a[184:187], a[12:15], v[180:183]
 v_mfma_f32_16x16x32_bf16 v[188:191], a[188:191], a[12:15], v[188:191]
 s_add_u32 s29, s20, 7168
 buffer_load_dwordx4 v3, s[12:15], s29 offen offset:1024 lds
 v_mfma_f32_16x16x32_bf16 v[184:187], a[188:191], a[8:11], v[184:187]
 s_waitcnt vmcnt(26) lgkmcnt(0)
 v_mfma_f32_16x16x32_bf16 v[128:131], a[128:131], a[16:19], v[128:131]
 ds_read_b64_tr_b16 a[160:161], v4 offset:24576
 ds_read_b64_tr_b16 a[162:163], v4 offset:28672
 v_mfma_f32_16x16x32_bf16 v[132:135], a[128:131], a[20:23], v[132:135]
 ds_read_b64_tr_b16 a[164:165], v5 offset:24576
 v_mfma_f32_16x16x32_bf16 v[140:143], a[132:135], a[20:23], v[140:143]
 ds_read_b64_tr_b16 a[166:167], v5 offset:28672
 v_mfma_f32_16x16x32_bf16 v[136:139], a[132:135], a[16:19], v[136:139]
 ds_read_b64_tr_b16 a[168:169], v6 offset:24576
 ds_read_b64_tr_b16 a[170:171], v6 offset:28672
 v_mfma_f32_16x16x32_bf16 v[144:147], a[136:139], a[16:19], v[144:147]
 ds_read_b64_tr_b16 a[172:173], v7 offset:24576
 v_mfma_f32_16x16x32_bf16 v[148:151], a[136:139], a[20:23], v[148:151]
 ds_read_b64_tr_b16 a[174:175], v7 offset:28672
 v_mfma_f32_16x16x32_bf16 v[156:159], a[140:143], a[20:23], v[156:159]
 ds_read_b64_tr_b16 a[176:177], v8 offset:24576
 ds_read_b64_tr_b16 a[178:179], v8 offset:28672
 v_mfma_f32_16x16x32_bf16 v[152:155], a[140:143], a[16:19], v[152:155]
 ds_read_b64_tr_b16 a[180:181], v9 offset:24576
 v_mfma_f32_16x16x32_bf16 v[160:163], a[144:147], a[16:19], v[160:163]
 ds_read_b64_tr_b16 a[182:183], v9 offset:28672
 buffer_load_dwordx4 a[8:11], v12, s[8:11], s26 offen offset:1024 sc1
 v_mfma_f32_16x16x32_bf16 v[164:167], a[144:147], a[20:23], v[164:167]
 ds_read_b64_tr_b16 a[184:185], v10 offset:24576
 ds_read_b64_tr_b16 a[186:187], v10 offset:28672
 v_mfma_f32_16x16x32_bf16 v[172:175], a[148:151], a[20:23], v[172:175]
 ds_read_b64_tr_b16 a[188:189], v11 offset:24576
 buffer_load_dwordx4 a[12:15], v13, s[8:11], s26 offen offset:1024 sc1
 v_mfma_f32_16x16x32_bf16 v[168:171], a[148:151], a[16:19], v[168:171]
 ds_read_b64_tr_b16 a[190:191], v11 offset:28672
 v_mfma_f32_16x16x32_bf16 v[176:179], a[152:155], a[16:19], v[176:179]
 s_add_u32 s29, s20, 14336
 buffer_load_dwordx4 v2, s[12:15], s29 offen offset:2048 lds
 v_mfma_f32_16x16x32_bf16 v[180:183], a[152:155], a[20:23], v[180:183]
 v_mfma_f32_16x16x32_bf16 v[188:191], a[156:159], a[20:23], v[188:191]
 s_add_u32 s29, s20, 21504
 buffer_load_dwordx4 v3, s[12:15], s29 offen offset:3072 lds
 s_add_u32 s20, s20, 131072
 v_mfma_f32_16x16x32_bf16 v[184:187], a[156:159], a[16:19], v[184:187]
 s_waitcnt vmcnt(16) lgkmcnt(0)
 s_barrier
 v_mfma_f32_16x16x32_bf16 v[128:131], a[160:163], a[24:27], v[128:131]
 ds_read_b64_tr_b16 a[128:129], v4 offset:32768
 ds_read_b64_tr_b16 a[130:131], v4 offset:36864
 v_mfma_f32_16x16x32_bf16 v[132:135], a[160:163], a[28:31], v[132:135]
 ds_read_b64_tr_b16 a[132:133], v5 offset:32768
 v_mfma_f32_16x16x32_bf16 v[140:143], a[164:167], a[28:31], v[140:143]
 ds_read_b64_tr_b16 a[134:135], v5 offset:36864
 v_mfma_f32_16x16x32_bf16 v[136:139], a[164:167], a[24:27], v[136:139]
 ds_read_b64_tr_b16 a[136:137], v6 offset:32768
 ds_read_b64_tr_b16 a[138:139], v6 offset:36864
 v_mfma_f32_16x16x32_bf16 v[144:147], a[168:171], a[24:27], v[144:147]
 ds_read_b64_tr_b16 a[140:141], v7 offset:32768
 v_mfma_f32_16x16x32_bf16 v[148:151], a[168:171], a[28:31], v[148:151]
 ds_read_b64_tr_b16 a[142:143], v7 offset:36864
 v_mfma_f32_16x16x32_bf16 v[156:159], a[172:175], a[28:31], v[156:159]
 ds_read_b64_tr_b16 a[144:145], v8 offset:32768
 ds_read_b64_tr_b16 a[146:147], v8 offset:36864
 v_mfma_f32_16x16x32_bf16 v[152:155], a[172:175], a[24:27], v[152:155]
 ds_read_b64_tr_b16 a[148:149], v9 offset:32768
 v_mfma_f32_16x16x32_bf16 v[160:163], a[176:179], a[24:27], v[160:163]
 ds_read_b64_tr_b16 a[150:151], v9 offset:36864
 buffer_load_dwordx4 a[16:19], v12, s[8:11], s26 offen offset:2048 sc1
 v_mfma_f32_16x16x32_bf16 v[164:167], a[176:179], a[28:31], v[164:167]
 ds_read_b64_tr_b16 a[152:153], v10 offset:32768
 ds_read_b64_tr_b16 a[154:155], v10 offset:36864
 v_mfma_f32_16x16x32_bf16 v[172:175], a[180:183], a[28:31], v[172:175]
 ds_read_b64_tr_b16 a[156:157], v11 offset:32768
 buffer_load_dwordx4 a[20:23], v13, s[8:11], s26 offen offset:2048 sc1
 v_mfma_f32_16x16x32_bf16 v[168:171], a[180:183], a[24:27], v[168:171]
 ds_read_b64_tr_b16 a[158:159], v11 offset:36864
 v_mfma_f32_16x16x32_bf16 v[176:179], a[184:187], a[24:27], v[176:179]
 s_add_u32 m0, s27, 16384
 s_nop 0
 buffer_load_dwordx4 v2, s[12:15], s20 offen lds
 v_mfma_f32_16x16x32_bf16 v[180:183], a[184:187], a[28:31], v[180:183]
 v_mfma_f32_16x16x32_bf16 v[188:191], a[188:191], a[28:31], v[188:191]
 s_add_u32 s29, s20, 7168
 buffer_load_dwordx4 v3, s[12:15], s29 offen offset:1024 lds
 v_mfma_f32_16x16x32_bf16 v[184:187], a[188:191], a[24:27], v[184:187]
 s_waitcnt vmcnt(26) lgkmcnt(0)
 v_mfma_f32_16x16x32_bf16 v[128:131], a[128:131], a[32:35], v[128:131]
 ds_read_b64_tr_b16 a[160:161], v4 offset:40960
 ds_read_b64_tr_b16 a[162:163], v4 offset:45056
 v_mfma_f32_16x16x32_bf16 v[132:135], a[128:131], a[36:39], v[132:135]
 ds_read_b64_tr_b16 a[164:165], v5 offset:40960
 v_mfma_f32_16x16x32_bf16 v[140:143], a[132:135], a[36:39], v[140:143]
 ds_read_b64_tr_b16 a[166:167], v5 offset:45056
 v_mfma_f32_16x16x32_bf16 v[136:139], a[132:135], a[32:35], v[136:139]
 ds_read_b64_tr_b16 a[168:169], v6 offset:40960
 ds_read_b64_tr_b16 a[170:171], v6 offset:45056
 v_mfma_f32_16x16x32_bf16 v[144:147], a[136:139], a[32:35], v[144:147]
 ds_read_b64_tr_b16 a[172:173], v7 offset:40960
 v_mfma_f32_16x16x32_bf16 v[148:151], a[136:139], a[36:39], v[148:151]
 ds_read_b64_tr_b16 a[174:175], v7 offset:45056
 v_mfma_f32_16x16x32_bf16 v[156:159], a[140:143], a[36:39], v[156:159]
 ds_read_b64_tr_b16 a[176:177], v8 offset:40960
 ds_read_b64_tr_b16 a[178:179], v8 offset:45056
 v_mfma_f32_16x16x32_bf16 v[152:155], a[140:143], a[32:35], v[152:155]
 ds_read_b64_tr_b16 a[180:181], v9 offset:40960
 v_mfma_f32_16x16x32_bf16 v[160:163], a[144:147], a[32:35], v[160:163]
 ds_read_b64_tr_b16 a[182:183], v9 offset:45056
 buffer_load_dwordx4 a[24:27], v12, s[8:11], s26 offen offset:3072 sc1
 v_mfma_f32_16x16x32_bf16 v[164:167], a[144:147], a[36:39], v[164:167]
 ds_read_b64_tr_b16 a[184:185], v10 offset:40960
 ds_read_b64_tr_b16 a[186:187], v10 offset:45056
 v_mfma_f32_16x16x32_bf16 v[172:175], a[148:151], a[36:39], v[172:175]
 ds_read_b64_tr_b16 a[188:189], v11 offset:40960
 buffer_load_dwordx4 a[28:31], v13, s[8:11], s26 offen offset:3072 sc1
 s_add_u32 s26, s26, 4096
 v_mfma_f32_16x16x32_bf16 v[168:171], a[148:151], a[32:35], v[168:171]
 ds_read_b64_tr_b16 a[190:191], v11 offset:45056
 v_mfma_f32_16x16x32_bf16 v[176:179], a[152:155], a[32:35], v[176:179]
 s_add_u32 s29, s20, 14336
 buffer_load_dwordx4 v2, s[12:15], s29 offen offset:2048 lds
 v_mfma_f32_16x16x32_bf16 v[180:183], a[152:155], a[36:39], v[180:183]
 v_mfma_f32_16x16x32_bf16 v[188:191], a[156:159], a[36:39], v[188:191]
 s_add_u32 s29, s20, 21504
 buffer_load_dwordx4 v3, s[12:15], s29 offen offset:3072 lds
 s_add_u32 s20, s20, 131072
 v_mfma_f32_16x16x32_bf16 v[184:187], a[156:159], a[32:35], v[184:187]
 s_waitcnt vmcnt(16) lgkmcnt(0)
 s_barrier
 v_mfma_f32_16x16x32_bf16 v[128:131], a[160:163], a[40:43], v[128:131]
 ds_read_b64_tr_b16 a[128:129], v4 offset:49152
 ds_read_b64_tr_b16 a[130:131], v4 offset:53248
 v_mfma_f32_16x16x32_bf16 v[132:135], a[160:163], a[44:47], v[132:135]
 ds_read_b64_tr_b16 a[132:133], v5 offset:49152
 v_mfma_f32_16x16x32_bf16 v[140:143], a[164:167], a[44:47], v[140:143]
 ds_read_b64_tr_b16 a[134:135], v5 offset:53248
 v_mfma_f32_16x16x32_bf16 v[136:139], a[164:167], a[40:43], v[136:139]
 ds_read_b64_tr_b16 a[136:137], v6 offset:49152
 ds_read_b64_tr_b16 a[138:139], v6 offset:53248
 v_mfma_f32_16x16x32_bf16 v[144:147], a[168:171], a[40:43], v[144:147]
 ds_read_b64_tr_b16 a[140:141], v7 offset:49152
 v_mfma_f32_16x16x32_bf16 v[148:151], a[168:171], a[44:47], v[148:151]
 ds_read_b64_tr_b16 a[142:143], v7 offset:53248
 v_mfma_f32_16x16x32_bf16 v[156:159], a[172:175], a[44:47], v[156:159]
 ds_read_b64_tr_b16 a[144:145], v8 offset:49152
 ds_read_b64_tr_b16 a[146:147], v8 offset:53248
 v_mfma_f32_16x16x32_bf16 v[152:155], a[172:175], a[40:43], v[152:155]
 ds_read_b64_tr_b16 a[148:149], v9 offset:49152
 v_mfma_f32_16x16x32_bf16 v[160:163], a[176:179], a[40:43], v[160:163]
 ds_read_b64_tr_b16 a[150:151], v9 offset:53248
 buffer_load_dwordx4 a[32:35], v12, s[8:11], s26 offen sc1
 v_mfma_f32_16x16x32_bf16 v[164:167], a[176:179], a[44:47], v[164:167]
 ds_read_b64_tr_b16 a[152:153], v10 offset:49152
 ds_read_b64_tr_b16 a[154:155], v10 offset:53248
 v_mfma_f32_16x16x32_bf16 v[172:175], a[180:183], a[44:47], v[172:175]
 ds_read_b64_tr_b16 a[156:157], v11 offset:49152
 buffer_load_dwordx4 a[36:39], v13, s[8:11], s26 offen sc1
 v_mfma_f32_16x16x32_bf16 v[168:171], a[180:183], a[40:43], v[168:171]
 ds_read_b64_tr_b16 a[158:159], v11 offset:53248
 v_mfma_f32_16x16x32_bf16 v[176:179], a[184:187], a[40:43], v[176:179]
 s_add_u32 m0, s27, 32768
 s_nop 0
 buffer_load_dwordx4 v2, s[12:15], s20 offen lds
 v_mfma_f32_16x16x32_bf16 v[180:183], a[184:187], a[44:47], v[180:183]
 v_mfma_f32_16x16x32_bf16 v[188:191], a[188:191], a[44:47], v[188:191]
 s_add_u32 s29, s20, 7168
 buffer_load_dwordx4 v3, s[12:15], s29 offen offset:1024 lds
 v_mfma_f32_16x16x32_bf16 v[184:187], a[188:191], a[40:43], v[184:187]
 s_waitcnt vmcnt(26) lgkmcnt(0)
 v_mfma_f32_16x16x32_bf16 v[128:131], a[128:131], a[48:51], v[128:131]
 ds_read_b64_tr_b16 a[160:161], v4 offset:57344
 ds_read_b64_tr_b16 a[162:163], v4 offset:61440
 v_mfma_f32_16x16x32_bf16 v[132:135], a[128:131], a[52:55], v[132:135]
 ds_read_b64_tr_b16 a[164:165], v5 offset:57344
 v_mfma_f32_16x16x32_bf16 v[140:143], a[132:135], a[52:55], v[140:143]
 ds_read_b64_tr_b16 a[166:167], v5 offset:61440
 v_mfma_f32_16x16x32_bf16 v[136:139], a[132:135], a[48:51], v[136:139]
 ds_read_b64_tr_b16 a[168:169], v6 offset:57344
 ds_read_b64_tr_b16 a[170:171], v6 offset:61440
 v_mfma_f32_16x16x32_bf16 v[144:147], a[136:139], a[48:51], v[144:147]
 ds_read_b64_tr_b16 a[172:173], v7 offset:57344
 v_mfma_f32_16x16x32_bf16 v[148:151], a[136:139], a[52:55], v[148:151]
 ds_read_b64_tr_b16 a[174:175], v7 offset:61440
 v_mfma_f32_16x16x32_bf16 v[156:159], a[140:143], a[52:55], v[156:159]
 ds_read_b64_tr_b16 a[176:177], v8 offset:57344
 ds_read_b64_tr_b16 a[178:179], v8 offset:61440
 v_mfma_f32_16x16x32_bf16 v[152:155], a[140:143], a[48:51], v[152:155]
 ds_read_b64_tr_b16 a[180:181], v9 offset:57344
 v_mfma_f32_16x16x32_bf16 v[160:163], a[144:147], a[48:51], v[160:163]
 ds_read_b64_tr_b16 a[182:183], v9 offset:61440
 buffer_load_dwordx4 a[40:43], v12, s[8:11], s26 offen offset:1024 sc1
 v_mfma_f32_16x16x32_bf16 v[164:167], a[144:147], a[52:55], v[164:167]
 ds_read_b64_tr_b16 a[184:185], v10 offset:57344
 ds_read_b64_tr_b16 a[186:187], v10 offset:61440
 v_mfma_f32_16x16x32_bf16 v[172:175], a[148:151], a[52:55], v[172:175]
 ds_read_b64_tr_b16 a[188:189], v11 offset:57344
 buffer_load_dwordx4 a[44:47], v13, s[8:11], s26 offen offset:1024 sc1
 v_mfma_f32_16x16x32_bf16 v[168:171], a[148:151], a[48:51], v[168:171]
 ds_read_b64_tr_b16 a[190:191], v11 offset:61440
 v_mfma_f32_16x16x32_bf16 v[176:179], a[152:155], a[48:51], v[176:179]
 s_add_u32 s29, s20, 14336
 buffer_load_dwordx4 v2, s[12:15], s29 offen offset:2048 lds
 v_mfma_f32_16x16x32_bf16 v[180:183], a[152:155], a[52:55], v[180:183]
 v_mfma_f32_16x16x32_bf16 v[188:191], a[156:159], a[52:55], v[188:191]
 s_add_u32 s29, s20, 21504
 buffer_load_dwordx4 v3, s[12:15], s29 offen offset:3072 lds
 s_add_u32 s20, s20, 131072
 v_mfma_f32_16x16x32_bf16 v[184:187], a[156:159], a[48:51], v[184:187]
 s_waitcnt vmcnt(16) lgkmcnt(0)
 s_barrier
 v_mfma_f32_16x16x32_bf16 v[128:131], a[160:163], a[56:59], v[128:131]
 ds_read_b64_tr_b16 a[128:129], v4 offset:0
 ds_read_b64_tr_b16 a[130:131], v4 offset:4096
 v_mfma_f32_16x16x32_bf16 v[132:135], a[160:163], a[60:63], v[132:135]
 ds_read_b64_tr_b16 a[132:133], v5 offset:0
 v_mfma_f32_16x16x32_bf16 v[140:143], a[164:167], a[60:63], v[140:143]
 ds_read_b64_tr_b16 a[134:135], v5 offset:4096
 v_mfma_f32_16x16x32_bf16 v[136:139], a[164:167], a[56:59], v[136:139]
 ds_read_b64_tr_b16 a[136:137], v6 offset:0
 ds_read_b64_tr_b16 a[138:139], v6 offset:4096
 v_mfma_f32_16x16x32_bf16 v[144:147], a[168:171], a[56:59], v[144:147]
 ds_read_b64_tr_b16 a[140:141], v7 offset:0
 v_mfma_f32_16x16x32_bf16 v[148:151], a[168:171], a[60:63], v[148:151]
 ds_read_b64_tr_b16 a[142:143], v7 offset:4096
 v_mfma_f32_16x16x32_bf16 v[156:159], a[172:175], a[60:63], v[156:159]
 ds_read_b64_tr_b16 a[144:145], v8 offset:0
 ds_read_b64_tr_b16 a[146:147], v8 offset:4096
 v_mfma_f32_16x16x32_bf16 v[152:155], a[172:175], a[56:59], v[152:155]
 ds_read_b64_tr_b16 a[148:149], v9 offset:0
 v_mfma_f32_16x16x32_bf16 v[160:163], a[176:179], a[56:59], v[160:163]
 ds_read_b64_tr_b16 a[150:151], v9 offset:4096
 buffer_load_dwordx4 a[48:51], v12, s[8:11], s26 offen offset:2048 sc1
 v_mfma_f32_16x16x32_bf16 v[164:167], a[176:179], a[60:63], v[164:167]
 ds_read_b64_tr_b16 a[152:153], v10 offset:0
 ds_read_b64_tr_b16 a[154:155], v10 offset:4096
 v_mfma_f32_16x16x32_bf16 v[172:175], a[180:183], a[60:63], v[172:175]
 ds_read_b64_tr_b16 a[156:157], v11 offset:0
 buffer_load_dwordx4 a[52:55], v13, s[8:11], s26 offen offset:2048 sc1
 v_mfma_f32_16x16x32_bf16 v[168:171], a[180:183], a[56:59], v[168:171]
 ds_read_b64_tr_b16 a[158:159], v11 offset:4096
 v_mfma_f32_16x16x32_bf16 v[176:179], a[184:187], a[56:59], v[176:179]
 s_add_u32 m0, s27, 49152
 s_nop 0
 buffer_load_dwordx4 v2, s[12:15], s20 offen lds
 v_mfma_f32_16x16x32_bf16 v[180:183], a[184:187], a[60:63], v[180:183]
 v_mfma_f32_16x16x32_bf16 v[188:191], a[188:191], a[60:63], v[188:191]
 s_add_u32 s29, s20, 7168
 buffer_load_dwordx4 v3, s[12:15], s29 offen offset:1024 lds
 v_mfma_f32_16x16x32_bf16 v[184:187], a[188:191], a[56:59], v[184:187]
 s_add_u32 s28, s28, 1
 s_cmp_lt_u32 s28, 8
 s_cbranch_scc1 wo_loop
 s_cmp_eq_u32 s30, 0
 s_cbranch_scc0 w0_9
 s_cmp_ge_u32 s2, 224
 s_cbranch_scc1 uva_10
 s_and_b32 s78, s2, 7
 s_lshl_b32 s78, s78, 7
 s_add_u32 s78, s78, 52699136
 v_mov_b32 v30, 1
 v_mov_b32 v31, 0
 s_mov_b64 exec, 1
 buffer_atomic_add v30, v31, s[8:11], s78 offen sc1
 s_mov_b64 exec, -1
uva_10:
w0_9:
 s_lshl_b32 s73, s31, 3
 s_add_u32 s73, s73, s68
 s_lshl_b32 s73, s73, 1
 s_add_u32 s74, s73, s69
 s_xor_b32 s75, s69, 1
 s_add_u32 s75, s73, s75
 s_lshl_b32 s74, s74, 2
 s_add_u32 s74, s74, s30
 s_lshl_b32 s75, s75, 2
 s_add_u32 s75, s75, s30
 s_lshl_b32 s78, s74, 7
 s_add_u32 s78, s78, 52428800
 s_lshl_b32 s79, s75, 7
 s_add_u32 s79, s79, 52428800
 s_lshl_b32 s74, s74, 14
 s_add_u32 s74, s74, 67108864
 s_lshl_b32 s75, s75, 14
 s_add_u32 s75, s75, 67108864
 s_nop 7
 buffer_store_dwordx4 v[160:163], v16, s[8:11], s75 offen offset:0 sc1
 buffer_store_dwordx4 v[164:167], v16, s[8:11], s75 offen offset:1024 sc1
 buffer_store_dwordx4 v[168:171], v16, s[8:11], s75 offen offset:2048 sc1
 buffer_store_dwordx4 v[172:175], v16, s[8:11], s75 offen offset:3072 sc1
 s_add_u32 s75, s75, 4096
 buffer_store_dwordx4 v[176:179], v16, s[8:11], s75 offen offset:0 sc1
 buffer_store_dwordx4 v[180:183], v16, s[8:11], s75 offen offset:1024 sc1
 buffer_store_dwordx4 v[184:187], v16, s[8:11], s75 offen offset:2048 sc1
 buffer_store_dwordx4 v[188:191], v16, s[8:11], s75 offen offset:3072 sc1
 s_lshl_b32 s42, s35, 15
 s_lshl_b32 s43, s32, 11
 s_add_u32 s42, s42, s43
 v_and_b32 v18, 63, v0
 v_lshlrev_b32 v18, 2, v18
 v_lshrrev_b32 v112, 6, v0
 v_and_b32 v112, 1, v112
 v_mul_u32_u24 v112, 8192, v112
 v_add_u32 v18, v18, v112
 s_add_u32 s40, s34, 51716096
 buffer_load_dword v112, v18, s[8:11], s40 offen
 s_add_u32 s40, s40, 24576
 buffer_load_dword v113, v18, s[8:11], s40 offen
 s_add_u32 s40, s40, 24576
 buffer_load_dword v114, v18, s[8:11], s40 offen
 s_add_u32 s40, s40, 24576
 buffer_load_dword v115, v18, s[8:11], s40 offen
 s_add_u32 s40, s40, 24576
 buffer_load_dword v116, v18, s[8:11], s40 offen
 s_add_u32 s40, s40, 24576
 buffer_load_dword v117, v18, s[8:11], s40 offen
 s_add_u32 s40, s40, 24576
 buffer_load_dword v118, v18, s[8:11], s40 offen
 s_add_u32 s40, s40, 24576
 buffer_load_dword v119, v18, s[8:11], s40 offen
 s_mov_b32 s44, s38
 s_mov_b32 s45, s39
 s_mov_b32 s46, 0x400000
 s_mov_b32 s47, 0x20000
 v_and_b32 v28, 15, v1
 v_lshlrev_b32 v28, 11, v28
 v_lshrrev_b32 v29, 4, v1
 v_lshl_add_u32 v28, v29, 3, v28
 s_lshl_b32 s43, s35, 15
 s_add_u32 s43, s43, s33
 buffer_load_dwordx2 v[64:65], v28, s[44:47], s43 offen offset:0
 buffer_load_dwordx2 v[66:67], v28, s[44:47], s43 offen offset:32
 buffer_load_dwordx2 v[68:69], v28, s[44:47], s43 offen offset:64
 buffer_load_dwordx2 v[70:71], v28, s[44:47], s43 offen offset:96
 s_add_u32 s43, s43, 32768
 buffer_load_dwordx2 v[72:73], v28, s[44:47], s43 offen offset:0
 buffer_load_dwordx2 v[74:75], v28, s[44:47], s43 offen offset:32
 buffer_load_dwordx2 v[76:77], v28, s[44:47], s43 offen offset:64
 buffer_load_dwordx2 v[78:79], v28, s[44:47], s43 offen offset:96
 v_mov_b32 v224, 1
 v_mov_b32 v225, 0
 s_waitcnt vmcnt(16)
 s_mov_b64 exec, 1
 buffer_store_dword v224, v225, s[8:11], s79 offen sc1
 s_mov_b64 exec, -1
 s_waitcnt vmcnt(9)
 v_add_f32 v112, v112, v113
 v_add_f32 v114, v114, v115
 v_add_f32 v116, v116, v117
 v_add_f32 v118, v118, v119
 v_add_f32 v112, v112, v114
 v_add_f32 v116, v116, v118
 v_add_f32 v112, v112, v116
 v_cvt_pk_bf16_f32 v112, v112, v112
 v_lshlrev_b32 v112, 16, v112
 v_add_f32 v113, 1.0, v112
 v_cvt_pk_bf16_f32 v113, v113, v113
 v_lshlrev_b32 v113, 16, v113
 v_lshrrev_b32 v18, 6, v0
 v_and_b32 v18, 1, v18
 v_cmp_eq_u32 vcc, 1, v18
 s_nop 1
 v_cndmask_b32 v112, v112, v113, vcc
 v_lshlrev_b32 v18, 2, v0
 v_add_u32 v18, 131072, v18
 ds_write_b32 v18, v112
 s_waitcnt lgkmcnt(0)
 s_barrier
 v_add_u32 v18, 131072, v17
 ds_read_b128 v[80:83], v18 offset:0
 ds_read_b128 v[96:99], v18 offset:256
 ds_read_b128 v[84:87], v18 offset:64
 ds_read_b128 v[100:103], v18 offset:320
 ds_read_b128 v[88:91], v18 offset:128
 ds_read_b128 v[104:107], v18 offset:384
 ds_read_b128 v[92:95], v18 offset:192
 ds_read_b128 v[108:111], v18 offset:448
 s_waitcnt lgkmcnt(0)
 v_mov_b32 v225, 0
 s_mov_b64 exec, 1
 s_mov_b32 s76, 0
main_kernel_wo_poll:
 buffer_load_dword v226, v225, s[8:11], s78 offen sc1
 s_waitcnt vmcnt(0)
 v_readfirstlane_b32 s77, v226
 s_add_u32 s76, s76, 1
 s_cmp_eq_u32 s77, 1
 s_cbranch_scc1 main_kernel_wo_got
 s_cmp_lt_u32 s76, 0x40000
 s_cbranch_scc1 main_kernel_wo_poll
main_kernel_wo_got:
 s_mov_b64 exec, -1
 s_add_u32 s77, s74, 4096
 buffer_load_dwordx4 v[192:195], v16, s[8:11], s74 offen offset:0 sc1
 buffer_load_dwordx4 v[196:199], v16, s[8:11], s74 offen offset:1024 sc1
 buffer_load_dwordx4 v[200:203], v16, s[8:11], s74 offen offset:2048 sc1
 buffer_load_dwordx4 v[204:207], v16, s[8:11], s74 offen offset:3072 sc1
 buffer_load_dwordx4 v[208:211], v16, s[8:11], s77 offen offset:0 sc1
 buffer_load_dwordx4 v[212:215], v16, s[8:11], s77 offen offset:1024 sc1
 buffer_load_dwordx4 v[216:219], v16, s[8:11], s77 offen offset:2048 sc1
 buffer_load_dwordx4 v[220:223], v16, s[8:11], s77 offen offset:3072 sc1
 s_waitcnt vmcnt(7)
 v_add_f32 v128, v128, v192
 v_add_f32 v129, v129, v193
 v_add_f32 v130, v130, v194
 v_add_f32 v131, v131, v195
 s_waitcnt vmcnt(6)
 v_add_f32 v132, v132, v196
 v_add_f32 v133, v133, v197
 v_add_f32 v134, v134, v198
 v_add_f32 v135, v135, v199
 s_waitcnt vmcnt(5)
 v_add_f32 v136, v136, v200
 v_add_f32 v137, v137, v201
 v_add_f32 v138, v138, v202
 v_add_f32 v139, v139, v203
 s_waitcnt vmcnt(4)
 v_add_f32 v140, v140, v204
 v_add_f32 v141, v141, v205
 v_add_f32 v142, v142, v206
 v_add_f32 v143, v143, v207
 s_waitcnt vmcnt(3)
 v_add_f32 v144, v144, v208
 v_add_f32 v145, v145, v209
 v_add_f32 v146, v146, v210
 v_add_f32 v147, v147, v211
 s_waitcnt vmcnt(2)
 v_add_f32 v148, v148, v212
 v_add_f32 v149, v149, v213
 v_add_f32 v150, v150, v214
 v_add_f32 v151, v151, v215
 s_waitcnt vmcnt(1)
 v_add_f32 v152, v152, v216
 v_add_f32 v153, v153, v217
 v_add_f32 v154, v154, v218
 v_add_f32 v155, v155, v219
 s_waitcnt vmcnt(0)
 v_add_f32 v156, v156, v220
 v_add_f32 v157, v157, v221
 v_add_f32 v158, v158, v222
 v_add_f32 v159, v159, v223
 v_lshlrev_b32 v224, 16, v64
 v_and_b32 v225, 0xffff0000, v64
 v_lshlrev_b32 v226, 16, v65
 v_and_b32 v227, 0xffff0000, v65
 v_fmac_f32 v224, v80, v128
 v_fmac_f32 v225, v81, v129
 v_fmac_f32 v226, v82, v130
 v_fmac_f32 v227, v83, v131
 v_lshlrev_b32 v228, 16, v66
 v_and_b32 v229, 0xffff0000, v66
 v_lshlrev_b32 v230, 16, v67
 v_and_b32 v231, 0xffff0000, v67
 v_fmac_f32 v228, v84, v136
 v_fmac_f32 v229, v85, v137
 v_fmac_f32 v230, v86, v138
 v_fmac_f32 v231, v87, v139
 v_lshlrev_b32 v232, 16, v68
 v_and_b32 v233, 0xffff0000, v68
 v_lshlrev_b32 v234, 16, v69
 v_and_b32 v235, 0xffff0000, v69
 v_fmac_f32 v232, v88, v144
 v_fmac_f32 v233, v89, v145
 v_fmac_f32 v234, v90, v146
 v_fmac_f32 v235, v91, v147
 v_lshlrev_b32 v236, 16, v70
 v_and_b32 v237, 0xffff0000, v70
 v_lshlrev_b32 v238, 16, v71
 v_and_b32 v239, 0xffff0000, v71
 v_fmac_f32 v236, v92, v152
 v_fmac_f32 v237, v93, v153
 v_fmac_f32 v238, v94, v154
 v_fmac_f32 v239, v95, v155
 v_cvt_pk_bf16_f32 v64, v224, v225
 v_cvt_pk_bf16_f32 v65, v226, v227
 v_cvt_pk_bf16_f32 v66, v228, v229
 v_cvt_pk_bf16_f32 v67, v230, v231
 v_cvt_pk_bf16_f32 v68, v232, v233
 v_cvt_pk_bf16_f32 v69, v234, v235
 v_cvt_pk_bf16_f32 v70, v236, v237
 v_cvt_pk_bf16_f32 v71, v238, v239
 v_lshlrev_b32 v224, 16, v64
 v_and_b32 v225, 0xffff0000, v64
 v_lshlrev_b32 v226, 16, v65
 v_and_b32 v227, 0xffff0000, v65
 v_lshlrev_b32 v228, 16, v66
 v_and_b32 v229, 0xffff0000, v66
 v_lshlrev_b32 v230, 16, v67
 v_and_b32 v231, 0xffff0000, v67
 v_lshlrev_b32 v232, 16, v68
 v_and_b32 v233, 0xffff0000, v68
 v_lshlrev_b32 v234, 16, v69
 v_and_b32 v235, 0xffff0000, v69
 v_lshlrev_b32 v236, 16, v70
 v_and_b32 v237, 0xffff0000, v70
 v_lshlrev_b32 v238, 16, v71
 v_and_b32 v239, 0xffff0000, v71
 v_mul_f32 v200, v224, v96
 v_mul_f32 v201, v225, v97
 v_mul_f32 v202, v226, v98
 v_mul_f32 v203, v227, v99
 v_mul_f32 v204, v228, v100
 v_mul_f32 v205, v229, v101
 v_mul_f32 v206, v230, v102
 v_mul_f32 v207, v231, v103
 v_mul_f32 v208, v232, v104
 v_mul_f32 v209, v233, v105
 v_mul_f32 v210, v234, v106
 v_mul_f32 v211, v235, v107
 v_mul_f32 v212, v236, v108
 v_mul_f32 v213, v237, v109
 v_mul_f32 v214, v238, v110
 v_mul_f32 v215, v239, v111
 v_cvt_pk_bf16_f32 v248, v200, v201
 v_cvt_pk_bf16_f32 v249, v202, v203
 v_cvt_pk_bf16_f32 v250, v204, v205
 v_cvt_pk_bf16_f32 v251, v206, v207
 v_cvt_pk_bf16_f32 v252, v208, v209
 v_cvt_pk_bf16_f32 v253, v210, v211
 v_cvt_pk_bf16_f32 v254, v212, v213
 v_cvt_pk_bf16_f32 v255, v214, v215
 s_add_u32 s43, s42, 29360128
 buffer_store_dwordx4 v[248:251], v16, s[8:11], s43 offen offset:0 sc1
 buffer_store_dwordx4 v[252:255], v16, s[8:11], s43 offen offset:1024 sc1
 v_add_f32 v20, v224, v225
 v_add_f32 v20, v20, v226
 v_add_f32 v20, v20, v227
 v_add_f32 v20, v20, v228
 v_add_f32 v20, v20, v229
 v_add_f32 v20, v20, v230
 v_add_f32 v20, v20, v231
 v_add_f32 v20, v20, v232
 v_add_f32 v20, v20, v233
 v_add_f32 v20, v20, v234
 v_add_f32 v20, v20, v235
 v_add_f32 v20, v20, v236
 v_add_f32 v20, v20, v237
 v_add_f32 v20, v20, v238
 v_add_f32 v20, v20, v239
 v_mov_b32 v44, v20
 s_nop 1
 v_permlane16_swap_b32 v20, v44
 v_add_f32 v20, v20, v44
 v_mov_b32 v44, v20
 s_nop 1
 v_permlane32_swap_b32 v20, v44
 v_add_f32 v20, v20, v44
 v_mul_f32 v20, 0x3c800000, v20
 v_sub_f32 v224, v224, v20
 v_sub_f32 v225, v225, v20
 v_sub_f32 v226, v226, v20
 v_sub_f32 v227, v227, v20
 v_sub_f32 v228, v228, v20
 v_sub_f32 v229, v229, v20
 v_sub_f32 v230, v230, v20
 v_sub_f32 v231, v231, v20
 v_sub_f32 v232, v232, v20
 v_sub_f32 v233, v233, v20
 v_sub_f32 v234, v234, v20
 v_sub_f32 v235, v235, v20
 v_sub_f32 v236, v236, v20
 v_sub_f32 v237, v237, v20
 v_sub_f32 v238, v238, v20
 v_sub_f32 v239, v239, v20
 v_mul_f32 v21, v224, v224
 v_fmac_f32 v21, v225, v225
 v_fmac_f32 v21, v226, v226
 v_fmac_f32 v21, v227, v227
 v_fmac_f32 v21, v228, v228
 v_fmac_f32 v21, v229, v229
 v_fmac_f32 v21, v230, v230
 v_fmac_f32 v21, v231, v231
 v_fmac_f32 v21, v232, v232
 v_fmac_f32 v21, v233, v233
 v_fmac_f32 v21, v234, v234
 v_fmac_f32 v21, v235, v235
 v_fmac_f32 v21, v236, v236
 v_fmac_f32 v21, v237, v237
 v_fmac_f32 v21, v238, v238
 v_fmac_f32 v21, v239, v239
 v_mov_b32 v44, v21
 s_nop 1
 v_permlane16_swap_b32 v21, v44
 v_add_f32 v21, v21, v44
 v_mov_b32 v44, v21
 s_nop 1
 v_permlane32_swap_b32 v21, v44
 v_add_f32 v21, v21, v44
 v_lshlrev_b32 v224, 16, v72
 v_and_b32 v225, 0xffff0000, v72
 v_lshlrev_b32 v226, 16, v73
 v_and_b32 v227, 0xffff0000, v73
 v_fmac_f32 v224, v80, v132
 v_fmac_f32 v225, v81, v133
 v_fmac_f32 v226, v82, v134
 v_fmac_f32 v227, v83, v135
 v_lshlrev_b32 v228, 16, v74
 v_and_b32 v229, 0xffff0000, v74
 v_lshlrev_b32 v230, 16, v75
 v_and_b32 v231, 0xffff0000, v75
 v_fmac_f32 v228, v84, v140
 v_fmac_f32 v229, v85, v141
 v_fmac_f32 v230, v86, v142
 v_fmac_f32 v231, v87, v143
 v_lshlrev_b32 v232, 16, v76
 v_and_b32 v233, 0xffff0000, v76
 v_lshlrev_b32 v234, 16, v77
 v_and_b32 v235, 0xffff0000, v77
 v_fmac_f32 v232, v88, v148
 v_fmac_f32 v233, v89, v149
 v_fmac_f32 v234, v90, v150
 v_fmac_f32 v235, v91, v151
 v_lshlrev_b32 v236, 16, v78
 v_and_b32 v237, 0xffff0000, v78
 v_lshlrev_b32 v238, 16, v79
 v_and_b32 v239, 0xffff0000, v79
 v_fmac_f32 v236, v92, v156
 v_fmac_f32 v237, v93, v157
 v_fmac_f32 v238, v94, v158
 v_fmac_f32 v239, v95, v159
 v_cvt_pk_bf16_f32 v72, v224, v225
 v_cvt_pk_bf16_f32 v73, v226, v227
 v_cvt_pk_bf16_f32 v74, v228, v229
 v_cvt_pk_bf16_f32 v75, v230, v231
 v_cvt_pk_bf16_f32 v76, v232, v233
 v_cvt_pk_bf16_f32 v77, v234, v235
 v_cvt_pk_bf16_f32 v78, v236, v237
 v_cvt_pk_bf16_f32 v79, v238, v239
 v_lshlrev_b32 v224, 16, v72
 v_and_b32 v225, 0xffff0000, v72
 v_lshlrev_b32 v226, 16, v73
 v_and_b32 v227, 0xffff0000, v73
 v_lshlrev_b32 v228, 16, v74
 v_and_b32 v229, 0xffff0000, v74
 v_lshlrev_b32 v230, 16, v75
 v_and_b32 v231, 0xffff0000, v75
 v_lshlrev_b32 v232, 16, v76
 v_and_b32 v233, 0xffff0000, v76
 v_lshlrev_b32 v234, 16, v77
 v_and_b32 v235, 0xffff0000, v77
 v_lshlrev_b32 v236, 16, v78
 v_and_b32 v237, 0xffff0000, v78
 v_lshlrev_b32 v238, 16, v79
 v_and_b32 v239, 0xffff0000, v79
 v_mul_f32 v200, v224, v96
 v_mul_f32 v201, v225, v97
 v_mul_f32 v202, v226, v98
 v_mul_f32 v203, v227, v99
 v_mul_f32 v204, v228, v100
 v_mul_f32 v205, v229, v101
 v_mul_f32 v206, v230, v102
 v_mul_f32 v207, v231, v103
 v_mul_f32 v208, v232, v104
 v_mul_f32 v209, v233, v105
 v_mul_f32 v210, v234, v106
 v_mul_f32 v211, v235, v107
 v_mul_f32 v212, v236, v108
 v_mul_f32 v213, v237, v109
 v_mul_f32 v214, v238, v110
 v_mul_f32 v215, v239, v111
 v_cvt_pk_bf16_f32 v248, v200, v201
 v_cvt_pk_bf16_f32 v249, v202, v203
 v_cvt_pk_bf16_f32 v250, v204, v205
 v_cvt_pk_bf16_f32 v251, v206, v207
 v_cvt_pk_bf16_f32 v252, v208, v209
 v_cvt_pk_bf16_f32 v253, v210, v211
 v_cvt_pk_bf16_f32 v254, v212, v213
 v_cvt_pk_bf16_f32 v255, v214, v215
 s_add_u32 s43, s42, 29392896
 buffer_store_dwordx4 v[248:251], v16, s[8:11], s43 offen offset:0 sc1
 buffer_store_dwordx4 v[252:255], v16, s[8:11], s43 offen offset:1024 sc1
 v_add_f32 v22, v224, v225
 v_add_f32 v22, v22, v226
 v_add_f32 v22, v22, v227
 v_add_f32 v22, v22, v228
 v_add_f32 v22, v22, v229
 v_add_f32 v22, v22, v230
 v_add_f32 v22, v22, v231
 v_add_f32 v22, v22, v232
 v_add_f32 v22, v22, v233
 v_add_f32 v22, v22, v234
 v_add_f32 v22, v22, v235
 v_add_f32 v22, v22, v236
 v_add_f32 v22, v22, v237
 v_add_f32 v22, v22, v238
 v_add_f32 v22, v22, v239
 v_mov_b32 v44, v22
 s_nop 1
 v_permlane16_swap_b32 v22, v44
 v_add_f32 v22, v22, v44
 v_mov_b32 v44, v22
 s_nop 1
 v_permlane32_swap_b32 v22, v44
 v_add_f32 v22, v22, v44
 v_mul_f32 v22, 0x3c800000, v22
 v_sub_f32 v224, v224, v22
 v_sub_f32 v225, v225, v22
 v_sub_f32 v226, v226, v22
 v_sub_f32 v227, v227, v22
 v_sub_f32 v228, v228, v22
 v_sub_f32 v229, v229, v22
 v_sub_f32 v230, v230, v22
 v_sub_f32 v231, v231, v22
 v_sub_f32 v232, v232, v22
 v_sub_f32 v233, v233, v22
 v_sub_f32 v234, v234, v22
 v_sub_f32 v235, v235, v22
 v_sub_f32 v236, v236, v22
 v_sub_f32 v237, v237, v22
 v_sub_f32 v238, v238, v22
 v_sub_f32 v239, v239, v22
 v_mul_f32 v23, v224, v224
 v_fmac_f32 v23, v225, v225
 v_fmac_f32 v23, v226, v226
 v_fmac_f32 v23, v227, v227
 v_fmac_f32 v23, v228, v228
 v_fmac_f32 v23, v229, v229
 v_fmac_f32 v23, v230, v230
 v_fmac_f32 v23, v231, v231
 v_fmac_f32 v23, v232, v232
 v_fmac_f32 v23, v233, v233
 v_fmac_f32 v23, v234, v234
 v_fmac_f32 v23, v235, v235
 v_fmac_f32 v23, v236, v236
 v_fmac_f32 v23, v237, v237
 v_fmac_f32 v23, v238, v238
 v_fmac_f32 v23, v239, v239
 v_mov_b32 v44, v23
 s_nop 1
 v_permlane16_swap_b32 v23, v44
 v_add_f32 v23, v23, v44
 v_mov_b32 v44, v23
 s_nop 1
 v_permlane32_swap_b32 v23, v44
 v_add_f32 v23, v23, v44
 v_lshlrev_b32 v45, 3, v1
 s_lshl_b32 s40, s35, 7
 s_lshl_b32 s41, s32, 14
 s_add_u32 s40, s40, s41
 s_add_u32 s40, s40, 51445760
 v_cmp_gt_u32 vcc, 16, v1
 s_and_saveexec_b64 s[44:45], vcc
 buffer_store_dwordx2 v[20:21], v45, s[8:11], s40 offen sc1
 buffer_store_dwordx2 v[22:23], v45, s[8:11], s40 offen offset:128 sc1
 s_mov_b64 exec, s[44:45]
 v_accvgpr_write_b32 a240, v64
 v_accvgpr_write_b32 a241, v65
 v_accvgpr_write_b32 a242, v66
 v_accvgpr_write_b32 a243, v67
 v_accvgpr_write_b32 a244, v68
 v_accvgpr_write_b32 a245, v69
 v_accvgpr_write_b32 a246, v70
 v_accvgpr_write_b32 a247, v71
 v_accvgpr_write_b32 a248, v72
 v_accvgpr_write_b32 a249, v73
 v_accvgpr_write_b32 a250, v74
 v_accvgpr_write_b32 a251, v75
 v_accvgpr_write_b32 a252, v76
 v_accvgpr_write_b32 a253, v77
 v_accvgpr_write_b32 a254, v78
 v_accvgpr_write_b32 a255, v79
 s_load_dwordx2 s[36:37], s[0:1], 48
 s_lshr_b32 s40, s31, 1
 s_bfe_u32 s32, s2, 0x20001
 s_mul_i32 s32, s32, 7
 s_lshr_b32 s33, s2, 5
 s_add_u32 s32, s32, s33
 s_min_u32 s32, s32, 27
 s_lshl_b32 s33, s32, 8
 s_waitcnt lgkmcnt(0)
 s_mov_b32 s12, s36
 s_mov_b32 s13, s37
 s_mov_b32 s14, 0x700000
 s_mov_b32 s15, 0x20000
 s_waitcnt vmcnt(0)
 s_barrier
 s_cmp_eq_u32 s30, 0
 s_cbranch_scc0 w0_11
 s_lshl_b32 s78, s40, 7
 s_add_u32 s78, s78, 52695040
 v_mov_b32 v30, 1
 v_mov_b32 v31, 0
 s_mov_b64 exec, 1
 buffer_atomic_add v30, v31, s[8:11], s78 offen sc1
 s_mov_b64 exec, -1
w0_11:
 v_lshrrev_b32 v40, 4, v1
 v_and_b32 v41, 15, v1
 v_and_b32 v42, 3, v40
 v_lshlrev_b32 v42, 1, v42
 v_xor_b32 v41, v41, v42
 s_mul_i32 s29, s30, 16
 v_add_u32 v40, s29, v40
 s_mov_b32 s29, 7168
 v_mul_lo_u32 v40, v40, s29
 v_add_u32 v40, s33, v40
 v_lshl_add_u32 v2, v41, 4, v40
 v_xor_b32 v41, 8, v41
 v_lshl_add_u32 v3, v41, 4, v40
 s_mul_i32 s27, s30, 4096
 v_lshrrev_b32 v41, 2, v1
 v_mul_u32_u24 v40, 256, v41
 v_and_b32 v42, 3, v1
 v_lshl_add_u32 v40, v42, 3, v40
 v_and_b32 v41, 7, v41
 v_xor_b32 v42, 0, v41
 v_lshlrev_b32 v42, 5, v42
 v_add_u32 v4, v40, v42
 v_xor_b32 v42, 1, v41
 v_lshlrev_b32 v42, 5, v42
 v_add_u32 v5, v40, v42
 v_xor_b32 v42, 2, v41
 v_lshlrev_b32 v42, 5, v42
 v_add_u32 v6, v40, v42
 v_xor_b32 v42, 3, v41
 v_lshlrev_b32 v42, 5, v42
 v_add_u32 v7, v40, v42
 v_xor_b32 v42, 4, v41
 v_lshlrev_b32 v42, 5, v42
 v_add_u32 v8, v40, v42
 v_xor_b32 v42, 5, v41
 v_lshlrev_b32 v42, 5, v42
 v_add_u32 v9, v40, v42
 v_xor_b32 v42, 6, v41
 v_lshlrev_b32 v42, 5, v42
 v_add_u32 v10, v40, v42
 v_xor_b32 v42, 7, v41
 v_lshlrev_b32 v42, 5, v42
 v_add_u32 v11, v40, v42
 s_mov_b32 s20, 0
 s_add_u32 m0, s27, 0
 s_nop 0
 buffer_load_dwordx4 v2, s[12:15], s20 offen lds
 s_add_u32 s29, s20, 27648
 buffer_load_dwordx4 v3, s[12:15], s29 offen offset:1024 lds
 s_add_u32 s29, s20, 55296
 buffer_load_dwordx4 v2, s[12:15], s29 offen offset:2048 lds
 s_add_u32 s29, s20, 82944
 buffer_load_dwordx4 v3, s[12:15], s29 offen offset:3072 lds
 s_add_u32 s20, s20, 458752
 s_add_u32 m0, s27, 16384
 s_nop 0
 buffer_load_dwordx4 v2, s[12:15], s20 offen lds
 s_add_u32 s29, s20, 27648
 buffer_load_dwordx4 v3, s[12:15], s29 offen offset:1024 lds
 s_add_u32 s29, s20, 55296
 buffer_load_dwordx4 v2, s[12:15], s29 offen offset:2048 lds
 s_add_u32 s29, s20, 82944
 buffer_load_dwordx4 v3, s[12:15], s29 offen offset:3072 lds
 s_add_u32 s20, s20, 458752
 s_add_u32 m0, s27, 32768
 s_nop 0
 buffer_load_dwordx4 v2, s[12:15], s20 offen lds
 s_add_u32 s29, s20, 27648
 buffer_load_dwordx4 v3, s[12:15], s29 offen offset:1024 lds
 s_add_u32 s29, s20, 55296
 buffer_load_dwordx4 v2, s[12:15], s29 offen offset:2048 lds
 s_add_u32 s29, s20, 82944
 buffer_load_dwordx4 v3, s[12:15], s29 offen offset:3072 lds
 s_add_u32 s20, s20, 458752
 s_add_u32 m0, s27, 49152
 s_nop 0
 buffer_load_dwordx4 v2, s[12:15], s20 offen lds
 s_add_u32 s29, s20, 27648
 buffer_load_dwordx4 v3, s[12:15], s29 offen offset:1024 lds
 s_lshl_b32 s35, s100, 4
 s_lshl_b32 s38, s30, 2
 s_add_u32 s35, s35, s38
 s_lshl_b32 s34, s32, 9
 v_lshrrev_b32 v17, 4, v1
 v_lshlrev_b32 v17, 4, v17
 v_lshlrev_b32 v16, 4, v1
 v_lshlrev_b32 v40, 4, v1
 s_mul_i32 s29, s35, 32768
 v_add_u32 v12, s29, v40
 s_add_u32 s29, s29, 32768
 v_add_u32 v13, s29, v40
 s_add_u32 s29, s29, 32768
 v_add_u32 v14, s29, v40
 s_add_u32 s29, s29, 32768
 v_add_u32 v15, s29, v40
 v_and_b32 v18, 127, v0
 v_lshlrev_b32 v18, 2, v18
 v_lshrrev_b32 v19, 7, v0
 s_mov_b32 s40, 14336
 v_mul_lo_u32 v19, v19, s40
 v_add_u32 v18, v18, v19
 s_cmp_ge_u32 s2, 224
 s_cbranch_scc1 main_kernel_w1skip
 s_cmp_eq_u32 s30, 0
 s_cbranch_scc0 w0_12
 s_mov_b64 exec, 0xff
 v_lshlrev_b32 v31, 7, v1
 s_mov_b32 s78, 52699136
 s_mov_b32 s76, 0
pu_13:
 buffer_load_dword v30, v31, s[8:11], s78 offen sc1
 s_waitcnt vmcnt(0)
 v_cmp_le_u32 vcc, 28, v30
 s_add_u32 s76, s76, 1
 s_nop 1
 s_cmp_eq_u32 vcc_lo, 0xff
 s_cbranch_scc1 pud_14
 s_cmp_lt_u32 s76, 0x40000
 s_cbranch_scc1 pu_13
pud_14:
 s_mov_b64 exec, -1
w0_12:
 s_barrier
 s_add_u32 s40, s34, 51904512
 buffer_load_dword v48, v18, s[8:11], s40 offen sc1
 s_add_u32 s40, s40, 28672
 buffer_load_dword v49, v18, s[8:11], s40 offen sc1
 s_add_u32 s40, s40, 28672
 buffer_load_dword v50, v18, s[8:11], s40 offen sc1
 s_add_u32 s40, s40, 28672
 buffer_load_dword v51, v18, s[8:11], s40 offen sc1
 s_add_u32 s40, s40, 28672
 buffer_load_dword v52, v18, s[8:11], s40 offen sc1
 s_add_u32 s40, s40, 28672
 buffer_load_dword v53, v18, s[8:11], s40 offen sc1
 s_add_u32 s40, s40, 28672
 buffer_load_dword v54, v18, s[8:11], s40 offen sc1
 s_add_u32 s40, s40, 28672
 buffer_load_dword v55, v18, s[8:11], s40 offen sc1
 s_waitcnt vmcnt(0)
 v_add_f32 v48, v48, v49
 v_add_f32 v50, v50, v51
 v_add_f32 v52, v52, v53
 v_add_f32 v54, v54, v55
 v_add_f32 v48, v48, v50
 v_add_f32 v52, v52, v54
 v_add_f32 v48, v48, v52
 v_lshlrev_b32 v18, 2, v0
 v_add_u32 v18, 131072, v18
 ds_write_b32 v18, v48
 s_waitcnt lgkmcnt(0)
 s_barrier
 v_add_u32 v18, 131072, v17
 ds_read_b128 v[96:99], v18 offset:0
 ds_read_b128 v[48:51], v18 offset:512
 ds_read_b128 v[100:103], v18 offset:64
 ds_read_b128 v[52:55], v18 offset:576
 ds_read_b128 v[104:107], v18 offset:128
 ds_read_b128 v[56:59], v18 offset:640
 ds_read_b128 v[108:111], v18 offset:192
 ds_read_b128 v[60:63], v18 offset:704
 ds_read_b128 v[112:115], v18 offset:256
 ds_read_b128 v[20:23], v18 offset:768
 ds_read_b128 v[116:119], v18 offset:320
 ds_read_b128 v[24:27], v18 offset:832
 ds_read_b128 v[120:123], v18 offset:384
 ds_read_b128 v[28:31], v18 offset:896
 ds_read_b128 v[124:127], v18 offset:448
 ds_read_b128 v[32:35], v18 offset:960
 s_cmp_eq_u32 s30, 0
 s_cbranch_scc0 w0_15
 s_lshl_b32 s78, s100, 7
 s_add_u32 s78, s78, 52695040
 v_mov_b32 v45, 0
 s_mov_b64 exec, 1
 s_mov_b32 s76, 0
pl_16:
 buffer_load_dword v44, v45, s[8:11], s78 offen sc1
 s_waitcnt vmcnt(0)
 v_readfirstlane_b32 s77, v44
 s_add_u32 s76, s76, 1
 s_cmp_ge_u32 s77, 32
 s_cbranch_scc1 pd_17
 s_cmp_lt_u32 s76, 0x40000
 s_cbranch_scc1 pl_16
pd_17:
 s_mov_b64 exec, -1
w0_15:
 s_barrier
 v_and_b32 v46, 15, v1
 v_lshlrev_b32 v46, 3, v46
 v_lshrrev_b32 v47, 4, v1
 v_lshl_add_u32 v46, v47, 16, v46
 s_lshl_b32 s40, s35, 7
 s_add_u32 s40, s40, 51445760
 buffer_load_dwordx2 v[64:65], v46, s[8:11], s40 offen offset:0 sc1
 buffer_load_dwordx2 v[72:73], v46, s[8:11], s40 offen offset:128 sc1
 buffer_load_dwordx2 v[80:81], v46, s[8:11], s40 offen offset:256 sc1
 buffer_load_dwordx2 v[88:89], v46, s[8:11], s40 offen offset:384 sc1
 s_add_u32 s40, s40, 16384
 buffer_load_dwordx2 v[66:67], v46, s[8:11], s40 offen offset:0 sc1
 buffer_load_dwordx2 v[74:75], v46, s[8:11], s40 offen offset:128 sc1
 buffer_load_dwordx2 v[82:83], v46, s[8:11], s40 offen offset:256 sc1
 buffer_load_dwordx2 v[90:91], v46, s[8:11], s40 offen offset:384 sc1
 s_add_u32 s40, s40, 16384
 buffer_load_dwordx2 v[68:69], v46, s[8:11], s40 offen offset:0 sc1
 buffer_load_dwordx2 v[76:77], v46, s[8:11], s40 offen offset:128 sc1
 buffer_load_dwordx2 v[84:85], v46, s[8:11], s40 offen offset:256 sc1
 buffer_load_dwordx2 v[92:93], v46, s[8:11], s40 offen offset:384 sc1
 s_add_u32 s40, s40, 16384
 buffer_load_dwordx2 v[70:71], v46, s[8:11], s40 offen offset:0 sc1
 buffer_load_dwordx2 v[78:79], v46, s[8:11], s40 offen offset:128 sc1
 buffer_load_dwordx2 v[86:87], v46, s[8:11], s40 offen offset:256 sc1
 buffer_load_dwordx2 v[94:95], v46, s[8:11], s40 offen offset:384 sc1
 s_mov_b32 s26, 0x1c00000
 buffer_load_dwordx4 a[0:3], v12, s[8:11], s26 offen sc1
 buffer_load_dwordx4 a[4:7], v13, s[8:11], s26 offen sc1
 buffer_load_dwordx4 a[8:11], v14, s[8:11], s26 offen sc1
 buffer_load_dwordx4 a[12:15], v15, s[8:11], s26 offen sc1
 buffer_load_dwordx4 a[16:19], v12, s[8:11], s26 offen offset:1024 sc1
 buffer_load_dwordx4 a[20:23], v13, s[8:11], s26 offen offset:1024 sc1
 buffer_load_dwordx4 a[24:27], v14, s[8:11], s26 offen offset:1024 sc1
 buffer_load_dwordx4 a[28:31], v15, s[8:11], s26 offen offset:1024 sc1
 buffer_load_dwordx4 a[32:35], v12, s[8:11], s26 offen offset:2048 sc1
 buffer_load_dwordx4 a[36:39], v13, s[8:11], s26 offen offset:2048 sc1
 buffer_load_dwordx4 a[40:43], v14, s[8:11], s26 offen offset:2048 sc1
 buffer_load_dwordx4 a[44:47], v15, s[8:11], s26 offen offset:2048 sc1
 s_waitcnt vmcnt(12) lgkmcnt(0)
 v_add_f32 v36, v64, v66
 v_add_f32 v40, v68, v70
 v_add_f32 v36, v36, v40
 v_add_f32 v37, v72, v74
 v_add_f32 v41, v76, v78
 v_add_f32 v37, v37, v41
 v_add_f32 v38, v80, v82
 v_add_f32 v42, v84, v86
 v_add_f32 v38, v38, v42
 v_add_f32 v39, v88, v90
 v_add_f32 v43, v92, v94
 v_add_f32 v39, v39, v43
 v_mov_b32 v44, v36
 v_mov_b32 v45, v37
 v_mov_b32 v46, v38
 v_mov_b32 v47, v39
 v_permlane16_swap_b32 v36, v44
 v_permlane16_swap_b32 v37, v45
 v_permlane16_swap_b32 v38, v46
 v_permlane16_swap_b32 v39, v47
 v_add_f32 v36, v36, v44
 v_add_f32 v37, v37, v45
 v_add_f32 v38, v38, v46
 v_add_f32 v39, v39, v47
 v_mov_b32 v44, v36
 v_mov_b32 v45, v37
 v_mov_b32 v46, v38
 v_mov_b32 v47, v39
 v_permlane32_swap_b32 v36, v44
 v_permlane32_swap_b32 v37, v45
 v_permlane32_swap_b32 v38, v46
 v_permlane32_swap_b32 v39, v47
 v_add_f32 v36, v36, v44
 v_add_f32 v37, v37, v45
 v_add_f32 v38, v38, v46
 v_add_f32 v39, v39, v47
 v_mul_f32 v36, 0x3d800000, v36
 v_sub_f32 v64, v64, v36
 v_sub_f32 v66, v66, v36
 v_sub_f32 v68, v68, v36
 v_sub_f32 v70, v70, v36
 v_mul_f32 v64, v64, v64
 v_mul_f32 v66, v66, v66
 v_mul_f32 v68, v68, v68
 v_mul_f32 v70, v70, v70
 v_add_f32 v64, v64, v66
 v_add_f32 v68, v68, v70
 v_add_f32 v64, v64, v68
 v_add_f32 v65, v65, v67
 v_add_f32 v69, v69, v71
 v_add_f32 v65, v65, v69
 v_mov_b32 v40, v65
 v_fmac_f32 v40, 0x42800000, v64
 v_mul_f32 v37, 0x3d800000, v37
 v_sub_f32 v72, v72, v37
 v_sub_f32 v74, v74, v37
 v_sub_f32 v76, v76, v37
 v_sub_f32 v78, v78, v37
 v_mul_f32 v72, v72, v72
 v_mul_f32 v74, v74, v74
 v_mul_f32 v76, v76, v76
 v_mul_f32 v78, v78, v78
 v_add_f32 v72, v72, v74
 v_add_f32 v76, v76, v78
 v_add_f32 v72, v72, v76
 v_add_f32 v73, v73, v75
 v_add_f32 v77, v77, v79
 v_add_f32 v73, v73, v77
 v_mov_b32 v41, v73
 v_fmac_f32 v41, 0x42800000, v72
 v_mul_f32 v38, 0x3d800000, v38
 v_sub_f32 v80, v80, v38
 v_sub_f32 v82, v82, v38
 v_sub_f32 v84, v84, v38
 v_sub_f32 v86, v86, v38
 v_mul_f32 v80, v80, v80
 v_mul_f32 v82, v82, v82
 v_mul_f32 v84, v84, v84
 v_mul_f32 v86, v86, v86
 v_add_f32 v80, v80, v82
 v_add_f32 v84, v84, v86
 v_add_f32 v80, v80, v84
 v_add_f32 v81, v81, v83
 v_add_f32 v85, v85, v87
 v_add_f32 v81, v81, v85
 v_mov_b32 v42, v81
 v_fmac_f32 v42, 0x42800000, v80
 v_mul_f32 v39, 0x3d800000, v39
 v_sub_f32 v88, v88, v39
 v_sub_f32 v90, v90, v39
 v_sub_f32 v92, v92, v39
 v_sub_f32 v94, v94, v39
 v_mul_f32 v88, v88, v88
 v_mul_f32 v90, v90, v90
 v_mul_f32 v92, v92, v92
 v_mul_f32 v94, v94, v94
 v_add_f32 v88, v88, v90
 v_add_f32 v92, v92, v94
 v_add_f32 v88, v88, v92
 v_add_f32 v89, v89, v91
 v_add_f32 v93, v93, v95
 v_add_f32 v89, v89, v93
 v_mov_b32 v43, v89
 v_fmac_f32 v43, 0x42800000, v88
 v_mov_b32 v44, v40
 v_mov_b32 v45, v41
 v_mov_b32 v46, v42
 v_mov_b32 v47, v43
 v_permlane16_swap_b32 v40, v44
 v_permlane16_swap_b32 v41, v45
 v_permlane16_swap_b32 v42, v46
 v_permlane16_swap_b32 v43, v47
 v_add_f32 v40, v40, v44
 v_add_f32 v41, v41, v45
 v_add_f32 v42, v42, v46
 v_add_f32 v43, v43, v47
 v_mov_b32 v44, v40
 v_mov_b32 v45, v41
 v_mov_b32 v46, v42
 v_mov_b32 v47, v43
 v_permlane32_swap_b32 v40, v44
 v_permlane32_swap_b32 v41, v45
 v_permlane32_swap_b32 v42, v46
 v_permlane32_swap_b32 v43, v47
 v_add_f32 v40, v40, v44
 v_add_f32 v41, v41, v45
 v_add_f32 v42, v42, v46
 v_add_f32 v43, v43, v47
 v_mov_b32 v44, 0x3727c5ac
 v_fmac_f32 v44, 0x3a800000, v40
 v_sqrt_f32 v40, v44
 v_mov_b32 v45, 0x3727c5ac
 v_fmac_f32 v45, 0x3a800000, v41
 v_sqrt_f32 v41, v45
 v_mov_b32 v46, 0x3727c5ac
 v_fmac_f32 v46, 0x3a800000, v42
 v_sqrt_f32 v42, v46
 v_mov_b32 v47, 0x3727c5ac
 v_fmac_f32 v47, 0x3a800000, v43
 v_sqrt_f32 v43, v47
 v_mov_b32 v64, v40
 v_mov_b32 v65, v40
 v_sub_f32 v72, 0, v36
 v_sub_f32 v73, 0, v36
 v_mov_b32 v66, v41
 v_mov_b32 v67, v41
 v_sub_f32 v74, 0, v37
 v_sub_f32 v75, 0, v37
 v_mov_b32 v68, v42
 v_mov_b32 v69, v42
 v_sub_f32 v76, 0, v38
 v_sub_f32 v77, 0, v38
 v_mov_b32 v70, v43
 v_mov_b32 v71, v43
 v_sub_f32 v78, 0, v39
 v_sub_f32 v79, 0, v39
 v_pk_mul_f32 v[128:129], v[48:49], v[64:65]
 v_pk_mul_f32 v[130:131], v[50:51], v[64:65]
 v_pk_fma_f32 v[128:129], v[96:97], v[72:73], v[128:129]
 v_pk_fma_f32 v[130:131], v[98:99], v[72:73], v[130:131]
 v_pk_mul_f32 v[132:133], v[48:49], v[66:67]
 v_pk_mul_f32 v[134:135], v[50:51], v[66:67]
 v_pk_fma_f32 v[132:133], v[96:97], v[74:75], v[132:133]
 v_pk_fma_f32 v[134:135], v[98:99], v[74:75], v[134:135]
 v_pk_mul_f32 v[136:137], v[48:49], v[68:69]
 v_pk_mul_f32 v[138:139], v[50:51], v[68:69]
 v_pk_fma_f32 v[136:137], v[96:97], v[76:77], v[136:137]
 v_pk_fma_f32 v[138:139], v[98:99], v[76:77], v[138:139]
 v_pk_mul_f32 v[140:141], v[48:49], v[70:71]
 v_pk_mul_f32 v[142:143], v[50:51], v[70:71]
 v_pk_fma_f32 v[140:141], v[96:97], v[78:79], v[140:141]
 v_pk_fma_f32 v[142:143], v[98:99], v[78:79], v[142:143]
 v_pk_mul_f32 v[144:145], v[52:53], v[64:65]
 v_pk_mul_f32 v[146:147], v[54:55], v[64:65]
 v_pk_fma_f32 v[144:145], v[100:101], v[72:73], v[144:145]
 v_pk_fma_f32 v[146:147], v[102:103], v[72:73], v[146:147]
 v_pk_mul_f32 v[148:149], v[52:53], v[66:67]
 v_pk_mul_f32 v[150:151], v[54:55], v[66:67]
 v_pk_fma_f32 v[148:149], v[100:101], v[74:75], v[148:149]
 v_pk_fma_f32 v[150:151], v[102:103], v[74:75], v[150:151]
 v_pk_mul_f32 v[152:153], v[52:53], v[68:69]
 v_pk_mul_f32 v[154:155], v[54:55], v[68:69]
 v_pk_fma_f32 v[152:153], v[100:101], v[76:77], v[152:153]
 v_pk_fma_f32 v[154:155], v[102:103], v[76:77], v[154:155]
 v_pk_mul_f32 v[156:157], v[52:53], v[70:71]
 v_pk_mul_f32 v[158:159], v[54:55], v[70:71]
 v_pk_fma_f32 v[156:157], v[100:101], v[78:79], v[156:157]
 v_pk_fma_f32 v[158:159], v[102:103], v[78:79], v[158:159]
 v_pk_mul_f32 v[160:161], v[56:57], v[64:65]
 v_pk_mul_f32 v[162:163], v[58:59], v[64:65]
 v_pk_fma_f32 v[160:161], v[104:105], v[72:73], v[160:161]
 v_pk_fma_f32 v[162:163], v[106:107], v[72:73], v[162:163]
 v_pk_mul_f32 v[164:165], v[56:57], v[66:67]
 v_pk_mul_f32 v[166:167], v[58:59], v[66:67]
 v_pk_fma_f32 v[164:165], v[104:105], v[74:75], v[164:165]
 v_pk_fma_f32 v[166:167], v[106:107], v[74:75], v[166:167]
 v_pk_mul_f32 v[168:169], v[56:57], v[68:69]
 v_pk_mul_f32 v[170:171], v[58:59], v[68:69]
 v_pk_fma_f32 v[168:169], v[104:105], v[76:77], v[168:169]
 v_pk_fma_f32 v[170:171], v[106:107], v[76:77], v[170:171]
 v_pk_mul_f32 v[172:173], v[56:57], v[70:71]
 v_pk_mul_f32 v[174:175], v[58:59], v[70:71]
 v_pk_fma_f32 v[172:173], v[104:105], v[78:79], v[172:173]
 v_pk_fma_f32 v[174:175], v[106:107], v[78:79], v[174:175]
 v_pk_mul_f32 v[176:177], v[60:61], v[64:65]
 v_pk_mul_f32 v[178:179], v[62:63], v[64:65]
 v_pk_fma_f32 v[176:177], v[108:109], v[72:73], v[176:177]
 v_pk_fma_f32 v[178:179], v[110:111], v[72:73], v[178:179]
 v_pk_mul_f32 v[180:181], v[60:61], v[66:67]
 v_pk_mul_f32 v[182:183], v[62:63], v[66:67]
 v_pk_fma_f32 v[180:181], v[108:109], v[74:75], v[180:181]
 v_pk_fma_f32 v[182:183], v[110:111], v[74:75], v[182:183]
 v_pk_mul_f32 v[184:185], v[60:61], v[68:69]
 v_pk_mul_f32 v[186:187], v[62:63], v[68:69]
 v_pk_fma_f32 v[184:185], v[108:109], v[76:77], v[184:185]
 v_pk_fma_f32 v[186:187], v[110:111], v[76:77], v[186:187]
 v_pk_mul_f32 v[188:189], v[60:61], v[70:71]
 v_pk_mul_f32 v[190:191], v[62:63], v[70:71]
 v_pk_fma_f32 v[188:189], v[108:109], v[78:79], v[188:189]
 v_pk_fma_f32 v[190:191], v[110:111], v[78:79], v[190:191]
 v_pk_mul_f32 v[192:193], v[20:21], v[64:65]
 v_pk_mul_f32 v[194:195], v[22:23], v[64:65]
 v_pk_fma_f32 v[192:193], v[112:113], v[72:73], v[192:193]
 v_pk_fma_f32 v[194:195], v[114:115], v[72:73], v[194:195]
 v_pk_mul_f32 v[196:197], v[20:21], v[66:67]
 v_pk_mul_f32 v[198:199], v[22:23], v[66:67]
 v_pk_fma_f32 v[196:197], v[112:113], v[74:75], v[196:197]
 v_pk_fma_f32 v[198:199], v[114:115], v[74:75], v[198:199]
 v_pk_mul_f32 v[200:201], v[20:21], v[68:69]
 v_pk_mul_f32 v[202:203], v[22:23], v[68:69]
 v_pk_fma_f32 v[200:201], v[112:113], v[76:77], v[200:201]
 v_pk_fma_f32 v[202:203], v[114:115], v[76:77], v[202:203]
 v_pk_mul_f32 v[204:205], v[20:21], v[70:71]
 v_pk_mul_f32 v[206:207], v[22:23], v[70:71]
 v_pk_fma_f32 v[204:205], v[112:113], v[78:79], v[204:205]
 v_pk_fma_f32 v[206:207], v[114:115], v[78:79], v[206:207]
 v_pk_mul_f32 v[208:209], v[24:25], v[64:65]
 v_pk_mul_f32 v[210:211], v[26:27], v[64:65]
 v_pk_fma_f32 v[208:209], v[116:117], v[72:73], v[208:209]
 v_pk_fma_f32 v[210:211], v[118:119], v[72:73], v[210:211]
 v_pk_mul_f32 v[212:213], v[24:25], v[66:67]
 v_pk_mul_f32 v[214:215], v[26:27], v[66:67]
 v_pk_fma_f32 v[212:213], v[116:117], v[74:75], v[212:213]
 v_pk_fma_f32 v[214:215], v[118:119], v[74:75], v[214:215]
 v_pk_mul_f32 v[216:217], v[24:25], v[68:69]
 v_pk_mul_f32 v[218:219], v[26:27], v[68:69]
 v_pk_fma_f32 v[216:217], v[116:117], v[76:77], v[216:217]
 v_pk_fma_f32 v[218:219], v[118:119], v[76:77], v[218:219]
 v_pk_mul_f32 v[220:221], v[24:25], v[70:71]
 v_pk_mul_f32 v[222:223], v[26:27], v[70:71]
 v_pk_fma_f32 v[220:221], v[116:117], v[78:79], v[220:221]
 v_pk_fma_f32 v[222:223], v[118:119], v[78:79], v[222:223]
 v_pk_mul_f32 v[224:225], v[28:29], v[64:65]
 v_pk_mul_f32 v[226:227], v[30:31], v[64:65]
 v_pk_fma_f32 v[224:225], v[120:121], v[72:73], v[224:225]
 v_pk_fma_f32 v[226:227], v[122:123], v[72:73], v[226:227]
 v_pk_mul_f32 v[228:229], v[28:29], v[66:67]
 v_pk_mul_f32 v[230:231], v[30:31], v[66:67]
 v_pk_fma_f32 v[228:229], v[120:121], v[74:75], v[228:229]
 v_pk_fma_f32 v[230:231], v[122:123], v[74:75], v[230:231]
 v_pk_mul_f32 v[232:233], v[28:29], v[68:69]
 v_pk_mul_f32 v[234:235], v[30:31], v[68:69]
 v_pk_fma_f32 v[232:233], v[120:121], v[76:77], v[232:233]
 v_pk_fma_f32 v[234:235], v[122:123], v[76:77], v[234:235]
 v_pk_mul_f32 v[236:237], v[28:29], v[70:71]
 v_pk_mul_f32 v[238:239], v[30:31], v[70:71]
 v_pk_fma_f32 v[236:237], v[120:121], v[78:79], v[236:237]
 v_pk_fma_f32 v[238:239], v[122:123], v[78:79], v[238:239]
 v_pk_mul_f32 v[240:241], v[32:33], v[64:65]
 v_pk_mul_f32 v[242:243], v[34:35], v[64:65]
 v_pk_fma_f32 v[240:241], v[124:125], v[72:73], v[240:241]
 v_pk_fma_f32 v[242:243], v[126:127], v[72:73], v[242:243]
 v_pk_mul_f32 v[244:245], v[32:33], v[66:67]
 v_pk_mul_f32 v[246:247], v[34:35], v[66:67]
 v_pk_fma_f32 v[244:245], v[124:125], v[74:75], v[244:245]
 v_pk_fma_f32 v[246:247], v[126:127], v[74:75], v[246:247]
 v_pk_mul_f32 v[248:249], v[32:33], v[68:69]
 v_pk_mul_f32 v[250:251], v[34:35], v[68:69]
 v_pk_fma_f32 v[248:249], v[124:125], v[76:77], v[248:249]
 v_pk_fma_f32 v[250:251], v[126:127], v[76:77], v[250:251]
 v_pk_mul_f32 v[252:253], v[32:33], v[70:71]
 v_pk_mul_f32 v[254:255], v[34:35], v[70:71]
 v_pk_fma_f32 v[252:253], v[124:125], v[78:79], v[252:253]
 v_pk_fma_f32 v[254:255], v[126:127], v[78:79], v[254:255]
 s_add_u32 m0, s27, 49152
 s_mov_b32 s28, 0
 s_waitcnt vmcnt(0)
 s_barrier
 ds_read_b64_tr_b16 a[64:65], v4 offset:0
 ds_read_b64_tr_b16 a[66:67], v4 offset:4096
 ds_read_b64_tr_b16 a[68:69], v5 offset:0
 ds_read_b64_tr_b16 a[70:71], v5 offset:4096
 ds_read_b64_tr_b16 a[72:73], v6 offset:0
 ds_read_b64_tr_b16 a[74:75], v6 offset:4096
 ds_read_b64_tr_b16 a[76:77], v7 offset:0
 ds_read_b64_tr_b16 a[78:79], v7 offset:4096
 ds_read_b64_tr_b16 a[80:81], v8 offset:0
 ds_read_b64_tr_b16 a[82:83], v8 offset:4096
 ds_read_b64_tr_b16 a[84:85], v9 offset:0
 ds_read_b64_tr_b16 a[86:87], v9 offset:4096
 ds_read_b64_tr_b16 a[88:89], v10 offset:0
 ds_read_b64_tr_b16 a[90:91], v10 offset:4096
 ds_read_b64_tr_b16 a[92:93], v11 offset:0
 ds_read_b64_tr_b16 a[94:95], v11 offset:4096
w1_loop:
 s_waitcnt vmcnt(14) lgkmcnt(0)
 v_mfma_f32_16x16x32_bf16 v[128:131], a[64:67], a[0:3], v[128:131]
 ds_read_b64_tr_b16 a[96:97], v4 offset:8192
 ds_read_b64_tr_b16 a[98:99], v4 offset:12288
 v_mfma_f32_16x16x32_bf16 v[132:135], a[64:67], a[4:7], v[132:135]
 buffer_load_dwordx4 a[48:51], v12, s[8:11], s26 offen offset:3072 sc1
 v_mfma_f32_16x16x32_bf16 v[136:139], a[64:67], a[8:11], v[136:139]
 v_mfma_f32_16x16x32_bf16 v[140:143], a[64:67], a[12:15], v[140:143]
 v_mfma_f32_16x16x32_bf16 v[156:159], a[68:71], a[12:15], v[156:159]
 ds_read_b64_tr_b16 a[100:101], v5 offset:8192
 ds_read_b64_tr_b16 a[102:103], v5 offset:12288
 v_mfma_f32_16x16x32_bf16 v[152:155], a[68:71], a[8:11], v[152:155]
 buffer_load_dwordx4 a[52:55], v13, s[8:11], s26 offen offset:3072 sc1
 v_mfma_f32_16x16x32_bf16 v[148:151], a[68:71], a[4:7], v[148:151]
 v_mfma_f32_16x16x32_bf16 v[144:147], a[68:71], a[0:3], v[144:147]
 v_mfma_f32_16x16x32_bf16 v[160:163], a[72:75], a[0:3], v[160:163]
 ds_read_b64_tr_b16 a[104:105], v6 offset:8192
 ds_read_b64_tr_b16 a[106:107], v6 offset:12288
 v_mfma_f32_16x16x32_bf16 v[164:167], a[72:75], a[4:7], v[164:167]
 v_mfma_f32_16x16x32_bf16 v[168:171], a[72:75], a[8:11], v[168:171]
 v_mfma_f32_16x16x32_bf16 v[172:175], a[72:75], a[12:15], v[172:175]
 buffer_load_dwordx4 a[56:59], v14, s[8:11], s26 offen offset:3072 sc1
 v_mfma_f32_16x16x32_bf16 v[188:191], a[76:79], a[12:15], v[188:191]
 ds_read_b64_tr_b16 a[108:109], v7 offset:8192
 ds_read_b64_tr_b16 a[110:111], v7 offset:12288
 v_mfma_f32_16x16x32_bf16 v[184:187], a[76:79], a[8:11], v[184:187]
 v_mfma_f32_16x16x32_bf16 v[180:183], a[76:79], a[4:7], v[180:183]
 v_mfma_f32_16x16x32_bf16 v[176:179], a[76:79], a[0:3], v[176:179]
 v_mfma_f32_16x16x32_bf16 v[192:195], a[80:83], a[0:3], v[192:195]
 ds_read_b64_tr_b16 a[112:113], v8 offset:8192
 ds_read_b64_tr_b16 a[114:115], v8 offset:12288
 v_mfma_f32_16x16x32_bf16 v[196:199], a[80:83], a[4:7], v[196:199]
 buffer_load_dwordx4 a[60:63], v15, s[8:11], s26 offen offset:3072 sc1
 s_add_u32 s26, s26, 4096
 v_mfma_f32_16x16x32_bf16 v[200:203], a[80:83], a[8:11], v[200:203]
 v_mfma_f32_16x16x32_bf16 v[204:207], a[80:83], a[12:15], v[204:207]
 v_mfma_f32_16x16x32_bf16 v[220:223], a[84:87], a[12:15], v[220:223]
 ds_read_b64_tr_b16 a[116:117], v9 offset:8192
 ds_read_b64_tr_b16 a[118:119], v9 offset:12288
 v_mfma_f32_16x16x32_bf16 v[216:219], a[84:87], a[8:11], v[216:219]
 s_add_u32 s29, s20, 55296
 buffer_load_dwordx4 v2, s[12:15], s29 offen offset:2048 lds
 v_mfma_f32_16x16x32_bf16 v[212:215], a[84:87], a[4:7], v[212:215]
 v_mfma_f32_16x16x32_bf16 v[208:211], a[84:87], a[0:3], v[208:211]
 v_mfma_f32_16x16x32_bf16 v[224:227], a[88:91], a[0:3], v[224:227]
 ds_read_b64_tr_b16 a[120:121], v10 offset:8192
 ds_read_b64_tr_b16 a[122:123], v10 offset:12288
 v_mfma_f32_16x16x32_bf16 v[228:231], a[88:91], a[4:7], v[228:231]
 v_mfma_f32_16x16x32_bf16 v[232:235], a[88:91], a[8:11], v[232:235]
 v_mfma_f32_16x16x32_bf16 v[236:239], a[88:91], a[12:15], v[236:239]
 s_add_u32 s29, s20, 82944
 buffer_load_dwordx4 v3, s[12:15], s29 offen offset:3072 lds
 s_add_u32 s20, s20, 458752
 v_mfma_f32_16x16x32_bf16 v[252:255], a[92:95], a[12:15], v[252:255]
 ds_read_b64_tr_b16 a[124:125], v11 offset:8192
 ds_read_b64_tr_b16 a[126:127], v11 offset:12288
 v_mfma_f32_16x16x32_bf16 v[248:251], a[92:95], a[8:11], v[248:251]
 v_mfma_f32_16x16x32_bf16 v[244:247], a[92:95], a[4:7], v[244:247]
 v_mfma_f32_16x16x32_bf16 v[240:243], a[92:95], a[0:3], v[240:243]
 s_waitcnt vmcnt(14) lgkmcnt(0)
 s_barrier
 v_mfma_f32_16x16x32_bf16 v[128:131], a[96:99], a[16:19], v[128:131]
 ds_read_b64_tr_b16 a[64:65], v4 offset:16384
 ds_read_b64_tr_b16 a[66:67], v4 offset:20480
 v_mfma_f32_16x16x32_bf16 v[132:135], a[96:99], a[20:23], v[132:135]
 buffer_load_dwordx4 a[0:3], v12, s[8:11], s26 offen sc1
 v_mfma_f32_16x16x32_bf16 v[136:139], a[96:99], a[24:27], v[136:139]
 v_mfma_f32_16x16x32_bf16 v[140:143], a[96:99], a[28:31], v[140:143]
 v_mfma_f32_16x16x32_bf16 v[156:159], a[100:103], a[28:31], v[156:159]
 ds_read_b64_tr_b16 a[68:69], v5 offset:16384
 ds_read_b64_tr_b16 a[70:71], v5 offset:20480
 v_mfma_f32_16x16x32_bf16 v[152:155], a[100:103], a[24:27], v[152:155]
 buffer_load_dwordx4 a[4:7], v13, s[8:11], s26 offen sc1
 v_mfma_f32_16x16x32_bf16 v[148:151], a[100:103], a[20:23], v[148:151]
 v_mfma_f32_16x16x32_bf16 v[144:147], a[100:103], a[16:19], v[144:147]
 v_mfma_f32_16x16x32_bf16 v[160:163], a[104:107], a[16:19], v[160:163]
 ds_read_b64_tr_b16 a[72:73], v6 offset:16384
 ds_read_b64_tr_b16 a[74:75], v6 offset:20480
 v_mfma_f32_16x16x32_bf16 v[164:167], a[104:107], a[20:23], v[164:167]
 v_mfma_f32_16x16x32_bf16 v[168:171], a[104:107], a[24:27], v[168:171]
 v_mfma_f32_16x16x32_bf16 v[172:175], a[104:107], a[28:31], v[172:175]
 buffer_load_dwordx4 a[8:11], v14, s[8:11], s26 offen sc1
 v_mfma_f32_16x16x32_bf16 v[188:191], a[108:111], a[28:31], v[188:191]
 ds_read_b64_tr_b16 a[76:77], v7 offset:16384
 ds_read_b64_tr_b16 a[78:79], v7 offset:20480
 v_mfma_f32_16x16x32_bf16 v[184:187], a[108:111], a[24:27], v[184:187]
 v_mfma_f32_16x16x32_bf16 v[180:183], a[108:111], a[20:23], v[180:183]
 v_mfma_f32_16x16x32_bf16 v[176:179], a[108:111], a[16:19], v[176:179]
 v_mfma_f32_16x16x32_bf16 v[192:195], a[112:115], a[16:19], v[192:195]
 ds_read_b64_tr_b16 a[80:81], v8 offset:16384
 ds_read_b64_tr_b16 a[82:83], v8 offset:20480
 v_mfma_f32_16x16x32_bf16 v[196:199], a[112:115], a[20:23], v[196:199]
 buffer_load_dwordx4 a[12:15], v15, s[8:11], s26 offen sc1
 v_mfma_f32_16x16x32_bf16 v[200:203], a[112:115], a[24:27], v[200:203]
 v_mfma_f32_16x16x32_bf16 v[204:207], a[112:115], a[28:31], v[204:207]
 v_mfma_f32_16x16x32_bf16 v[220:223], a[116:119], a[28:31], v[220:223]
 ds_read_b64_tr_b16 a[84:85], v9 offset:16384
 ds_read_b64_tr_b16 a[86:87], v9 offset:20480
 v_mfma_f32_16x16x32_bf16 v[216:219], a[116:119], a[24:27], v[216:219]
 s_add_u32 m0, s27, 0
 s_nop 0
 buffer_load_dwordx4 v2, s[12:15], s20 offen lds
 v_mfma_f32_16x16x32_bf16 v[212:215], a[116:119], a[20:23], v[212:215]
 v_mfma_f32_16x16x32_bf16 v[208:211], a[116:119], a[16:19], v[208:211]
 v_mfma_f32_16x16x32_bf16 v[224:227], a[120:123], a[16:19], v[224:227]
 ds_read_b64_tr_b16 a[88:89], v10 offset:16384
 ds_read_b64_tr_b16 a[90:91], v10 offset:20480
 v_mfma_f32_16x16x32_bf16 v[228:231], a[120:123], a[20:23], v[228:231]
 v_mfma_f32_16x16x32_bf16 v[232:235], a[120:123], a[24:27], v[232:235]
 v_mfma_f32_16x16x32_bf16 v[236:239], a[120:123], a[28:31], v[236:239]
 s_add_u32 s29, s20, 27648
 buffer_load_dwordx4 v3, s[12:15], s29 offen offset:1024 lds
 v_mfma_f32_16x16x32_bf16 v[252:255], a[124:127], a[28:31], v[252:255]
 ds_read_b64_tr_b16 a[92:93], v11 offset:16384
 ds_read_b64_tr_b16 a[94:95], v11 offset:20480
 v_mfma_f32_16x16x32_bf16 v[248:251], a[124:127], a[24:27], v[248:251]
 v_mfma_f32_16x16x32_bf16 v[244:247], a[124:127], a[20:23], v[244:247]
 v_mfma_f32_16x16x32_bf16 v[240:243], a[124:127], a[16:19], v[240:243]
 s_waitcnt vmcnt(14) lgkmcnt(0)
 v_mfma_f32_16x16x32_bf16 v[128:131], a[64:67], a[32:35], v[128:131]
 ds_read_b64_tr_b16 a[96:97], v4 offset:24576
 ds_read_b64_tr_b16 a[98:99], v4 offset:28672
 v_mfma_f32_16x16x32_bf16 v[132:135], a[64:67], a[36:39], v[132:135]
 buffer_load_dwordx4 a[16:19], v12, s[8:11], s26 offen offset:1024 sc1
 v_mfma_f32_16x16x32_bf16 v[136:139], a[64:67], a[40:43], v[136:139]
 v_mfma_f32_16x16x32_bf16 v[140:143], a[64:67], a[44:47], v[140:143]
 v_mfma_f32_16x16x32_bf16 v[156:159], a[68:71], a[44:47], v[156:159]
 ds_read_b64_tr_b16 a[100:101], v5 offset:24576
 ds_read_b64_tr_b16 a[102:103], v5 offset:28672
 v_mfma_f32_16x16x32_bf16 v[152:155], a[68:71], a[40:43], v[152:155]
 buffer_load_dwordx4 a[20:23], v13, s[8:11], s26 offen offset:1024 sc1
 v_mfma_f32_16x16x32_bf16 v[148:151], a[68:71], a[36:39], v[148:151]
 v_mfma_f32_16x16x32_bf16 v[144:147], a[68:71], a[32:35], v[144:147]
 v_mfma_f32_16x16x32_bf16 v[160:163], a[72:75], a[32:35], v[160:163]
 ds_read_b64_tr_b16 a[104:105], v6 offset:24576
 ds_read_b64_tr_b16 a[106:107], v6 offset:28672
 v_mfma_f32_16x16x32_bf16 v[164:167], a[72:75], a[36:39], v[164:167]
 v_mfma_f32_16x16x32_bf16 v[168:171], a[72:75], a[40:43], v[168:171]
 v_mfma_f32_16x16x32_bf16 v[172:175], a[72:75], a[44:47], v[172:175]
 buffer_load_dwordx4 a[24:27], v14, s[8:11], s26 offen offset:1024 sc1
 v_mfma_f32_16x16x32_bf16 v[188:191], a[76:79], a[44:47], v[188:191]
 ds_read_b64_tr_b16 a[108:109], v7 offset:24576
 ds_read_b64_tr_b16 a[110:111], v7 offset:28672
 v_mfma_f32_16x16x32_bf16 v[184:187], a[76:79], a[40:43], v[184:187]
 v_mfma_f32_16x16x32_bf16 v[180:183], a[76:79], a[36:39], v[180:183]
 v_mfma_f32_16x16x32_bf16 v[176:179], a[76:79], a[32:35], v[176:179]
 v_mfma_f32_16x16x32_bf16 v[192:195], a[80:83], a[32:35], v[192:195]
 ds_read_b64_tr_b16 a[112:113], v8 offset:24576
 ds_read_b64_tr_b16 a[114:115], v8 offset:28672
 v_mfma_f32_16x16x32_bf16 v[196:199], a[80:83], a[36:39], v[196:199]
 buffer_load_dwordx4 a[28:31], v15, s[8:11], s26 offen offset:1024 sc1
 v_mfma_f32_16x16x32_bf16 v[200:203], a[80:83], a[40:43], v[200:203]
 v_mfma_f32_16x16x32_bf16 v[204:207], a[80:83], a[44:47], v[204:207]
 v_mfma_f32_16x16x32_bf16 v[220:223], a[84:87], a[44:47], v[220:223]
 ds_read_b64_tr_b16 a[116:117], v9 offset:24576
 ds_read_b64_tr_b16 a[118:119], v9 offset:28672
 v_mfma_f32_16x16x32_bf16 v[216:219], a[84:87], a[40:43], v[216:219]
 s_add_u32 s29, s20, 55296
 buffer_load_dwordx4 v2, s[12:15], s29 offen offset:2048 lds
 v_mfma_f32_16x16x32_bf16 v[212:215], a[84:87], a[36:39], v[212:215]
 v_mfma_f32_16x16x32_bf16 v[208:211], a[84:87], a[32:35], v[208:211]
 v_mfma_f32_16x16x32_bf16 v[224:227], a[88:91], a[32:35], v[224:227]
 ds_read_b64_tr_b16 a[120:121], v10 offset:24576
 ds_read_b64_tr_b16 a[122:123], v10 offset:28672
 v_mfma_f32_16x16x32_bf16 v[228:231], a[88:91], a[36:39], v[228:231]
 v_mfma_f32_16x16x32_bf16 v[232:235], a[88:91], a[40:43], v[232:235]
 v_mfma_f32_16x16x32_bf16 v[236:239], a[88:91], a[44:47], v[236:239]
 s_add_u32 s29, s20, 82944
 buffer_load_dwordx4 v3, s[12:15], s29 offen offset:3072 lds
 s_add_u32 s20, s20, 458752
 v_mfma_f32_16x16x32_bf16 v[252:255], a[92:95], a[44:47], v[252:255]
 ds_read_b64_tr_b16 a[124:125], v11 offset:24576
 ds_read_b64_tr_b16 a[126:127], v11 offset:28672
 v_mfma_f32_16x16x32_bf16 v[248:251], a[92:95], a[40:43], v[248:251]
 v_mfma_f32_16x16x32_bf16 v[244:247], a[92:95], a[36:39], v[244:247]
 v_mfma_f32_16x16x32_bf16 v[240:243], a[92:95], a[32:35], v[240:243]
 s_waitcnt vmcnt(14) lgkmcnt(0)
 s_barrier
 v_mfma_f32_16x16x32_bf16 v[128:131], a[96:99], a[48:51], v[128:131]
 ds_read_b64_tr_b16 a[64:65], v4 offset:32768
 ds_read_b64_tr_b16 a[66:67], v4 offset:36864
 v_mfma_f32_16x16x32_bf16 v[132:135], a[96:99], a[52:55], v[132:135]
 buffer_load_dwordx4 a[32:35], v12, s[8:11], s26 offen offset:2048 sc1
 v_mfma_f32_16x16x32_bf16 v[136:139], a[96:99], a[56:59], v[136:139]
 v_mfma_f32_16x16x32_bf16 v[140:143], a[96:99], a[60:63], v[140:143]
 v_mfma_f32_16x16x32_bf16 v[156:159], a[100:103], a[60:63], v[156:159]
 ds_read_b64_tr_b16 a[68:69], v5 offset:32768
 ds_read_b64_tr_b16 a[70:71], v5 offset:36864
 v_mfma_f32_16x16x32_bf16 v[152:155], a[100:103], a[56:59], v[152:155]
 buffer_load_dwordx4 a[36:39], v13, s[8:11], s26 offen offset:2048 sc1
 v_mfma_f32_16x16x32_bf16 v[148:151], a[100:103], a[52:55], v[148:151]
 v_mfma_f32_16x16x32_bf16 v[144:147], a[100:103], a[48:51], v[144:147]
 v_mfma_f32_16x16x32_bf16 v[160:163], a[104:107], a[48:51], v[160:163]
 ds_read_b64_tr_b16 a[72:73], v6 offset:32768
 ds_read_b64_tr_b16 a[74:75], v6 offset:36864
 v_mfma_f32_16x16x32_bf16 v[164:167], a[104:107], a[52:55], v[164:167]
 v_mfma_f32_16x16x32_bf16 v[168:171], a[104:107], a[56:59], v[168:171]
 v_mfma_f32_16x16x32_bf16 v[172:175], a[104:107], a[60:63], v[172:175]
 buffer_load_dwordx4 a[40:43], v14, s[8:11], s26 offen offset:2048 sc1
 v_mfma_f32_16x16x32_bf16 v[188:191], a[108:111], a[60:63], v[188:191]
 ds_read_b64_tr_b16 a[76:77], v7 offset:32768
 ds_read_b64_tr_b16 a[78:79], v7 offset:36864
 v_mfma_f32_16x16x32_bf16 v[184:187], a[108:111], a[56:59], v[184:187]
 v_mfma_f32_16x16x32_bf16 v[180:183], a[108:111], a[52:55], v[180:183]
 v_mfma_f32_16x16x32_bf16 v[176:179], a[108:111], a[48:51], v[176:179]
 v_mfma_f32_16x16x32_bf16 v[192:195], a[112:115], a[48:51], v[192:195]
 ds_read_b64_tr_b16 a[80:81], v8 offset:32768
 ds_read_b64_tr_b16 a[82:83], v8 offset:36864
 v_mfma_f32_16x16x32_bf16 v[196:199], a[112:115], a[52:55], v[196:199]
 buffer_load_dwordx4 a[44:47], v15, s[8:11], s26 offen offset:2048 sc1
 v_mfma_f32_16x16x32_bf16 v[200:203], a[112:115], a[56:59], v[200:203]
 v_mfma_f32_16x16x32_bf16 v[204:207], a[112:115], a[60:63], v[204:207]
 v_mfma_f32_16x16x32_bf16 v[220:223], a[116:119], a[60:63], v[220:223]
 ds_read_b64_tr_b16 a[84:85], v9 offset:32768
 ds_read_b64_tr_b16 a[86:87], v9 offset:36864
 v_mfma_f32_16x16x32_bf16 v[216:219], a[116:119], a[56:59], v[216:219]
 s_add_u32 m0, s27, 16384
 s_nop 0
 buffer_load_dwordx4 v2, s[12:15], s20 offen lds
 v_mfma_f32_16x16x32_bf16 v[212:215], a[116:119], a[52:55], v[212:215]
 v_mfma_f32_16x16x32_bf16 v[208:211], a[116:119], a[48:51], v[208:211]
 v_mfma_f32_16x16x32_bf16 v[224:227], a[120:123], a[48:51], v[224:227]
 ds_read_b64_tr_b16 a[88:89], v10 offset:32768
 ds_read_b64_tr_b16 a[90:91], v10 offset:36864
 v_mfma_f32_16x16x32_bf16 v[228:231], a[120:123], a[52:55], v[228:231]
 v_mfma_f32_16x16x32_bf16 v[232:235], a[120:123], a[56:59], v[232:235]
 v_mfma_f32_16x16x32_bf16 v[236:239], a[120:123], a[60:63], v[236:239]
 s_add_u32 s29, s20, 27648
 buffer_load_dwordx4 v3, s[12:15], s29 offen offset:1024 lds
 v_mfma_f32_16x16x32_bf16 v[252:255], a[124:127], a[60:63], v[252:255]
 ds_read_b64_tr_b16 a[92:93], v11 offset:32768
 ds_read_b64_tr_b16 a[94:95], v11 offset:36864
 v_mfma_f32_16x16x32_bf16 v[248:251], a[124:127], a[56:59], v[248:251]
 v_mfma_f32_16x16x32_bf16 v[244:247], a[124:127], a[52:55], v[244:247]
 v_mfma_f32_16x16x32_bf16 v[240:243], a[124:127], a[48:51], v[240:243]
 s_waitcnt vmcnt(14) lgkmcnt(0)
 v_mfma_f32_16x16x32_bf16 v[128:131], a[64:67], a[0:3], v[128:131]
 ds_read_b64_tr_b16 a[96:97], v4 offset:40960
 ds_read_b64_tr_b16 a[98:99], v4 offset:45056
 v_mfma_f32_16x16x32_bf16 v[132:135], a[64:67], a[4:7], v[132:135]
 buffer_load_dwordx4 a[48:51], v12, s[8:11], s26 offen offset:3072 sc1
 v_mfma_f32_16x16x32_bf16 v[136:139], a[64:67], a[8:11], v[136:139]
 v_mfma_f32_16x16x32_bf16 v[140:143], a[64:67], a[12:15], v[140:143]
 v_mfma_f32_16x16x32_bf16 v[156:159], a[68:71], a[12:15], v[156:159]
 ds_read_b64_tr_b16 a[100:101], v5 offset:40960
 ds_read_b64_tr_b16 a[102:103], v5 offset:45056
 v_mfma_f32_16x16x32_bf16 v[152:155], a[68:71], a[8:11], v[152:155]
 buffer_load_dwordx4 a[52:55], v13, s[8:11], s26 offen offset:3072 sc1
 v_mfma_f32_16x16x32_bf16 v[148:151], a[68:71], a[4:7], v[148:151]
 v_mfma_f32_16x16x32_bf16 v[144:147], a[68:71], a[0:3], v[144:147]
 v_mfma_f32_16x16x32_bf16 v[160:163], a[72:75], a[0:3], v[160:163]
 ds_read_b64_tr_b16 a[104:105], v6 offset:40960
 ds_read_b64_tr_b16 a[106:107], v6 offset:45056
 v_mfma_f32_16x16x32_bf16 v[164:167], a[72:75], a[4:7], v[164:167]
 v_mfma_f32_16x16x32_bf16 v[168:171], a[72:75], a[8:11], v[168:171]
 v_mfma_f32_16x16x32_bf16 v[172:175], a[72:75], a[12:15], v[172:175]
 buffer_load_dwordx4 a[56:59], v14, s[8:11], s26 offen offset:3072 sc1
 v_mfma_f32_16x16x32_bf16 v[188:191], a[76:79], a[12:15], v[188:191]
 ds_read_b64_tr_b16 a[108:109], v7 offset:40960
 ds_read_b64_tr_b16 a[110:111], v7 offset:45056
 v_mfma_f32_16x16x32_bf16 v[184:187], a[76:79], a[8:11], v[184:187]
 v_mfma_f32_16x16x32_bf16 v[180:183], a[76:79], a[4:7], v[180:183]
 v_mfma_f32_16x16x32_bf16 v[176:179], a[76:79], a[0:3], v[176:179]
 v_mfma_f32_16x16x32_bf16 v[192:195], a[80:83], a[0:3], v[192:195]
 ds_read_b64_tr_b16 a[112:113], v8 offset:40960
 ds_read_b64_tr_b16 a[114:115], v8 offset:45056
 v_mfma_f32_16x16x32_bf16 v[196:199], a[80:83], a[4:7], v[196:199]
 buffer_load_dwordx4 a[60:63], v15, s[8:11], s26 offen offset:3072 sc1
 s_add_u32 s26, s26, 4096
 v_mfma_f32_16x16x32_bf16 v[200:203], a[80:83], a[8:11], v[200:203]
 v_mfma_f32_16x16x32_bf16 v[204:207], a[80:83], a[12:15], v[204:207]
 v_mfma_f32_16x16x32_bf16 v[220:223], a[84:87], a[12:15], v[220:223]
 ds_read_b64_tr_b16 a[116:117], v9 offset:40960
 ds_read_b64_tr_b16 a[118:119], v9 offset:45056
 v_mfma_f32_16x16x32_bf16 v[216:219], a[84:87], a[8:11], v[216:219]
 s_add_u32 s29, s20, 55296
 buffer_load_dwordx4 v2, s[12:15], s29 offen offset:2048 lds
 v_mfma_f32_16x16x32_bf16 v[212:215], a[84:87], a[4:7], v[212:215]
 v_mfma_f32_16x16x32_bf16 v[208:211], a[84:87], a[0:3], v[208:211]
 v_mfma_f32_16x16x32_bf16 v[224:227], a[88:91], a[0:3], v[224:227]
 ds_read_b64_tr_b16 a[120:121], v10 offset:40960
 ds_read_b64_tr_b16 a[122:123], v10 offset:45056
 v_mfma_f32_16x16x32_bf16 v[228:231], a[88:91], a[4:7], v[228:231]
 v_mfma_f32_16x16x32_bf16 v[232:235], a[88:91], a[8:11], v[232:235]
 v_mfma_f32_16x16x32_bf16 v[236:239], a[88:91], a[12:15], v[236:239]
 s_add_u32 s29, s20, 82944
 buffer_load_dwordx4 v3, s[12:15], s29 offen offset:3072 lds
 s_add_u32 s20, s20, 458752
 v_mfma_f32_16x16x32_bf16 v[252:255], a[92:95], a[12:15], v[252:255]
 ds_read_b64_tr_b16 a[124:125], v11 offset:40960
 ds_read_b64_tr_b16 a[126:127], v11 offset:45056
 v_mfma_f32_16x16x32_bf16 v[248:251], a[92:95], a[8:11], v[248:251]
 v_mfma_f32_16x16x32_bf16 v[244:247], a[92:95], a[4:7], v[244:247]
 v_mfma_f32_16x16x32_bf16 v[240:243], a[92:95], a[0:3], v[240:243]
 s_waitcnt vmcnt(14) lgkmcnt(0)
 s_barrier
 v_mfma_f32_16x16x32_bf16 v[128:131], a[96:99], a[16:19], v[128:131]
 ds_read_b64_tr_b16 a[64:65], v4 offset:49152
 ds_read_b64_tr_b16 a[66:67], v4 offset:53248
 v_mfma_f32_16x16x32_bf16 v[132:135], a[96:99], a[20:23], v[132:135]
 buffer_load_dwordx4 a[0:3], v12, s[8:11], s26 offen sc1
 v_mfma_f32_16x16x32_bf16 v[136:139], a[96:99], a[24:27], v[136:139]
 v_mfma_f32_16x16x32_bf16 v[140:143], a[96:99], a[28:31], v[140:143]
 v_mfma_f32_16x16x32_bf16 v[156:159], a[100:103], a[28:31], v[156:159]
 ds_read_b64_tr_b16 a[68:69], v5 offset:49152
 ds_read_b64_tr_b16 a[70:71], v5 offset:53248
 v_mfma_f32_16x16x32_bf16 v[152:155], a[100:103], a[24:27], v[152:155]
 buffer_load_dwordx4 a[4:7], v13, s[8:11], s26 offen sc1
 v_mfma_f32_16x16x32_bf16 v[148:151], a[100:103], a[20:23], v[148:151]
 v_mfma_f32_16x16x32_bf16 v[144:147], a[100:103], a[16:19], v[144:147]
 v_mfma_f32_16x16x32_bf16 v[160:163], a[104:107], a[16:19], v[160:163]
 ds_read_b64_tr_b16 a[72:73], v6 offset:49152
 ds_read_b64_tr_b16 a[74:75], v6 offset:53248
 v_mfma_f32_16x16x32_bf16 v[164:167], a[104:107], a[20:23], v[164:167]
 v_mfma_f32_16x16x32_bf16 v[168:171], a[104:107], a[24:27], v[168:171]
 v_mfma_f32_16x16x32_bf16 v[172:175], a[104:107], a[28:31], v[172:175]
 buffer_load_dwordx4 a[8:11], v14, s[8:11], s26 offen sc1
 v_mfma_f32_16x16x32_bf16 v[188:191], a[108:111], a[28:31], v[188:191]
 ds_read_b64_tr_b16 a[76:77], v7 offset:49152
 ds_read_b64_tr_b16 a[78:79], v7 offset:53248
 v_mfma_f32_16x16x32_bf16 v[184:187], a[108:111], a[24:27], v[184:187]
 v_mfma_f32_16x16x32_bf16 v[180:183], a[108:111], a[20:23], v[180:183]
 v_mfma_f32_16x16x32_bf16 v[176:179], a[108:111], a[16:19], v[176:179]
 v_mfma_f32_16x16x32_bf16 v[192:195], a[112:115], a[16:19], v[192:195]
 ds_read_b64_tr_b16 a[80:81], v8 offset:49152
 ds_read_b64_tr_b16 a[82:83], v8 offset:53248
 v_mfma_f32_16x16x32_bf16 v[196:199], a[112:115], a[20:23], v[196:199]
 buffer_load_dwordx4 a[12:15], v15, s[8:11], s26 offen sc1
 v_mfma_f32_16x16x32_bf16 v[200:203], a[112:115], a[24:27], v[200:203]
 v_mfma_f32_16x16x32_bf16 v[204:207], a[112:115], a[28:31], v[204:207]
 v_mfma_f32_16x16x32_bf16 v[220:223], a[116:119], a[28:31], v[220:223]
 ds_read_b64_tr_b16 a[84:85], v9 offset:49152
 ds_read_b64_tr_b16 a[86:87], v9 offset:53248
 v_mfma_f32_16x16x32_bf16 v[216:219], a[116:119], a[24:27], v[216:219]
 s_add_u32 m0, s27, 32768
 s_nop 0
 buffer_load_dwordx4 v2, s[12:15], s20 offen lds
 v_mfma_f32_16x16x32_bf16 v[212:215], a[116:119], a[20:23], v[212:215]
 v_mfma_f32_16x16x32_bf16 v[208:211], a[116:119], a[16:19], v[208:211]
 v_mfma_f32_16x16x32_bf16 v[224:227], a[120:123], a[16:19], v[224:227]
 ds_read_b64_tr_b16 a[88:89], v10 offset:49152
 ds_read_b64_tr_b16 a[90:91], v10 offset:53248
 v_mfma_f32_16x16x32_bf16 v[228:231], a[120:123], a[20:23], v[228:231]
 v_mfma_f32_16x16x32_bf16 v[232:235], a[120:123], a[24:27], v[232:235]
 v_mfma_f32_16x16x32_bf16 v[236:239], a[120:123], a[28:31], v[236:239]
 s_add_u32 s29, s20, 27648
 buffer_load_dwordx4 v3, s[12:15], s29 offen offset:1024 lds
 v_mfma_f32_16x16x32_bf16 v[252:255], a[124:127], a[28:31], v[252:255]
 ds_read_b64_tr_b16 a[92:93], v11 offset:49152
 ds_read_b64_tr_b16 a[94:95], v11 offset:53248
 v_mfma_f32_16x16x32_bf16 v[248:251], a[124:127], a[24:27], v[248:251]
 v_mfma_f32_16x16x32_bf16 v[244:247], a[124:127], a[20:23], v[244:247]
 v_mfma_f32_16x16x32_bf16 v[240:243], a[124:127], a[16:19], v[240:243]
 s_waitcnt vmcnt(14) lgkmcnt(0)
 v_mfma_f32_16x16x32_bf16 v[128:131], a[64:67], a[32:35], v[128:131]
 ds_read_b64_tr_b16 a[96:97], v4 offset:57344
 ds_read_b64_tr_b16 a[98:99], v4 offset:61440
 v_mfma_f32_16x16x32_bf16 v[132:135], a[64:67], a[36:39], v[132:135]
 buffer_load_dwordx4 a[16:19], v12, s[8:11], s26 offen offset:1024 sc1
 v_mfma_f32_16x16x32_bf16 v[136:139], a[64:67], a[40:43], v[136:139]
 v_mfma_f32_16x16x32_bf16 v[140:143], a[64:67], a[44:47], v[140:143]
 v_mfma_f32_16x16x32_bf16 v[156:159], a[68:71], a[44:47], v[156:159]
 ds_read_b64_tr_b16 a[100:101], v5 offset:57344
 ds_read_b64_tr_b16 a[102:103], v5 offset:61440
 v_mfma_f32_16x16x32_bf16 v[152:155], a[68:71], a[40:43], v[152:155]
 buffer_load_dwordx4 a[20:23], v13, s[8:11], s26 offen offset:1024 sc1
 v_mfma_f32_16x16x32_bf16 v[148:151], a[68:71], a[36:39], v[148:151]
 v_mfma_f32_16x16x32_bf16 v[144:147], a[68:71], a[32:35], v[144:147]
 v_mfma_f32_16x16x32_bf16 v[160:163], a[72:75], a[32:35], v[160:163]
 ds_read_b64_tr_b16 a[104:105], v6 offset:57344
 ds_read_b64_tr_b16 a[106:107], v6 offset:61440
 v_mfma_f32_16x16x32_bf16 v[164:167], a[72:75], a[36:39], v[164:167]
 v_mfma_f32_16x16x32_bf16 v[168:171], a[72:75], a[40:43], v[168:171]
 v_mfma_f32_16x16x32_bf16 v[172:175], a[72:75], a[44:47], v[172:175]
 buffer_load_dwordx4 a[24:27], v14, s[8:11], s26 offen offset:1024 sc1
 v_mfma_f32_16x16x32_bf16 v[188:191], a[76:79], a[44:47], v[188:191]
 ds_read_b64_tr_b16 a[108:109], v7 offset:57344
 ds_read_b64_tr_b16 a[110:111], v7 offset:61440
 v_mfma_f32_16x16x32_bf16 v[184:187], a[76:79], a[40:43], v[184:187]
 v_mfma_f32_16x16x32_bf16 v[180:183], a[76:79], a[36:39], v[180:183]
 v_mfma_f32_16x16x32_bf16 v[176:179], a[76:79], a[32:35], v[176:179]
 v_mfma_f32_16x16x32_bf16 v[192:195], a[80:83], a[32:35], v[192:195]
 ds_read_b64_tr_b16 a[112:113], v8 offset:57344
 ds_read_b64_tr_b16 a[114:115], v8 offset:61440
 v_mfma_f32_16x16x32_bf16 v[196:199], a[80:83], a[36:39], v[196:199]
 buffer_load_dwordx4 a[28:31], v15, s[8:11], s26 offen offset:1024 sc1
 v_mfma_f32_16x16x32_bf16 v[200:203], a[80:83], a[40:43], v[200:203]
 v_mfma_f32_16x16x32_bf16 v[204:207], a[80:83], a[44:47], v[204:207]
 v_mfma_f32_16x16x32_bf16 v[220:223], a[84:87], a[44:47], v[220:223]
 ds_read_b64_tr_b16 a[116:117], v9 offset:57344
 ds_read_b64_tr_b16 a[118:119], v9 offset:61440
 v_mfma_f32_16x16x32_bf16 v[216:219], a[84:87], a[40:43], v[216:219]
 s_add_u32 s29, s20, 55296
 buffer_load_dwordx4 v2, s[12:15], s29 offen offset:2048 lds
 v_mfma_f32_16x16x32_bf16 v[212:215], a[84:87], a[36:39], v[212:215]
 v_mfma_f32_16x16x32_bf16 v[208:211], a[84:87], a[32:35], v[208:211]
 v_mfma_f32_16x16x32_bf16 v[224:227], a[88:91], a[32:35], v[224:227]
 ds_read_b64_tr_b16 a[120:121], v10 offset:57344
 ds_read_b64_tr_b16 a[122:123], v10 offset:61440
 v_mfma_f32_16x16x32_bf16 v[228:231], a[88:91], a[36:39], v[228:231]
 v_mfma_f32_16x16x32_bf16 v[232:235], a[88:91], a[40:43], v[232:235]
 v_mfma_f32_16x16x32_bf16 v[236:239], a[88:91], a[44:47], v[236:239]
 s_add_u32 s29, s20, 82944
 buffer_load_dwordx4 v3, s[12:15], s29 offen offset:3072 lds
 s_add_u32 s20, s20, 458752
 v_mfma_f32_16x16x32_bf16 v[252:255], a[92:95], a[44:47], v[252:255]
 ds_read_b64_tr_b16 a[124:125], v11 offset:57344
 ds_read_b64_tr_b16 a[126:127], v11 offset:61440
 v_mfma_f32_16x16x32_bf16 v[248:251], a[92:95], a[40:43], v[248:251]
 v_mfma_f32_16x16x32_bf16 v[244:247], a[92:95], a[36:39], v[244:247]
 v_mfma_f32_16x16x32_bf16 v[240:243], a[92:95], a[32:35], v[240:243]
 s_waitcnt vmcnt(14) lgkmcnt(0)
 s_barrier
 v_mfma_f32_16x16x32_bf16 v[128:131], a[96:99], a[48:51], v[128:131]
 ds_read_b64_tr_b16 a[64:65], v4 offset:0
 ds_read_b64_tr_b16 a[66:67], v4 offset:4096
 v_mfma_f32_16x16x32_bf16 v[132:135], a[96:99], a[52:55], v[132:135]
 buffer_load_dwordx4 a[32:35], v12, s[8:11], s26 offen offset:2048 sc1
 v_mfma_f32_16x16x32_bf16 v[136:139], a[96:99], a[56:59], v[136:139]
 v_mfma_f32_16x16x32_bf16 v[140:143], a[96:99], a[60:63], v[140:143]
 v_mfma_f32_16x16x32_bf16 v[156:159], a[100:103], a[60:63], v[156:159]
 ds_read_b64_tr_b16 a[68:69], v5 offset:0
 ds_read_b64_tr_b16 a[70:71], v5 offset:4096
 v_mfma_f32_16x16x32_bf16 v[152:155], a[100:103], a[56:59], v[152:155]
 buffer_load_dwordx4 a[36:39], v13, s[8:11], s26 offen offset:2048 sc1
 v_mfma_f32_16x16x32_bf16 v[148:151], a[100:103], a[52:55], v[148:151]
 v_mfma_f32_16x16x32_bf16 v[144:147], a[100:103], a[48:51], v[144:147]
 v_mfma_f32_16x16x32_bf16 v[160:163], a[104:107], a[48:51], v[160:163]
 ds_read_b64_tr_b16 a[72:73], v6 offset:0
 ds_read_b64_tr_b16 a[74:75], v6 offset:4096
 v_mfma_f32_16x16x32_bf16 v[164:167], a[104:107], a[52:55], v[164:167]
 v_mfma_f32_16x16x32_bf16 v[168:171], a[104:107], a[56:59], v[168:171]
 v_mfma_f32_16x16x32_bf16 v[172:175], a[104:107], a[60:63], v[172:175]
 buffer_load_dwordx4 a[40:43], v14, s[8:11], s26 offen offset:2048 sc1
 v_mfma_f32_16x16x32_bf16 v[188:191], a[108:111], a[60:63], v[188:191]
 ds_read_b64_tr_b16 a[76:77], v7 offset:0
 ds_read_b64_tr_b16 a[78:79], v7 offset:4096
 v_mfma_f32_16x16x32_bf16 v[184:187], a[108:111], a[56:59], v[184:187]
 v_mfma_f32_16x16x32_bf16 v[180:183], a[108:111], a[52:55], v[180:183]
 v_mfma_f32_16x16x32_bf16 v[176:179], a[108:111], a[48:51], v[176:179]
 v_mfma_f32_16x16x32_bf16 v[192:195], a[112:115], a[48:51], v[192:195]
 ds_read_b64_tr_b16 a[80:81], v8 offset:0
 ds_read_b64_tr_b16 a[82:83], v8 offset:4096
 v_mfma_f32_16x16x32_bf16 v[196:199], a[112:115], a[52:55], v[196:199]
 buffer_load_dwordx4 a[44:47], v15, s[8:11], s26 offen offset:2048 sc1
 v_mfma_f32_16x16x32_bf16 v[200:203], a[112:115], a[56:59], v[200:203]
 v_mfma_f32_16x16x32_bf16 v[204:207], a[112:115], a[60:63], v[204:207]
 v_mfma_f32_16x16x32_bf16 v[220:223], a[116:119], a[60:63], v[220:223]
 ds_read_b64_tr_b16 a[84:85], v9 offset:0
 ds_read_b64_tr_b16 a[86:87], v9 offset:4096
 v_mfma_f32_16x16x32_bf16 v[216:219], a[116:119], a[56:59], v[216:219]
 s_add_u32 m0, s27, 49152
 s_nop 0
 buffer_load_dwordx4 v2, s[12:15], s20 offen lds
 v_mfma_f32_16x16x32_bf16 v[212:215], a[116:119], a[52:55], v[212:215]
 v_mfma_f32_16x16x32_bf16 v[208:211], a[116:119], a[48:51], v[208:211]
 v_mfma_f32_16x16x32_bf16 v[224:227], a[120:123], a[48:51], v[224:227]
 ds_read_b64_tr_b16 a[88:89], v10 offset:0
 ds_read_b64_tr_b16 a[90:91], v10 offset:4096
 v_mfma_f32_16x16x32_bf16 v[228:231], a[120:123], a[52:55], v[228:231]
 v_mfma_f32_16x16x32_bf16 v[232:235], a[120:123], a[56:59], v[232:235]
 v_mfma_f32_16x16x32_bf16 v[236:239], a[120:123], a[60:63], v[236:239]
 s_add_u32 s29, s20, 27648
 buffer_load_dwordx4 v3, s[12:15], s29 offen offset:1024 lds
 v_mfma_f32_16x16x32_bf16 v[252:255], a[124:127], a[60:63], v[252:255]
 ds_read_b64_tr_b16 a[92:93], v11 offset:0
 ds_read_b64_tr_b16 a[94:95], v11 offset:4096
 v_mfma_f32_16x16x32_bf16 v[248:251], a[124:127], a[56:59], v[248:251]
 v_mfma_f32_16x16x32_bf16 v[244:247], a[124:127], a[52:55], v[244:247]
 v_mfma_f32_16x16x32_bf16 v[240:243], a[124:127], a[48:51], v[240:243]
 s_add_u32 s28, s28, 1
 s_cmp_lt_u32 s28, 4
 s_cbranch_scc1 w1_loop
 s_nop 7
 s_mul_i32 s42, s35, 114688
 s_lshl_b32 s43, s32, 12
 s_add_u32 s42, s42, s43
 s_add_u32 s42, s42, 33554432
 v_cvt_pk_bf16_f32 v24, v128, v129
 v_cvt_pk_bf16_f32 v25, v130, v131
 v_cvt_pk_bf16_f32 v26, v144, v145
 v_cvt_pk_bf16_f32 v27, v146, v147
 v_pk_max_i16 v24, v24, 0
 v_pk_max_i16 v25, v25, 0
 v_pk_max_i16 v26, v26, 0
 v_pk_max_i16 v27, v27, 0
 buffer_store_dwordx4 v[24:27], v16, s[8:11], s42 offen offset:0 sc1
 v_cvt_pk_bf16_f32 v28, v160, v161
 v_cvt_pk_bf16_f32 v29, v162, v163
 v_cvt_pk_bf16_f32 v30, v176, v177
 v_cvt_pk_bf16_f32 v31, v178, v179
 v_pk_max_i16 v28, v28, 0
 v_pk_max_i16 v29, v29, 0
 v_pk_max_i16 v30, v30, 0
 v_pk_max_i16 v31, v31, 0
 buffer_store_dwordx4 v[28:31], v16, s[8:11], s42 offen offset:1024 sc1
 v_cvt_pk_bf16_f32 v32, v192, v193
 v_cvt_pk_bf16_f32 v33, v194, v195
 v_cvt_pk_bf16_f32 v34, v208, v209
 v_cvt_pk_bf16_f32 v35, v210, v211
 v_pk_max_i16 v32, v32, 0
 v_pk_max_i16 v33, v33, 0
 v_pk_max_i16 v34, v34, 0
 v_pk_max_i16 v35, v35, 0
 buffer_store_dwordx4 v[32:35], v16, s[8:11], s42 offen offset:2048 sc1
 v_cvt_pk_bf16_f32 v36, v224, v225
 v_cvt_pk_bf16_f32 v37, v226, v227
 v_cvt_pk_bf16_f32 v38, v240, v241
 v_cvt_pk_bf16_f32 v39, v242, v243
 v_pk_max_i16 v36, v36, 0
 v_pk_max_i16 v37, v37, 0
 v_pk_max_i16 v38, v38, 0
 v_pk_max_i16 v39, v39, 0
 buffer_store_dwordx4 v[36:39], v16, s[8:11], s42 offen offset:3072 sc1
 s_add_u32 s42, s42, 114688
 v_cvt_pk_bf16_f32 v24, v132, v133
 v_cvt_pk_bf16_f32 v25, v134, v135
 v_cvt_pk_bf16_f32 v26, v148, v149
 v_cvt_pk_bf16_f32 v27, v150, v151
 v_pk_max_i16 v24, v24, 0
 v_pk_max_i16 v25, v25, 0
 v_pk_max_i16 v26, v26, 0
 v_pk_max_i16 v27, v27, 0
 buffer_store_dwordx4 v[24:27], v16, s[8:11], s42 offen offset:0 sc1
 v_cvt_pk_bf16_f32 v28, v164, v165
 v_cvt_pk_bf16_f32 v29, v166, v167
 v_cvt_pk_bf16_f32 v30, v180, v181
 v_cvt_pk_bf16_f32 v31, v182, v183
 v_pk_max_i16 v28, v28, 0
 v_pk_max_i16 v29, v29, 0
 v_pk_max_i16 v30, v30, 0
 v_pk_max_i16 v31, v31, 0
 buffer_store_dwordx4 v[28:31], v16, s[8:11], s42 offen offset:1024 sc1
 v_cvt_pk_bf16_f32 v32, v196, v197
 v_cvt_pk_bf16_f32 v33, v198, v199
 v_cvt_pk_bf16_f32 v34, v212, v213
 v_cvt_pk_bf16_f32 v35, v214, v215
 v_pk_max_i16 v32, v32, 0
 v_pk_max_i16 v33, v33, 0
 v_pk_max_i16 v34, v34, 0
 v_pk_max_i16 v35, v35, 0
 buffer_store_dwordx4 v[32:35], v16, s[8:11], s42 offen offset:2048 sc1
 v_cvt_pk_bf16_f32 v36, v228, v229
 v_cvt_pk_bf16_f32 v37, v230, v231
 v_cvt_pk_bf16_f32 v38, v244, v245
 v_cvt_pk_bf16_f32 v39, v246, v247
 v_pk_max_i16 v36, v36, 0
 v_pk_max_i16 v37, v37, 0
 v_pk_max_i16 v38, v38, 0
 v_pk_max_i16 v39, v39, 0
 buffer_store_dwordx4 v[36:39], v16, s[8:11], s42 offen offset:3072 sc1
 s_add_u32 s42, s42, 114688
 v_cvt_pk_bf16_f32 v24, v136, v137
 v_cvt_pk_bf16_f32 v25, v138, v139
 v_cvt_pk_bf16_f32 v26, v152, v153
 v_cvt_pk_bf16_f32 v27, v154, v155
 v_pk_max_i16 v24, v24, 0
 v_pk_max_i16 v25, v25, 0
 v_pk_max_i16 v26, v26, 0
 v_pk_max_i16 v27, v27, 0
 buffer_store_dwordx4 v[24:27], v16, s[8:11], s42 offen offset:0 sc1
 v_cvt_pk_bf16_f32 v28, v168, v169
 v_cvt_pk_bf16_f32 v29, v170, v171
 v_cvt_pk_bf16_f32 v30, v184, v185
 v_cvt_pk_bf16_f32 v31, v186, v187
 v_pk_max_i16 v28, v28, 0
 v_pk_max_i16 v29, v29, 0
 v_pk_max_i16 v30, v30, 0
 v_pk_max_i16 v31, v31, 0
 buffer_store_dwordx4 v[28:31], v16, s[8:11], s42 offen offset:1024 sc1
 v_cvt_pk_bf16_f32 v32, v200, v201
 v_cvt_pk_bf16_f32 v33, v202, v203
 v_cvt_pk_bf16_f32 v34, v216, v217
 v_cvt_pk_bf16_f32 v35, v218, v219
 v_pk_max_i16 v32, v32, 0
 v_pk_max_i16 v33, v33, 0
 v_pk_max_i16 v34, v34, 0
 v_pk_max_i16 v35, v35, 0
 buffer_store_dwordx4 v[32:35], v16, s[8:11], s42 offen offset:2048 sc1
 v_cvt_pk_bf16_f32 v36, v232, v233
 v_cvt_pk_bf16_f32 v37, v234, v235
 v_cvt_pk_bf16_f32 v38, v248, v249
 v_cvt_pk_bf16_f32 v39, v250, v251
 v_pk_max_i16 v36, v36, 0
 v_pk_max_i16 v37, v37, 0
 v_pk_max_i16 v38, v38, 0
 v_pk_max_i16 v39, v39, 0
 buffer_store_dwordx4 v[36:39], v16, s[8:11], s42 offen offset:3072 sc1
 s_add_u32 s42, s42, 114688
 v_cvt_pk_bf16_f32 v24, v140, v141
 v_cvt_pk_bf16_f32 v25, v142, v143
 v_cvt_pk_bf16_f32 v26, v156, v157
 v_cvt_pk_bf16_f32 v27, v158, v159
 v_pk_max_i16 v24, v24, 0
 v_pk_max_i16 v25, v25, 0
 v_pk_max_i16 v26, v26, 0
 v_pk_max_i16 v27, v27, 0
 buffer_store_dwordx4 v[24:27], v16, s[8:11], s42 offen offset:0 sc1
 v_cvt_pk_bf16_f32 v28, v172, v173
 v_cvt_pk_bf16_f32 v29, v174, v175
 v_cvt_pk_bf16_f32 v30, v188, v189
 v_cvt_pk_bf16_f32 v31, v190, v191
 v_pk_max_i16 v28, v28, 0
 v_pk_max_i16 v29, v29, 0
 v_pk_max_i16 v30, v30, 0
 v_pk_max_i16 v31, v31, 0
 buffer_store_dwordx4 v[28:31], v16, s[8:11], s42 offen offset:1024 sc1
 v_cvt_pk_bf16_f32 v32, v204, v205
 v_cvt_pk_bf16_f32 v33, v206, v207
 v_cvt_pk_bf16_f32 v34, v220, v221
 v_cvt_pk_bf16_f32 v35, v222, v223
 v_pk_max_i16 v32, v32, 0
 v_pk_max_i16 v33, v33, 0
 v_pk_max_i16 v34, v34, 0
 v_pk_max_i16 v35, v35, 0
 buffer_store_dwordx4 v[32:35], v16, s[8:11], s42 offen offset:2048 sc1
 v_cvt_pk_bf16_f32 v36, v236, v237
 v_cvt_pk_bf16_f32 v37, v238, v239
 v_cvt_pk_bf16_f32 v38, v252, v253
 v_cvt_pk_bf16_f32 v39, v254, v255
 v_pk_max_i16 v36, v36, 0
 v_pk_max_i16 v37, v37, 0
 v_pk_max_i16 v38, v38, 0
 v_pk_max_i16 v39, v39, 0
 buffer_store_dwordx4 v[36:39], v16, s[8:11], s42 offen offset:3072 sc1
main_kernel_w1skip:
 s_cmp_ge_u32 s32, 14
 s_cselect_b32 s41, 1, 0
 s_lshl_b32 s46, s100, 1
 s_add_u32 s46, s46, s41
 s_and_b32 s69, s2, 1
 s_bfe_u32 s31, s2, 0x20001
 s_lshl_b32 s31, s31, 2
 s_bfe_u32 s33, s2, 0x20003
 s_add_u32 s31, s31, s33
 s_lshr_b32 s68, s2, 5
 s_lshl_b32 s32, s68, 1
 s_add_u32 s32, s32, s69
 s_lshl_b32 s70, s69, 2
 s_mul_i32 s71, s69, 3670016
 s_mul_i32 s72, s69, 57344
 s_lshl_b32 s33, s32, 7
 s_lshl_b32 s67, s68, 8
 s_lshl_b32 s35, s31, 3
 s_lshl_b32 s41, s30, 1
 s_add_u32 s35, s35, s41
 s_lshl_b32 s34, s32, 8
 v_lshrrev_b32 v17, 4, v1
 v_lshlrev_b32 v17, 4, v17
 v_lshlrev_b32 v16, 4, v1
 s_load_dwordx2 s[36:37], s[0:1], 56
 s_load_dwordx2 s[38:39], s[0:1], 80
 s_waitcnt lgkmcnt(0)
 s_mov_b32 s12, s36
 s_mov_b32 s13, s37
 s_mov_b32 s14, 0x700000
 s_mov_b32 s15, 0x20000
 s_mov_b32 s16, s38
 s_mov_b32 s17, s39
 s_mov_b32 s18, 0x400000
 s_mov_b32 s19, 0x20000
 s_cmp_ge_u32 s2, 224
 s_cbranch_scc1 noarr_18
 s_waitcnt vmcnt(0)
 s_barrier
 s_cmp_eq_u32 s30, 0
 s_cbranch_scc0 w0_19
 s_lshl_b32 s78, s46, 7
 s_add_u32 s78, s78, 52697088
 v_mov_b32 v30, 1
 v_mov_b32 v31, 0
 s_mov_b64 exec, 1
 buffer_atomic_add v30, v31, s[8:11], s78 offen sc1
 s_mov_b64 exec, -1
w0_19:
noarr_18:
 v_lshrrev_b32 v40, 4, v1
 v_and_b32 v41, 15, v1
 v_and_b32 v42, 3, v40
 v_lshlrev_b32 v42, 1, v42
 v_xor_b32 v41, v41, v42
 s_mul_i32 s29, s30, 16
 v_add_u32 v40, s29, v40
 s_mov_b32 s29, 2048
 v_mul_lo_u32 v40, v40, s29
 v_add_u32 v40, s67, v40
 v_lshl_add_u32 v2, v41, 4, v40
 v_xor_b32 v41, 8, v41
 v_lshl_add_u32 v3, v41, 4, v40
 s_mul_i32 s27, s30, 4096
 v_lshrrev_b32 v41, 2, v1
 v_mul_u32_u24 v40, 256, v41
 v_and_b32 v42, 3, v1
 v_lshl_add_u32 v40, v42, 3, v40
 v_and_b32 v41, 7, v41
 v_xor_b32 v41, s70, v41
 v_xor_b32 v42, 0, v41
 v_lshlrev_b32 v42, 5, v42
 v_add_u32 v4, v40, v42
 v_xor_b32 v42, 1, v41
 v_lshlrev_b32 v42, 5, v42
 v_add_u32 v5, v40, v42
 v_xor_b32 v42, 2, v41
 v_lshlrev_b32 v42, 5, v42
 v_add_u32 v6, v40, v42
 v_xor_b32 v42, 3, v41
 v_lshlrev_b32 v42, 5, v42
 v_add_u32 v7, v40, v42
 v_xor_b32 v42, 4, v41
 v_lshlrev_b32 v42, 5, v42
 v_add_u32 v8, v40, v42
 v_xor_b32 v42, 5, v41
 v_lshlrev_b32 v42, 5, v42
 v_add_u32 v9, v40, v42
 v_xor_b32 v42, 6, v41
 v_lshlrev_b32 v42, 5, v42
 v_add_u32 v10, v40, v42
 v_xor_b32 v42, 7, v41
 v_lshlrev_b32 v42, 5, v42
 v_add_u32 v11, v40, v42
 s_mov_b32 s20, s71
 s_add_u32 m0, s27, 0
 s_nop 0
 buffer_load_dwordx4 v2, s[12:15], s20 offen lds
 s_add_u32 s29, s20, 7168
 buffer_load_dwordx4 v3, s[12:15], s29 offen offset:1024 lds
 s_add_u32 s29, s20, 14336
 buffer_load_dwordx4 v2, s[12:15], s29 offen offset:2048 lds
 s_add_u32 s29, s20, 21504
 buffer_load_dwordx4 v3, s[12:15], s29 offen offset:3072 lds
 s_add_u32 s20, s20, 131072
 s_add_u32 m0, s27, 16384
 s_nop 0
 buffer_load_dwordx4 v2, s[12:15], s20 offen lds
 s_add_u32 s29, s20, 7168
 buffer_load_dwordx4 v3, s[12:15], s29 offen offset:1024 lds
 s_add_u32 s29, s20, 14336
 buffer_load_dwordx4 v2, s[12:15], s29 offen offset:2048 lds
 s_add_u32 s29, s20, 21504
 buffer_load_dwordx4 v3, s[12:15], s29 offen offset:3072 lds
 s_add_u32 s20, s20, 131072
 s_add_u32 m0, s27, 32768
 s_nop 0
 buffer_load_dwordx4 v2, s[12:15], s20 offen lds
 s_add_u32 s29, s20, 7168
 buffer_load_dwordx4 v3, s[12:15], s29 offen offset:1024 lds
 s_add_u32 s29, s20, 14336
 buffer_load_dwordx4 v2, s[12:15], s29 offen offset:2048 lds
 s_add_u32 s29, s20, 21504
 buffer_load_dwordx4 v3, s[12:15], s29 offen offset:3072 lds
 s_add_u32 s20, s20, 131072
 s_add_u32 m0, s27, 49152
 s_nop 0
 buffer_load_dwordx4 v2, s[12:15], s20 offen lds
 s_add_u32 s29, s20, 7168
 buffer_load_dwordx4 v3, s[12:15], s29 offen offset:1024 lds
 v_lshlrev_b32 v40, 4, v1
 s_mul_i32 s29, s35, 114688
 v_add_u32 v12, s29, v40
 s_add_u32 s29, s29, 114688
 v_add_u32 v13, s29, v40
 v_mov_b32 v128, 0
 v_mov_b32 v129, 0
 v_mov_b32 v130, 0
 v_mov_b32 v131, 0
 v_mov_b32 v132, 0
 v_mov_b32 v133, 0
 v_mov_b32 v134, 0
 v_mov_b32 v135, 0
 v_mov_b32 v136, 0
 v_mov_b32 v137, 0
 v_mov_b32 v138, 0
 v_mov_b32 v139, 0
 v_mov_b32 v140, 0
 v_mov_b32 v141, 0
 v_mov_b32 v142, 0
 v_mov_b32 v143, 0
 v_mov_b32 v144, 0
 v_mov_b32 v145, 0
 v_mov_b32 v146, 0
 v_mov_b32 v147, 0
 v_mov_b32 v148, 0
 v_mov_b32 v149, 0
 v_mov_b32 v150, 0
 v_mov_b32 v151, 0
 v_mov_b32 v152, 0
 v_mov_b32 v153, 0
 v_mov_b32 v154, 0
 v_mov_b32 v155, 0
 v_mov_b32 v156, 0
 v_mov_b32 v157, 0
 v_mov_b32 v158, 0
 v_mov_b32 v159, 0
 v_mov_b32 v160, 0
 v_mov_b32 v161, 0
 v_mov_b32 v162, 0
 v_mov_b32 v163, 0
 v_mov_b32 v164, 0
 v_mov_b32 v165, 0
 v_mov_b32 v166, 0
 v_mov_b32 v167, 0
 v_mov_b32 v168, 0
 v_mov_b32 v169, 0
 v_mov_b32 v170, 0
 v_mov_b32 v171, 0
 v_mov_b32 v172, 0
 v_mov_b32 v173, 0
 v_mov_b32 v174, 0
 v_mov_b32 v175, 0
 v_mov_b32 v176, 0
 v_mov_b32 v177, 0
 v_mov_b32 v178, 0
 v_mov_b32 v179, 0
 v_mov_b32 v180, 0
 v_mov_b32 v181, 0
 v_mov_b32 v182, 0
 v_mov_b32 v183, 0
 v_mov_b32 v184, 0
 v_mov_b32 v185, 0
 v_mov_b32 v186, 0
 v_mov_b32 v187, 0
 v_mov_b32 v188, 0
 v_mov_b32 v189, 0
 v_mov_b32 v190, 0
 v_mov_b32 v191, 0
 s_lshr_b32 s40, s31, 1
 s_lshl_b32 s40, s40, 1
 s_add_u32 s40, s40, s69
 s_cmp_eq_u32 s30, 0
 s_cbranch_scc0 w0_20
 s_lshl_b32 s78, s40, 7
 s_add_u32 s78, s78, 52697088
 v_mov_b32 v31, 0
 s_mov_b64 exec, 1
 s_mov_b32 s76, 0
pl_21:
 buffer_load_dword v30, v31, s[8:11], s78 offen sc1
 s_waitcnt vmcnt(0)
 v_readfirstlane_b32 s77, v30
 s_add_u32 s76, s76, 1
 s_cmp_ge_u32 s77, 14
 s_cbranch_scc1 pd_22
 s_cmp_lt_u32 s76, 0x40000
 s_cbranch_scc1 pl_21
pd_22:
 s_mov_b64 exec, -1
w0_20:
 s_barrier
 s_add_u32 s26, s72, 0x2000000
 buffer_load_dwordx4 a[0:3], v12, s[8:11], s26 offen sc1
 buffer_load_dwordx4 a[4:7], v13, s[8:11], s26 offen sc1
 buffer_load_dwordx4 a[8:11], v12, s[8:11], s26 offen offset:1024 sc1
 buffer_load_dwordx4 a[12:15], v13, s[8:11], s26 offen offset:1024 sc1
 buffer_load_dwordx4 a[16:19], v12, s[8:11], s26 offen offset:2048 sc1
 buffer_load_dwordx4 a[20:23], v13, s[8:11], s26 offen offset:2048 sc1
 buffer_load_dwordx4 a[24:27], v12, s[8:11], s26 offen offset:3072 sc1
 buffer_load_dwordx4 a[28:31], v13, s[8:11], s26 offen offset:3072 sc1
 s_add_u32 s26, s26, 4096
 buffer_load_dwordx4 a[32:35], v12, s[8:11], s26 offen sc1
 buffer_load_dwordx4 a[36:39], v13, s[8:11], s26 offen sc1
 buffer_load_dwordx4 a[40:43], v12, s[8:11], s26 offen offset:1024 sc1
 buffer_load_dwordx4 a[44:47], v13, s[8:11], s26 offen offset:1024 sc1
 buffer_load_dwordx4 a[48:51], v12, s[8:11], s26 offen offset:2048 sc1
 buffer_load_dwordx4 a[52:55], v13, s[8:11], s26 offen offset:2048 sc1
 v_accvgpr_read_b32 v64, a240
 v_accvgpr_read_b32 v65, a241
 v_accvgpr_read_b32 v66, a242
 v_accvgpr_read_b32 v67, a243
 v_accvgpr_read_b32 v68, a244
 v_accvgpr_read_b32 v69, a245
 v_accvgpr_read_b32 v70, a246
 v_accvgpr_read_b32 v71, a247
 v_accvgpr_read_b32 v72, a248
 v_accvgpr_read_b32 v73, a249
 v_accvgpr_read_b32 v74, a250
 v_accvgpr_read_b32 v75, a251
 v_accvgpr_read_b32 v76, a252
 v_accvgpr_read_b32 v77, a253
 v_accvgpr_read_b32 v78, a254
 v_accvgpr_read_b32 v79, a255
 s_add_u32 m0, s27, 49152
 s_mov_b32 s28, 0
 s_waitcnt vmcnt(8)
 s_barrier
 ds_read_b64_tr_b16 a[128:129], v4 offset:0
 ds_read_b64_tr_b16 a[130:131], v4 offset:4096
 ds_read_b64_tr_b16 a[132:133], v5 offset:0
 ds_read_b64_tr_b16 a[134:135], v5 offset:4096
 ds_read_b64_tr_b16 a[136:137], v6 offset:0
 ds_read_b64_tr_b16 a[138:139], v6 offset:4096
 ds_read_b64_tr_b16 a[140:141], v7 offset:0
 ds_read_b64_tr_b16 a[142:143], v7 offset:4096
 ds_read_b64_tr_b16 a[144:145], v8 offset:0
 ds_read_b64_tr_b16 a[146:147], v8 offset:4096
 ds_read_b64_tr_b16 a[148:149], v9 offset:0
 ds_read_b64_tr_b16 a[150:151], v9 offset:4096
 ds_read_b64_tr_b16 a[152:153], v10 offset:0
 ds_read_b64_tr_b16 a[154:155], v10 offset:4096
 ds_read_b64_tr_b16 a[156:157], v11 offset:0
 ds_read_b64_tr_b16 a[158:159], v11 offset:4096
w2_loop:
 s_waitcnt vmcnt(26) lgkmcnt(0)
 v_mfma_f32_16x16x32_bf16 v[128:131], a[128:131], a[0:3], v[128:131]
 ds_read_b64_tr_b16 a[160:161], v4 offset:8192
 ds_read_b64_tr_b16 a[162:163], v4 offset:12288
 v_mfma_f32_16x16x32_bf16 v[132:135], a[128:131], a[4:7], v[132:135]
 ds_read_b64_tr_b16 a[164:165], v5 offset:8192
 v_mfma_f32_16x16x32_bf16 v[140:143], a[132:135], a[4:7], v[140:143]
 ds_read_b64_tr_b16 a[166:167], v5 offset:12288
 v_mfma_f32_16x16x32_bf16 v[136:139], a[132:135], a[0:3], v[136:139]
 ds_read_b64_tr_b16 a[168:169], v6 offset:8192
 ds_read_b64_tr_b16 a[170:171], v6 offset:12288
 v_mfma_f32_16x16x32_bf16 v[144:147], a[136:139], a[0:3], v[144:147]
 ds_read_b64_tr_b16 a[172:173], v7 offset:8192
 v_mfma_f32_16x16x32_bf16 v[148:151], a[136:139], a[4:7], v[148:151]
 ds_read_b64_tr_b16 a[174:175], v7 offset:12288
 v_mfma_f32_16x16x32_bf16 v[156:159], a[140:143], a[4:7], v[156:159]
 ds_read_b64_tr_b16 a[176:177], v8 offset:8192
 ds_read_b64_tr_b16 a[178:179], v8 offset:12288
 v_mfma_f32_16x16x32_bf16 v[152:155], a[140:143], a[0:3], v[152:155]
 ds_read_b64_tr_b16 a[180:181], v9 offset:8192
 v_mfma_f32_16x16x32_bf16 v[160:163], a[144:147], a[0:3], v[160:163]
 ds_read_b64_tr_b16 a[182:183], v9 offset:12288
 buffer_load_dwordx4 a[56:59], v12, s[8:11], s26 offen offset:3072 sc1
 v_mfma_f32_16x16x32_bf16 v[164:167], a[144:147], a[4:7], v[164:167]
 ds_read_b64_tr_b16 a[184:185], v10 offset:8192
 ds_read_b64_tr_b16 a[186:187], v10 offset:12288
 v_mfma_f32_16x16x32_bf16 v[172:175], a[148:151], a[4:7], v[172:175]
 ds_read_b64_tr_b16 a[188:189], v11 offset:8192
 buffer_load_dwordx4 a[60:63], v13, s[8:11], s26 offen offset:3072 sc1
 s_add_u32 s26, s26, 4096
 v_mfma_f32_16x16x32_bf16 v[168:171], a[148:151], a[0:3], v[168:171]
 ds_read_b64_tr_b16 a[190:191], v11 offset:12288
 v_mfma_f32_16x16x32_bf16 v[176:179], a[152:155], a[0:3], v[176:179]
 s_add_u32 s29, s20, 14336
 buffer_load_dwordx4 v2, s[12:15], s29 offen offset:2048 lds
 v_mfma_f32_16x16x32_bf16 v[180:183], a[152:155], a[4:7], v[180:183]
 v_mfma_f32_16x16x32_bf16 v[188:191], a[156:159], a[4:7], v[188:191]
 s_add_u32 s29, s20, 21504
 buffer_load_dwordx4 v3, s[12:15], s29 offen offset:3072 lds
 s_add_u32 s20, s20, 131072
 v_mfma_f32_16x16x32_bf16 v[184:187], a[156:159], a[0:3], v[184:187]
 s_waitcnt vmcnt(16) lgkmcnt(0)
 s_barrier
 v_mfma_f32_16x16x32_bf16 v[128:131], a[160:163], a[8:11], v[128:131]
 ds_read_b64_tr_b16 a[128:129], v4 offset:16384
 ds_read_b64_tr_b16 a[130:131], v4 offset:20480
 v_mfma_f32_16x16x32_bf16 v[132:135], a[160:163], a[12:15], v[132:135]
 ds_read_b64_tr_b16 a[132:133], v5 offset:16384
 v_mfma_f32_16x16x32_bf16 v[140:143], a[164:167], a[12:15], v[140:143]
 ds_read_b64_tr_b16 a[134:135], v5 offset:20480
 v_mfma_f32_16x16x32_bf16 v[136:139], a[164:167], a[8:11], v[136:139]
 ds_read_b64_tr_b16 a[136:137], v6 offset:16384
 ds_read_b64_tr_b16 a[138:139], v6 offset:20480
 v_mfma_f32_16x16x32_bf16 v[144:147], a[168:171], a[8:11], v[144:147]
 ds_read_b64_tr_b16 a[140:141], v7 offset:16384
 v_mfma_f32_16x16x32_bf16 v[148:151], a[168:171], a[12:15], v[148:151]
 ds_read_b64_tr_b16 a[142:143], v7 offset:20480
 v_mfma_f32_16x16x32_bf16 v[156:159], a[172:175], a[12:15], v[156:159]
 ds_read_b64_tr_b16 a[144:145], v8 offset:16384
 ds_read_b64_tr_b16 a[146:147], v8 offset:20480
 v_mfma_f32_16x16x32_bf16 v[152:155], a[172:175], a[8:11], v[152:155]
 ds_read_b64_tr_b16 a[148:149], v9 offset:16384
 v_mfma_f32_16x16x32_bf16 v[160:163], a[176:179], a[8:11], v[160:163]
 ds_read_b64_tr_b16 a[150:151], v9 offset:20480
 buffer_load_dwordx4 a[0:3], v12, s[8:11], s26 offen sc1
 v_mfma_f32_16x16x32_bf16 v[164:167], a[176:179], a[12:15], v[164:167]
 ds_read_b64_tr_b16 a[152:153], v10 offset:16384
 ds_read_b64_tr_b16 a[154:155], v10 offset:20480
 v_mfma_f32_16x16x32_bf16 v[172:175], a[180:183], a[12:15], v[172:175]
 ds_read_b64_tr_b16 a[156:157], v11 offset:16384
 buffer_load_dwordx4 a[4:7], v13, s[8:11], s26 offen sc1
 v_mfma_f32_16x16x32_bf16 v[168:171], a[180:183], a[8:11], v[168:171]
 ds_read_b64_tr_b16 a[158:159], v11 offset:20480
 v_mfma_f32_16x16x32_bf16 v[176:179], a[184:187], a[8:11], v[176:179]
 s_add_u32 m0, s27, 0
 s_nop 0
 buffer_load_dwordx4 v2, s[12:15], s20 offen lds
 v_mfma_f32_16x16x32_bf16 v[180:183], a[184:187], a[12:15], v[180:183]
 v_mfma_f32_16x16x32_bf16 v[188:191], a[188:191], a[12:15], v[188:191]
 s_add_u32 s29, s20, 7168
 buffer_load_dwordx4 v3, s[12:15], s29 offen offset:1024 lds
 v_mfma_f32_16x16x32_bf16 v[184:187], a[188:191], a[8:11], v[184:187]
 s_waitcnt vmcnt(26) lgkmcnt(0)
 v_mfma_f32_16x16x32_bf16 v[128:131], a[128:131], a[16:19], v[128:131]
 ds_read_b64_tr_b16 a[160:161], v4 offset:24576
 ds_read_b64_tr_b16 a[162:163], v4 offset:28672
 v_mfma_f32_16x16x32_bf16 v[132:135], a[128:131], a[20:23], v[132:135]
 ds_read_b64_tr_b16 a[164:165], v5 offset:24576
 v_mfma_f32_16x16x32_bf16 v[140:143], a[132:135], a[20:23], v[140:143]
 ds_read_b64_tr_b16 a[166:167], v5 offset:28672
 v_mfma_f32_16x16x32_bf16 v[136:139], a[132:135], a[16:19], v[136:139]
 ds_read_b64_tr_b16 a[168:169], v6 offset:24576
 ds_read_b64_tr_b16 a[170:171], v6 offset:28672
 v_mfma_f32_16x16x32_bf16 v[144:147], a[136:139], a[16:19], v[144:147]
 ds_read_b64_tr_b16 a[172:173], v7 offset:24576
 v_mfma_f32_16x16x32_bf16 v[148:151], a[136:139], a[20:23], v[148:151]
 ds_read_b64_tr_b16 a[174:175], v7 offset:28672
 v_mfma_f32_16x16x32_bf16 v[156:159], a[140:143], a[20:23], v[156:159]
 ds_read_b64_tr_b16 a[176:177], v8 offset:24576
 ds_read_b64_tr_b16 a[178:179], v8 offset:28672
 v_mfma_f32_16x16x32_bf16 v[152:155], a[140:143], a[16:19], v[152:155]
 ds_read_b64_tr_b16 a[180:181], v9 offset:24576
 v_mfma_f32_16x16x32_bf16 v[160:163], a[144:147], a[16:19], v[160:163]
 ds_read_b64_tr_b16 a[182:183], v9 offset:28672
 buffer_load_dwordx4 a[8:11], v12, s[8:11], s26 offen offset:1024 sc1
 v_mfma_f32_16x16x32_bf16 v[164:167], a[144:147], a[20:23], v[164:167]
 ds_read_b64_tr_b16 a[184:185], v10 offset:24576
 ds_read_b64_tr_b16 a[186:187], v10 offset:28672
 v_mfma_f32_16x16x32_bf16 v[172:175], a[148:151], a[20:23], v[172:175]
 ds_read_b64_tr_b16 a[188:189], v11 offset:24576
 buffer_load_dwordx4 a[12:15], v13, s[8:11], s26 offen offset:1024 sc1
 v_mfma_f32_16x16x32_bf16 v[168:171], a[148:151], a[16:19], v[168:171]
 ds_read_b64_tr_b16 a[190:191], v11 offset:28672
 v_mfma_f32_16x16x32_bf16 v[176:179], a[152:155], a[16:19], v[176:179]
 s_add_u32 s29, s20, 14336
 buffer_load_dwordx4 v2, s[12:15], s29 offen offset:2048 lds
 v_mfma_f32_16x16x32_bf16 v[180:183], a[152:155], a[20:23], v[180:183]
 v_mfma_f32_16x16x32_bf16 v[188:191], a[156:159], a[20:23], v[188:191]
 s_add_u32 s29, s20, 21504
 buffer_load_dwordx4 v3, s[12:15], s29 offen offset:3072 lds
 s_add_u32 s20, s20, 131072
 v_mfma_f32_16x16x32_bf16 v[184:187], a[156:159], a[16:19], v[184:187]
 s_waitcnt vmcnt(16) lgkmcnt(0)
 s_barrier
 v_mfma_f32_16x16x32_bf16 v[128:131], a[160:163], a[24:27], v[128:131]
 ds_read_b64_tr_b16 a[128:129], v4 offset:32768
 ds_read_b64_tr_b16 a[130:131], v4 offset:36864
 v_mfma_f32_16x16x32_bf16 v[132:135], a[160:163], a[28:31], v[132:135]
 ds_read_b64_tr_b16 a[132:133], v5 offset:32768
 v_mfma_f32_16x16x32_bf16 v[140:143], a[164:167], a[28:31], v[140:143]
 ds_read_b64_tr_b16 a[134:135], v5 offset:36864
 v_mfma_f32_16x16x32_bf16 v[136:139], a[164:167], a[24:27], v[136:139]
 ds_read_b64_tr_b16 a[136:137], v6 offset:32768
 ds_read_b64_tr_b16 a[138:139], v6 offset:36864
 v_mfma_f32_16x16x32_bf16 v[144:147], a[168:171], a[24:27], v[144:147]
 ds_read_b64_tr_b16 a[140:141], v7 offset:32768
 v_mfma_f32_16x16x32_bf16 v[148:151], a[168:171], a[28:31], v[148:151]
 ds_read_b64_tr_b16 a[142:143], v7 offset:36864
 v_mfma_f32_16x16x32_bf16 v[156:159], a[172:175], a[28:31], v[156:159]
 ds_read_b64_tr_b16 a[144:145], v8 offset:32768
 ds_read_b64_tr_b16 a[146:147], v8 offset:36864
 v_mfma_f32_16x16x32_bf16 v[152:155], a[172:175], a[24:27], v[152:155]
 ds_read_b64_tr_b16 a[148:149], v9 offset:32768
 v_mfma_f32_16x16x32_bf16 v[160:163], a[176:179], a[24:27], v[160:163]
 ds_read_b64_tr_b16 a[150:151], v9 offset:36864
 buffer_load_dwordx4 a[16:19], v12, s[8:11], s26 offen offset:2048 sc1
 v_mfma_f32_16x16x32_bf16 v[164:167], a[176:179], a[28:31], v[164:167]
 ds_read_b64_tr_b16 a[152:153], v10 offset:32768
 ds_read_b64_tr_b16 a[154:155], v10 offset:36864
 v_mfma_f32_16x16x32_bf16 v[172:175], a[180:183], a[28:31], v[172:175]
 ds_read_b64_tr_b16 a[156:157], v11 offset:32768
 buffer_load_dwordx4 a[20:23], v13, s[8:11], s26 offen offset:2048 sc1
 v_mfma_f32_16x16x32_bf16 v[168:171], a[180:183], a[24:27], v[168:171]
 ds_read_b64_tr_b16 a[158:159], v11 offset:36864
 v_mfma_f32_16x16x32_bf16 v[176:179], a[184:187], a[24:27], v[176:179]
 s_add_u32 m0, s27, 16384
 s_nop 0
 buffer_load_dwordx4 v2, s[12:15], s20 offen lds
 v_mfma_f32_16x16x32_bf16 v[180:183], a[184:187], a[28:31], v[180:183]
 v_mfma_f32_16x16x32_bf16 v[188:191], a[188:191], a[28:31], v[188:191]
 s_add_u32 s29, s20, 7168
 buffer_load_dwordx4 v3, s[12:15], s29 offen offset:1024 lds
 v_mfma_f32_16x16x32_bf16 v[184:187], a[188:191], a[24:27], v[184:187]
 s_waitcnt vmcnt(26) lgkmcnt(0)
 v_mfma_f32_16x16x32_bf16 v[128:131], a[128:131], a[32:35], v[128:131]
 ds_read_b64_tr_b16 a[160:161], v4 offset:40960
 ds_read_b64_tr_b16 a[162:163], v4 offset:45056
 v_mfma_f32_16x16x32_bf16 v[132:135], a[128:131], a[36:39], v[132:135]
 ds_read_b64_tr_b16 a[164:165], v5 offset:40960
 v_mfma_f32_16x16x32_bf16 v[140:143], a[132:135], a[36:39], v[140:143]
 ds_read_b64_tr_b16 a[166:167], v5 offset:45056
 v_mfma_f32_16x16x32_bf16 v[136:139], a[132:135], a[32:35], v[136:139]
 ds_read_b64_tr_b16 a[168:169], v6 offset:40960
 ds_read_b64_tr_b16 a[170:171], v6 offset:45056
 v_mfma_f32_16x16x32_bf16 v[144:147], a[136:139], a[32:35], v[144:147]
 ds_read_b64_tr_b16 a[172:173], v7 offset:40960
 v_mfma_f32_16x16x32_bf16 v[148:151], a[136:139], a[36:39], v[148:151]
 ds_read_b64_tr_b16 a[174:175], v7 offset:45056
 v_mfma_f32_16x16x32_bf16 v[156:159], a[140:143], a[36:39], v[156:159]
 ds_read_b64_tr_b16 a[176:177], v8 offset:40960
 ds_read_b64_tr_b16 a[178:179], v8 offset:45056
 v_mfma_f32_16x16x32_bf16 v[152:155], a[140:143], a[32:35], v[152:155]
 ds_read_b64_tr_b16 a[180:181], v9 offset:40960
 v_mfma_f32_16x16x32_bf16 v[160:163], a[144:147], a[32:35], v[160:163]
 ds_read_b64_tr_b16 a[182:183], v9 offset:45056
 buffer_load_dwordx4 a[24:27], v12, s[8:11], s26 offen offset:3072 sc1
 v_mfma_f32_16x16x32_bf16 v[164:167], a[144:147], a[36:39], v[164:167]
 ds_read_b64_tr_b16 a[184:185], v10 offset:40960
 ds_read_b64_tr_b16 a[186:187], v10 offset:45056
 v_mfma_f32_16x16x32_bf16 v[172:175], a[148:151], a[36:39], v[172:175]
 ds_read_b64_tr_b16 a[188:189], v11 offset:40960
 buffer_load_dwordx4 a[28:31], v13, s[8:11], s26 offen offset:3072 sc1
 s_add_u32 s26, s26, 4096
 v_mfma_f32_16x16x32_bf16 v[168:171], a[148:151], a[32:35], v[168:171]
 ds_read_b64_tr_b16 a[190:191], v11 offset:45056
 v_mfma_f32_16x16x32_bf16 v[176:179], a[152:155], a[32:35], v[176:179]
 s_add_u32 s29, s20, 14336
 buffer_load_dwordx4 v2, s[12:15], s29 offen offset:2048 lds
 v_mfma_f32_16x16x32_bf16 v[180:183], a[152:155], a[36:39], v[180:183]
 v_mfma_f32_16x16x32_bf16 v[188:191], a[156:159], a[36:39], v[188:191]
 s_add_u32 s29, s20, 21504
 buffer_load_dwordx4 v3, s[12:15], s29 offen offset:3072 lds
 s_add_u32 s20, s20, 131072
 v_mfma_f32_16x16x32_bf16 v[184:187], a[156:159], a[32:35], v[184:187]
 s_waitcnt vmcnt(16) lgkmcnt(0)
 s_barrier
 v_mfma_f32_16x16x32_bf16 v[128:131], a[160:163], a[40:43], v[128:131]
 ds_read_b64_tr_b16 a[128:129], v4 offset:49152
 ds_read_b64_tr_b16 a[130:131], v4 offset:53248
 v_mfma_f32_16x16x32_bf16 v[132:135], a[160:163], a[44:47], v[132:135]
 ds_read_b64_tr_b16 a[132:133], v5 offset:49152
 v_mfma_f32_16x16x32_bf16 v[140:143], a[164:167], a[44:47], v[140:143]
 ds_read_b64_tr_b16 a[134:135], v5 offset:53248
 v_mfma_f32_16x16x32_bf16 v[136:139], a[164:167], a[40:43], v[136:139]
 ds_read_b64_tr_b16 a[136:137], v6 offset:49152
 ds_read_b64_tr_b16 a[138:139], v6 offset:53248
 v_mfma_f32_16x16x32_bf16 v[144:147], a[168:171], a[40:43], v[144:147]
 ds_read_b64_tr_b16 a[140:141], v7 offset:49152
 v_mfma_f32_16x16x32_bf16 v[148:151], a[168:171], a[44:47], v[148:151]
 ds_read_b64_tr_b16 a[142:143], v7 offset:53248
 v_mfma_f32_16x16x32_bf16 v[156:159], a[172:175], a[44:47], v[156:159]
 ds_read_b64_tr_b16 a[144:145], v8 offset:49152
 ds_read_b64_tr_b16 a[146:147], v8 offset:53248
 v_mfma_f32_16x16x32_bf16 v[152:155], a[172:175], a[40:43], v[152:155]
 ds_read_b64_tr_b16 a[148:149], v9 offset:49152
 v_mfma_f32_16x16x32_bf16 v[160:163], a[176:179], a[40:43], v[160:163]
 ds_read_b64_tr_b16 a[150:151], v9 offset:53248
 buffer_load_dwordx4 a[32:35], v12, s[8:11], s26 offen sc1
 v_mfma_f32_16x16x32_bf16 v[164:167], a[176:179], a[44:47], v[164:167]
 ds_read_b64_tr_b16 a[152:153], v10 offset:49152
 ds_read_b64_tr_b16 a[154:155], v10 offset:53248
 v_mfma_f32_16x16x32_bf16 v[172:175], a[180:183], a[44:47], v[172:175]
 ds_read_b64_tr_b16 a[156:157], v11 offset:49152
 buffer_load_dwordx4 a[36:39], v13, s[8:11], s26 offen sc1
 v_mfma_f32_16x16x32_bf16 v[168:171], a[180:183], a[40:43], v[168:171]
 ds_read_b64_tr_b16 a[158:159], v11 offset:53248
 v_mfma_f32_16x16x32_bf16 v[176:179], a[184:187], a[40:43], v[176:179]
 s_add_u32 m0, s27, 32768
 s_nop 0
 buffer_load_dwordx4 v2, s[12:15], s20 offen lds
 v_mfma_f32_16x16x32_bf16 v[180:183], a[184:187], a[44:47], v[180:183]
 v_mfma_f32_16x16x32_bf16 v[188:191], a[188:191], a[44:47], v[188:191]
 s_add_u32 s29, s20, 7168
 buffer_load_dwordx4 v3, s[12:15], s29 offen offset:1024 lds
 v_mfma_f32_16x16x32_bf16 v[184:187], a[188:191], a[40:43], v[184:187]
 s_waitcnt vmcnt(26) lgkmcnt(0)
 v_mfma_f32_16x16x32_bf16 v[128:131], a[128:131], a[48:51], v[128:131]
 ds_read_b64_tr_b16 a[160:161], v4 offset:57344
 ds_read_b64_tr_b16 a[162:163], v4 offset:61440
 v_mfma_f32_16x16x32_bf16 v[132:135], a[128:131], a[52:55], v[132:135]
 ds_read_b64_tr_b16 a[164:165], v5 offset:57344
 v_mfma_f32_16x16x32_bf16 v[140:143], a[132:135], a[52:55], v[140:143]
 ds_read_b64_tr_b16 a[166:167], v5 offset:61440
 v_mfma_f32_16x16x32_bf16 v[136:139], a[132:135], a[48:51], v[136:139]
 ds_read_b64_tr_b16 a[168:169], v6 offset:57344
 ds_read_b64_tr_b16 a[170:171], v6 offset:61440
 v_mfma_f32_16x16x32_bf16 v[144:147], a[136:139], a[48:51], v[144:147]
 ds_read_b64_tr_b16 a[172:173], v7 offset:57344
 v_mfma_f32_16x16x32_bf16 v[148:151], a[136:139], a[52:55], v[148:151]
 ds_read_b64_tr_b16 a[174:175], v7 offset:61440
 v_mfma_f32_16x16x32_bf16 v[156:159], a[140:143], a[52:55], v[156:159]
 ds_read_b64_tr_b16 a[176:177], v8 offset:57344
 ds_read_b64_tr_b16 a[178:179], v8 offset:61440
 v_mfma_f32_16x16x32_bf16 v[152:155], a[140:143], a[48:51], v[152:155]
 ds_read_b64_tr_b16 a[180:181], v9 offset:57344
 v_mfma_f32_16x16x32_bf16 v[160:163], a[144:147], a[48:51], v[160:163]
 ds_read_b64_tr_b16 a[182:183], v9 offset:61440
 buffer_load_dwordx4 a[40:43], v12, s[8:11], s26 offen offset:1024 sc1
 v_mfma_f32_16x16x32_bf16 v[164:167], a[144:147], a[52:55], v[164:167]
 ds_read_b64_tr_b16 a[184:185], v10 offset:57344
 ds_read_b64_tr_b16 a[186:187], v10 offset:61440
 v_mfma_f32_16x16x32_bf16 v[172:175], a[148:151], a[52:55], v[172:175]
 ds_read_b64_tr_b16 a[188:189], v11 offset:57344
 buffer_load_dwordx4 a[44:47], v13, s[8:11], s26 offen offset:1024 sc1
 v_mfma_f32_16x16x32_bf16 v[168:171], a[148:151], a[48:51], v[168:171]
 ds_read_b64_tr_b16 a[190:191], v11 offset:61440
 v_mfma_f32_16x16x32_bf16 v[176:179], a[152:155], a[48:51], v[176:179]
 s_add_u32 s29, s20, 14336
 buffer_load_dwordx4 v2, s[12:15], s29 offen offset:2048 lds
 v_mfma_f32_16x16x32_bf16 v[180:183], a[152:155], a[52:55], v[180:183]
 v_mfma_f32_16x16x32_bf16 v[188:191], a[156:159], a[52:55], v[188:191]
 s_add_u32 s29, s20, 21504
 buffer_load_dwordx4 v3, s[12:15], s29 offen offset:3072 lds
 s_add_u32 s20, s20, 131072
 v_mfma_f32_16x16x32_bf16 v[184:187], a[156:159], a[48:51], v[184:187]
 s_waitcnt vmcnt(16) lgkmcnt(0)
 s_barrier
 v_mfma_f32_16x16x32_bf16 v[128:131], a[160:163], a[56:59], v[128:131]
 ds_read_b64_tr_b16 a[128:129], v4 offset:0
 ds_read_b64_tr_b16 a[130:131], v4 offset:4096
 v_mfma_f32_16x16x32_bf16 v[132:135], a[160:163], a[60:63], v[132:135]
 ds_read_b64_tr_b16 a[132:133], v5 offset:0
 v_mfma_f32_16x16x32_bf16 v[140:143], a[164:167], a[60:63], v[140:143]
 ds_read_b64_tr_b16 a[134:135], v5 offset:4096
 v_mfma_f32_16x16x32_bf16 v[136:139], a[164:167], a[56:59], v[136:139]
 ds_read_b64_tr_b16 a[136:137], v6 offset:0
 ds_read_b64_tr_b16 a[138:139], v6 offset:4096
 v_mfma_f32_16x16x32_bf16 v[144:147], a[168:171], a[56:59], v[144:147]
 ds_read_b64_tr_b16 a[140:141], v7 offset:0
 v_mfma_f32_16x16x32_bf16 v[148:151], a[168:171], a[60:63], v[148:151]
 ds_read_b64_tr_b16 a[142:143], v7 offset:4096
 v_mfma_f32_16x16x32_bf16 v[156:159], a[172:175], a[60:63], v[156:159]
 ds_read_b64_tr_b16 a[144:145], v8 offset:0
 ds_read_b64_tr_b16 a[146:147], v8 offset:4096
 v_mfma_f32_16x16x32_bf16 v[152:155], a[172:175], a[56:59], v[152:155]
 ds_read_b64_tr_b16 a[148:149], v9 offset:0
 v_mfma_f32_16x16x32_bf16 v[160:163], a[176:179], a[56:59], v[160:163]
 ds_read_b64_tr_b16 a[150:151], v9 offset:4096
 buffer_load_dwordx4 a[48:51], v12, s[8:11], s26 offen offset:2048 sc1
 v_mfma_f32_16x16x32_bf16 v[164:167], a[176:179], a[60:63], v[164:167]
 ds_read_b64_tr_b16 a[152:153], v10 offset:0
 ds_read_b64_tr_b16 a[154:155], v10 offset:4096
 v_mfma_f32_16x16x32_bf16 v[172:175], a[180:183], a[60:63], v[172:175]
 ds_read_b64_tr_b16 a[156:157], v11 offset:0
 buffer_load_dwordx4 a[52:55], v13, s[8:11], s26 offen offset:2048 sc1
 v_mfma_f32_16x16x32_bf16 v[168:171], a[180:183], a[56:59], v[168:171]
 ds_read_b64_tr_b16 a[158:159], v11 offset:4096
 v_mfma_f32_16x16x32_bf16 v[176:179], a[184:187], a[56:59], v[176:179]
 s_add_u32 m0, s27, 49152
 s_nop 0
 buffer_load_dwordx4 v2, s[12:15], s20 offen lds
 v_mfma_f32_16x16x32_bf16 v[180:183], a[184:187], a[60:63], v[180:183]
 v_mfma_f32_16x16x32_bf16 v[188:191], a[188:191], a[60:63], v[188:191]
 s_add_u32 s29, s20, 7168
 buffer_load_dwordx4 v3, s[12:15], s29 offen offset:1024 lds
 v_mfma_f32_16x16x32_bf16 v[184:187], a[188:191], a[56:59], v[184:187]
 s_add_u32 s28, s28, 1
 s_cmp_lt_u32 s28, 7
 s_cbranch_scc1 w2_loop
 s_lshl_b32 s73, s31, 3
 s_add_u32 s73, s73, s68
 s_lshl_b32 s73, s73, 1
 s_add_u32 s74, s73, s69
 s_xor_b32 s75, s69, 1
 s_add_u32 s75, s73, s75
 s_lshl_b32 s74, s74, 2
 s_add_u32 s74, s74, s30
 s_lshl_b32 s75, s75, 2
 s_add_u32 s75, s75, s30
 s_lshl_b32 s78, s74, 7
 s_add_u32 s78, s78, 52559872
 s_lshl_b32 s79, s75, 7
 s_add_u32 s79, s79, 52559872
 s_lshl_b32 s74, s74, 14
 s_add_u32 s74, s74, 67117056
 s_lshl_b32 s75, s75, 14
 s_add_u32 s75, s75, 67117056
 s_nop 7
 buffer_store_dwordx4 v[160:163], v16, s[8:11], s75 offen offset:0 sc1
 buffer_store_dwordx4 v[164:167], v16, s[8:11], s75 offen offset:1024 sc1
 buffer_store_dwordx4 v[168:171], v16, s[8:11], s75 offen offset:2048 sc1
 buffer_store_dwordx4 v[172:175], v16, s[8:11], s75 offen offset:3072 sc1
 s_add_u32 s75, s75, 4096
 buffer_store_dwordx4 v[176:179], v16, s[8:11], s75 offen offset:0 sc1
 buffer_store_dwordx4 v[180:183], v16, s[8:11], s75 offen offset:1024 sc1
 buffer_store_dwordx4 v[184:187], v16, s[8:11], s75 offen offset:2048 sc1
 buffer_store_dwordx4 v[188:191], v16, s[8:11], s75 offen offset:3072 sc1
 v_and_b32 v18, 63, v0
 v_lshlrev_b32 v18, 2, v18
 s_add_u32 s40, s34, 51728384
 buffer_load_dword v112, v18, s[8:11], s40 offen
 s_add_u32 s40, s40, 24576
 buffer_load_dword v113, v18, s[8:11], s40 offen
 s_add_u32 s40, s40, 24576
 buffer_load_dword v114, v18, s[8:11], s40 offen
 s_add_u32 s40, s40, 24576
 buffer_load_dword v115, v18, s[8:11], s40 offen
 s_add_u32 s40, s40, 24576
 buffer_load_dword v116, v18, s[8:11], s40 offen
 s_add_u32 s40, s40, 24576
 buffer_load_dword v117, v18, s[8:11], s40 offen
 s_add_u32 s40, s40, 24576
 buffer_load_dword v118, v18, s[8:11], s40 offen
 s_add_u32 s40, s40, 24576
 buffer_load_dword v119, v18, s[8:11], s40 offen
 v_and_b32 v46, 15, v1
 v_lshlrev_b32 v46, 3, v46
 v_lshrrev_b32 v47, 4, v1
 v_lshl_add_u32 v46, v47, 16, v46
 s_lshl_b32 s40, s35, 7
 s_add_u32 s40, s40, 51445760
 buffer_load_dwordx2 v[96:97], v46, s[8:11], s40 offen offset:0 sc1
 buffer_load_dwordx2 v[104:105], v46, s[8:11], s40 offen offset:128 sc1
 s_add_u32 s40, s40, 16384
 buffer_load_dwordx2 v[98:99], v46, s[8:11], s40 offen offset:0 sc1
 buffer_load_dwordx2 v[106:107], v46, s[8:11], s40 offen offset:128 sc1
 s_add_u32 s40, s40, 16384
 buffer_load_dwordx2 v[100:101], v46, s[8:11], s40 offen offset:0 sc1
 buffer_load_dwordx2 v[108:109], v46, s[8:11], s40 offen offset:128 sc1
 s_add_u32 s40, s40, 16384
 buffer_load_dwordx2 v[102:103], v46, s[8:11], s40 offen offset:0 sc1
 buffer_load_dwordx2 v[110:111], v46, s[8:11], s40 offen offset:128 sc1
 v_mov_b32 v224, 1
 v_mov_b32 v225, 0
 s_waitcnt vmcnt(16)
 s_mov_b64 exec, 1
 buffer_store_dword v224, v225, s[8:11], s79 offen sc1
 s_mov_b64 exec, -1
 s_waitcnt vmcnt(1)
 v_add_f32 v112, v112, v113
 v_add_f32 v114, v114, v115
 v_add_f32 v116, v116, v117
 v_add_f32 v118, v118, v119
 v_add_f32 v112, v112, v114
 v_add_f32 v116, v116, v118
 v_add_f32 v112, v112, v116
 v_cvt_pk_bf16_f32 v112, v112, v112
 v_lshlrev_b32 v112, 16, v112
 v_lshlrev_b32 v18, 2, v0
 v_add_u32 v18, 131072, v18
 ds_write_b32 v18, v112
 s_waitcnt lgkmcnt(0)
 s_barrier
 v_add_u32 v18, 131072, v17
 ds_read_b128 v[80:83], v18 offset:0
 ds_read_b128 v[84:87], v18 offset:64
 ds_read_b128 v[88:91], v18 offset:128
 ds_read_b128 v[92:95], v18 offset:192
 v_add_f32 v20, v96, v98
 v_add_f32 v22, v100, v102
 v_add_f32 v20, v20, v22
 v_add_f32 v21, v104, v106
 v_add_f32 v23, v108, v110
 v_add_f32 v21, v21, v23
 v_mov_b32 v44, v20
 v_mov_b32 v45, v21
 s_nop 0
 v_permlane16_swap_b32 v20, v44
 v_permlane16_swap_b32 v21, v45
 v_add_f32 v20, v20, v44
 v_add_f32 v21, v21, v45
 v_mov_b32 v44, v20
 v_mov_b32 v45, v21
 s_nop 0
 v_permlane32_swap_b32 v20, v44
 v_permlane32_swap_b32 v21, v45
 v_add_f32 v20, v20, v44
 v_add_f32 v21, v21, v45
 v_mul_f32 v20, 0x3d800000, v20
 v_sub_f32 v96, v96, v20
 v_sub_f32 v98, v98, v20
 v_sub_f32 v100, v100, v20
 v_sub_f32 v102, v102, v20
 v_mul_f32 v96, v96, v96
 v_mul_f32 v98, v98, v98
 v_mul_f32 v100, v100, v100
 v_mul_f32 v102, v102, v102
 v_add_f32 v96, v96, v98
 v_add_f32 v100, v100, v102
 v_add_f32 v96, v96, v100
 v_add_f32 v97, v97, v99
 v_add_f32 v101, v101, v103
 v_add_f32 v97, v97, v101
 v_mov_b32 v22, v97
 v_fmac_f32 v22, 0x42800000, v96
 v_mul_f32 v21, 0x3d800000, v21
 v_sub_f32 v104, v104, v21
 v_sub_f32 v106, v106, v21
 v_sub_f32 v108, v108, v21
 v_sub_f32 v110, v110, v21
 v_mul_f32 v104, v104, v104
 v_mul_f32 v106, v106, v106
 v_mul_f32 v108, v108, v108
 v_mul_f32 v110, v110, v110
 v_add_f32 v104, v104, v106
 v_add_f32 v108, v108, v110
 v_add_f32 v104, v104, v108
 v_add_f32 v105, v105, v107
 v_add_f32 v109, v109, v111
 v_add_f32 v105, v105, v109
 v_mov_b32 v23, v105
 v_fmac_f32 v23, 0x42800000, v104
 v_mov_b32 v44, v22
 v_mov_b32 v45, v23
 s_nop 0
 v_permlane16_swap_b32 v22, v44
 v_permlane16_swap_b32 v23, v45
 v_add_f32 v22, v22, v44
 v_add_f32 v23, v23, v45
 v_mov_b32 v44, v22
 v_mov_b32 v45, v23
 s_nop 0
 v_permlane32_swap_b32 v22, v44
 v_permlane32_swap_b32 v23, v45
 v_add_f32 v22, v22, v44
 v_add_f32 v23, v23, v45
 v_mov_b32 v44, 0x3727c5ac
 v_fmac_f32 v44, 0x3a800000, v22
 v_sqrt_f32 v22, v44
 v_mov_b32 v45, 0x3727c5ac
 v_fmac_f32 v45, 0x3a800000, v23
 v_sqrt_f32 v23, v45
 v_rcp_f32 v22, v22
 v_rcp_f32 v23, v23
 v_and_b32 v24, 15, v1
 v_lshlrev_b32 v24, 11, v24
 v_bfe_u32 v25, v1, 4, 1
 v_lshl_add_u32 v24, v25, 5, v24
 v_lshrrev_b32 v25, 5, v1
 v_lshl_add_u32 v24, v25, 4, v24
 s_lshl_b32 s43, s35, 15
 s_add_u32 s43, s43, s33
 s_waitcnt lgkmcnt(0)
 v_mov_b32 v225, 0
 s_mov_b64 exec, 1
 s_mov_b32 s76, 0
main_kernel_w2_poll:
 buffer_load_dword v226, v225, s[8:11], s78 offen sc1
 s_waitcnt vmcnt(0)
 v_readfirstlane_b32 s77, v226
 s_add_u32 s76, s76, 1
 s_cmp_eq_u32 s77, 1
 s_cbranch_scc1 main_kernel_w2_got
 s_cmp_lt_u32 s76, 0x40000
 s_cbranch_scc1 main_kernel_w2_poll
main_kernel_w2_got:
 s_mov_b64 exec, -1
 s_add_u32 s77, s74, 4096
 buffer_load_dwordx4 v[192:195], v16, s[8:11], s74 offen offset:0 sc1
 buffer_load_dwordx4 v[196:199], v16, s[8:11], s74 offen offset:1024 sc1
 buffer_load_dwordx4 v[200:203], v16, s[8:11], s74 offen offset:2048 sc1
 buffer_load_dwordx4 v[204:207], v16, s[8:11], s74 offen offset:3072 sc1
 buffer_load_dwordx4 v[208:211], v16, s[8:11], s77 offen offset:0 sc1
 buffer_load_dwordx4 v[212:215], v16, s[8:11], s77 offen offset:1024 sc1
 buffer_load_dwordx4 v[216:219], v16, s[8:11], s77 offen offset:2048 sc1
 buffer_load_dwordx4 v[220:223], v16, s[8:11], s77 offen offset:3072 sc1
 s_waitcnt vmcnt(7)
 v_add_f32 v128, v128, v192
 v_add_f32 v129, v129, v193
 v_add_f32 v130, v130, v194
 v_add_f32 v131, v131, v195
 s_waitcnt vmcnt(6)
 v_add_f32 v132, v132, v196
 v_add_f32 v133, v133, v197
 v_add_f32 v134, v134, v198
 v_add_f32 v135, v135, v199
 s_waitcnt vmcnt(5)
 v_add_f32 v136, v136, v200
 v_add_f32 v137, v137, v201
 v_add_f32 v138, v138, v202
 v_add_f32 v139, v139, v203
 s_waitcnt vmcnt(4)
 v_add_f32 v140, v140, v204
 v_add_f32 v141, v141, v205
 v_add_f32 v142, v142, v206
 v_add_f32 v143, v143, v207
 s_waitcnt vmcnt(3)
 v_add_f32 v144, v144, v208
 v_add_f32 v145, v145, v209
 v_add_f32 v146, v146, v210
 v_add_f32 v147, v147, v211
 s_waitcnt vmcnt(2)
 v_add_f32 v148, v148, v212
 v_add_f32 v149, v149, v213
 v_add_f32 v150, v150, v214
 v_add_f32 v151, v151, v215
 s_waitcnt vmcnt(1)
 v_add_f32 v152, v152, v216
 v_add_f32 v153, v153, v217
 v_add_f32 v154, v154, v218
 v_add_f32 v155, v155, v219
 s_waitcnt vmcnt(0)
 v_add_f32 v156, v156, v220
 v_add_f32 v157, v157, v221
 v_add_f32 v158, v158, v222
 v_add_f32 v159, v159, v223
 v_mul_f32 v128, v128, v22
 v_mul_f32 v129, v129, v22
 v_mul_f32 v130, v130, v22
 v_mul_f32 v131, v131, v22
 v_lshlrev_b32 v224, 16, v64
 v_and_b32 v225, 0xffff0000, v64
 v_lshlrev_b32 v226, 16, v65
 v_and_b32 v227, 0xffff0000, v65
 v_fmac_f32 v224, v80, v128
 v_fmac_f32 v225, v81, v129
 v_fmac_f32 v226, v82, v130
 v_fmac_f32 v227, v83, v131
 v_mul_f32 v136, v136, v22
 v_mul_f32 v137, v137, v22
 v_mul_f32 v138, v138, v22
 v_mul_f32 v139, v139, v22
 v_lshlrev_b32 v228, 16, v66
 v_and_b32 v229, 0xffff0000, v66
 v_lshlrev_b32 v230, 16, v67
 v_and_b32 v231, 0xffff0000, v67
 v_fmac_f32 v228, v84, v136
 v_fmac_f32 v229, v85, v137
 v_fmac_f32 v230, v86, v138
 v_fmac_f32 v231, v87, v139
 v_mul_f32 v144, v144, v22
 v_mul_f32 v145, v145, v22
 v_mul_f32 v146, v146, v22
 v_mul_f32 v147, v147, v22
 v_lshlrev_b32 v232, 16, v68
 v_and_b32 v233, 0xffff0000, v68
 v_lshlrev_b32 v234, 16, v69
 v_and_b32 v235, 0xffff0000, v69
 v_fmac_f32 v232, v88, v144
 v_fmac_f32 v233, v89, v145
 v_fmac_f32 v234, v90, v146
 v_fmac_f32 v235, v91, v147
 v_mul_f32 v152, v152, v22
 v_mul_f32 v153, v153, v22
 v_mul_f32 v154, v154, v22
 v_mul_f32 v155, v155, v22
 v_lshlrev_b32 v236, 16, v70
 v_and_b32 v237, 0xffff0000, v70
 v_lshlrev_b32 v238, 16, v71
 v_and_b32 v239, 0xffff0000, v71
 v_fmac_f32 v236, v92, v152
 v_fmac_f32 v237, v93, v153
 v_fmac_f32 v238, v94, v154
 v_fmac_f32 v239, v95, v155
 v_cvt_pk_bf16_f32 v240, v224, v225
 v_cvt_pk_bf16_f32 v241, v226, v227
 v_cvt_pk_bf16_f32 v242, v228, v229
 v_cvt_pk_bf16_f32 v243, v230, v231
 v_cvt_pk_bf16_f32 v244, v232, v233
 v_cvt_pk_bf16_f32 v245, v234, v235
 v_cvt_pk_bf16_f32 v246, v236, v237
 v_cvt_pk_bf16_f32 v247, v238, v239
 v_permlane16_swap_b32 v240, v242
 v_permlane16_swap_b32 v241, v243
 v_permlane16_swap_b32 v244, v246
 v_permlane16_swap_b32 v245, v247
 buffer_store_dwordx4 v[240:243], v24, s[16:19], s43 offen offset:0
 buffer_store_dwordx4 v[244:247], v24, s[16:19], s43 offen offset:64
 s_add_u32 s43, s43, 32768
 v_mul_f32 v132, v132, v23
 v_mul_f32 v133, v133, v23
 v_mul_f32 v134, v134, v23
 v_mul_f32 v135, v135, v23
 v_lshlrev_b32 v224, 16, v72
 v_and_b32 v225, 0xffff0000, v72
 v_lshlrev_b32 v226, 16, v73
 v_and_b32 v227, 0xffff0000, v73
 v_fmac_f32 v224, v80, v132
 v_fmac_f32 v225, v81, v133
 v_fmac_f32 v226, v82, v134
 v_fmac_f32 v227, v83, v135
 v_mul_f32 v140, v140, v23
 v_mul_f32 v141, v141, v23
 v_mul_f32 v142, v142, v23
 v_mul_f32 v143, v143, v23
 v_lshlrev_b32 v228, 16, v74
 v_and_b32 v229, 0xffff0000, v74
 v_lshlrev_b32 v230, 16, v75
 v_and_b32 v231, 0xffff0000, v75
 v_fmac_f32 v228, v84, v140
 v_fmac_f32 v229, v85, v141
 v_fmac_f32 v230, v86, v142
 v_fmac_f32 v231, v87, v143
 v_mul_f32 v148, v148, v23
 v_mul_f32 v149, v149, v23
 v_mul_f32 v150, v150, v23
 v_mul_f32 v151, v151, v23
 v_lshlrev_b32 v232, 16, v76
 v_and_b32 v233, 0xffff0000, v76
 v_lshlrev_b32 v234, 16, v77
 v_and_b32 v235, 0xffff0000, v77
 v_fmac_f32 v232, v88, v148
 v_fmac_f32 v233, v89, v149
 v_fmac_f32 v234, v90, v150
 v_fmac_f32 v235, v91, v151
 v_mul_f32 v156, v156, v23
 v_mul_f32 v157, v157, v23
 v_mul_f32 v158, v158, v23
 v_mul_f32 v159, v159, v23
 v_lshlrev_b32 v236, 16, v78
 v_and_b32 v237, 0xffff0000, v78
 v_lshlrev_b32 v238, 16, v79
 v_and_b32 v239, 0xffff0000, v79
 v_fmac_f32 v236, v92, v156
 v_fmac_f32 v237, v93, v157
 v_fmac_f32 v238, v94, v158
 v_fmac_f32 v239, v95, v159
 v_cvt_pk_bf16_f32 v248, v224, v225
 v_cvt_pk_bf16_f32 v249, v226, v227
 v_cvt_pk_bf16_f32 v250, v228, v229
 v_cvt_pk_bf16_f32 v251, v230, v231
 v_cvt_pk_bf16_f32 v252, v232, v233
 v_cvt_pk_bf16_f32 v253, v234, v235
 v_cvt_pk_bf16_f32 v254, v236, v237
 v_cvt_pk_bf16_f32 v255, v238, v239
 v_permlane16_swap_b32 v248, v250
 v_permlane16_swap_b32 v249, v251
 v_permlane16_swap_b32 v252, v254
 v_permlane16_swap_b32 v253, v255
 buffer_store_dwordx4 v[248:251], v24, s[16:19], s43 offen offset:0
 buffer_store_dwordx4 v[252:255], v24, s[16:19], s43 offen offset:64
main_kernel_end:
 s_endpgm
.section .rodata,"a"
.p2align 6
.amdhsa_kernel prep_kernel
.amdhsa_next_free_vgpr 192
.amdhsa_next_free_sgpr 102
.amdhsa_accum_offset 192
.amdhsa_group_segment_fixed_size 0
.amdhsa_kernarg_size 104
.amdhsa_user_sgpr_count 2
.amdhsa_user_sgpr_kernarg_segment_ptr 1
.amdhsa_system_sgpr_workgroup_id_x 1
.amdhsa_float_denorm_mode_32 3
.amdhsa_float_denorm_mode_16_64 3
.amdhsa_ieee_mode 0
.amdhsa_dx10_clamp 0
.end_amdhsa_kernel
.amdhsa_kernel main_kernel
.amdhsa_next_free_vgpr 512
.amdhsa_next_free_sgpr 102
.amdhsa_accum_offset 256
.amdhsa_group_segment_fixed_size 0
.amdhsa_kernarg_size 104
.amdhsa_user_sgpr_count 2
.amdhsa_user_sgpr_kernarg_segment_ptr 1
.amdhsa_system_sgpr_workgroup_id_x 1
.amdhsa_float_denorm_mode_32 3
.amdhsa_float_denorm_mode_16_64 3
.amdhsa_ieee_mode 0
.amdhsa_dx10_clamp 0
.end_amdhsa_kernel
```
